```python
import torch

def _softmax(x, axis=-1):
    return torch.softmax(x, dim=axis)
def _gelu(x):
    return torch.nn.functional.gelu(x, approximate="tanh")
def _silu(x):
    return torch.nn.functional.silu(x)
def _sigmoid(x):
    return torch.sigmoid(x)
def _layernorm(x, axis=-1, eps=1e-5):
    m = x.mean(dim=axis, keepdim=True)
    v = x.var(dim=axis, keepdim=True, unbiased=False)
    return (x - m) / torch.sqrt(v + eps)
def _scatter_add(tgt, idx, src, axis=0):
    return tgt.clone().index_add_(axis, idx, src)
def _segment_sum(src, seg, n):
    out = torch.zeros((n,) + src.shape[1:], dtype=src.dtype)
    return out.index_add_(0, seg, src)
def _pad(x, pw):
    flat = tuple(v for pair in reversed(pw) for v in pair)
    return torch.nn.functional.pad(x, flat)

kernel_name = 'gated_mix__softmax_full_mha__linear_kernel_hedgehog__prompt'

def setup_inputs():

    _w = (lambda a: (lambda t: t.to(torch.bfloat16) if t.is_floating_point() else t)(torch.as_tensor(a)))
    def _A_setup():
        B, S, D = 1, 2048, 1024
        return {
            "x": _w((lambda *s: torch.randn(*s, dtype=torch.bfloat16) * 0.05)(B, S, D)),
            "wqkv": _w((lambda *s: torch.randn(*s, dtype=torch.bfloat16) * 3.2)(D, 3 * D)),
            "wo": _w((lambda *s: torch.randn(*s, dtype=torch.bfloat16) * 0.1)(D, D)),
        }
    _A_in = _A_setup()

    def _B_setup():
        B, S, D, H = 1, 2048, 1024, 32
        Dh = D // H
        return {
            "x": _w((lambda *s: torch.randn(*s, dtype=torch.bfloat16) * 0.05)(B, S, D)),
            "wqkv": _w((lambda *s: torch.randn(*s, dtype=torch.bfloat16) * 3.2)(D, 3 * D)),
            "w_phi": _w((lambda *s: torch.randn(*s, dtype=torch.bfloat16) * 3.2)(H, Dh, Dh) * (Dh ** -0.5)),
            "wo": _w((lambda *s: torch.randn(*s, dtype=torch.bfloat16) * 1.6)(D, D)),
        }
    _B_in = _B_setup()

    return {
        "A_x": _A_in["x"],
        "A_wqkv": _A_in["wqkv"],
        "A_wo": _A_in["wo"],
        "B_x": _B_in["x"],
        "B_wqkv": _B_in["wqkv"],
        "B_w_phi": _B_in["w_phi"],
        "B_wo": _B_in["wo"],
        "gate_w": _w((lambda *s: torch.randn(*s, dtype=torch.bfloat16) * 0.4)(1024) * 16.0),
    }

def reference(A_x, A_wqkv, A_wo, B_x, B_wqkv, B_w_phi, B_wo, gate_w):
    def _A_ref(x, wqkv, wo):
        B, S, D = x.shape
        H = 32; Dh = D // H
        qkv = (lambda x, *d: x.permute(*d))((x @ wqkv).reshape(B, S, 3, H, Dh), 2, 0, 3, 1, 4)
        q, k, v = qkv[0], qkv[1], qkv[2]
        scale = Dh ** -0.5
        scores = torch.einsum("bhqd,bhkd->bhqk", q, k) * scale
        p = _softmax(scores, axis=-1)
        o = torch.einsum("bhqk,bhkd->bhqd", p, v)
        return (lambda x, *d: x.permute(*d))(o, 0, 2, 1, 3).reshape(B, S, D) @ wo

    def _B_ref(x, wqkv, w_phi, wo):
        B, S, D = x.shape
        H = 32; Dh = D // H
        qkv = (lambda x, *d: x.permute(*d))((x @ wqkv).reshape(B, S, 3, H, Dh), 2, 0, 3, 1, 4)
        q, k, v = qkv[0], qkv[1], qkv[2]
        pq = torch.einsum("bhsd,hdf->bhsf", q, w_phi)
        pk = torch.einsum("bhsd,hdf->bhsf", k, w_phi)
        phi_q = torch.concatenate([_softmax(pq, axis=-1), _softmax(-pq, axis=-1)], axis=-1)
        phi_k = torch.concatenate([_softmax(pk, axis=-1), _softmax(-pk, axis=-1)], axis=-1)
        kv = torch.einsum("bhsf,bhsd->bhfd", phi_k, v)
        z  = torch.einsum("bhsf->bhf", phi_k)
        num = torch.einsum("bhqf,bhfd->bhqd", phi_q, kv)
        den = torch.einsum("bhqf,bhf->bhq", phi_q, z)[..., None] + 1e-6
        o = num / den
        return (lambda x, *d: x.permute(*d))(o, 0, 2, 1, 3).reshape(B, S, D) @ wo

    x = A_x
    g = _sigmoid((x * gate_w).sum(-1, keepdims=True))
    a = _A_ref(x, A_wqkv, A_wo)
    b = _B_ref(x, B_wqkv, B_w_phi, B_wo)
    return g * a + (1 - g) * b
```

```asm
; @launch grid=(256,1,1) block=(512,1,1) lds=163840
.amdgcn_target "amdgcn-amd-amdhsa--gfx950"
.text
.globl gated_mix__softmax_full_mha__linear_kernel_hedgehog__prompt_kernel
.p2align 8
.type gated_mix__softmax_full_mha__linear_kernel_hedgehog__prompt_kernel,@function
gated_mix__softmax_full_mha__linear_kernel_hedgehog__prompt_kernel:
    s_cmp_ge_u32 s2, 256
    s_cbranch_scc1 gated_mix__softmax_full_mha__linear_kernel_hedgehog__prompt_kernel_end
    s_load_dwordx2 s[100:101], s[0:1], 72
    s_getpc_b64 s[90:91]
gated_mix__softmax_full_mha__linear_kernel_hedgehog__prompt_kernel_pc:
    s_sub_u32 s90, s90, gated_mix__softmax_full_mha__linear_kernel_hedgehog__prompt_kernel_pc-gated_mix__softmax_full_mha__linear_kernel_hedgehog__prompt_kernel
    s_subb_u32 s91, s91, 0
    v_lshlrev_b32 v252, 6, v0
    v_min_u32 v255, gated_mix__softmax_full_mha__linear_kernel_hedgehog__prompt_kernel_last-gated_mix__softmax_full_mha__linear_kernel_hedgehog__prompt_kernel-4, v252
    global_load_dword v254, v255, s[90:91]
    v_add_u32 v252, 32768, v252
    v_min_u32 v255, gated_mix__softmax_full_mha__linear_kernel_hedgehog__prompt_kernel_last-gated_mix__softmax_full_mha__linear_kernel_hedgehog__prompt_kernel-4, v252
    global_load_dword v254, v255, s[90:91]
    s_load_dwordx4 s[44:47], s[0:1], 0
    s_load_dwordx2 s[48:49], s[0:1], 32
    s_load_dwordx2 s[52:53], s[0:1], 80
    s_load_dwordx2 s[56:57], s[0:1], 40
    s_load_dwordx2 s[58:59], s[0:1], 56
    s_load_dwordx2 s[32:33], s[0:1], 16
    s_load_dwordx2 s[34:35], s[0:1], 48
    s_and_b32 s3, s2, 7
    s_lshr_b32 s4, s2, 3
    s_and_b32 s5, s3, 1
    s_lshl_b32 s5, s5, 3
    s_and_b32 s6, s4, 7
    s_add_u32 s20, s5, s6
    s_lshr_b32 s5, s3, 1
    s_lshl_b32 s5, s5, 2
    s_lshr_b32 s6, s4, 3
    s_add_u32 s21, s5, s6
    v_lshrrev_b32 v20, 6, v0
    v_and_b32 v19, 63, v0
    v_lshrrev_b32 v21, 3, v19
    v_readfirstlane_b32 s22, v20
    v_and_b32 v22, 7, v19
    v_lshrrev_b32 v23, 4, v19
    s_and_b32 s27, s22, 1
    s_bfe_u32 s28, s22, 0x10001
    s_lshr_b32 s29, s22, 2
    s_xor_b32 s31, s29, 1
    s_and_b32 s7, s22, 3
    s_lshl_b32 s30, s21, 1
    s_add_u32 s30, s30, s28
    s_lshl_b32 s3, s20, 7
    s_lshl_b32 s4, s7, 5
    s_add_u32 s3, s3, s4
    v_add_u32 v24, s3, v21
    v_lshlrev_b32 v24, 11, v24
    v_xor_b32 v25, v22, v23
    v_xor_b32 v26, 4, v25
    v_lshl_add_u32 v25, v25, 4, v24
    v_lshl_add_u32 v26, v26, 4, v24
    v_add_u32 v1, 0, v25
    v_add_u32 v2, 15360, v26
    v_add_u32 v3, 32768, v25
    v_add_u32 v4, 48128, v26
    v_and_b32 v25, 1, v23
    v_lshlrev_b32 v25, 1, v25
    v_xor_b32 v25, v25, v22
    s_mov_b32 s3, 6144
    v_mul_lo_u32 v26, v21, s3
    s_lshl_b32 s4, s21, 7
    v_add_u32 v26, s4, v26
    v_lshl_add_u32 v28, v25, 4, v26
    v_xor_b32 v27, 4, v25
    v_lshl_add_u32 v27, v27, 4, v26
    s_and_b32 s5, s7, 1
    s_cmp_eq_u32 s5, 0
    s_mov_b32 s3, 100352
    s_cselect_b32 s3, 0, s3
    v_add_u32 v5, s3, v28
    s_mov_b32 s3, 148480
    s_cselect_b32 s3, 48128, s3
    v_add_u32 v6, s3, v27
    s_mov_b32 s3, 2048
    s_cselect_b32 s3, 96256, s3
    v_add_u32 v7, s3, v28
    s_mov_b32 s3, 50176
    s_cselect_b32 s3, 144384, s3
    v_add_u32 v8, s3, v27
    s_mov_b32 s3, 102400
    s_cselect_b32 s3, 2048, s3
    v_add_u32 v9, s3, v28
    s_mov_b32 s3, 150528
    s_cselect_b32 s3, 50176, s3
    v_add_u32 v10, s3, v27
    s_lshl_b32 s25, s7, 12
    s_mul_i32 s26, s7, 6144
    s_waitcnt lgkmcnt(0)
    s_mov_b32 s8, s44
    s_and_b32 s9, s45, 0xffff
    s_mov_b32 s10, 4194304
    s_mov_b32 s11, 0x00020000
    s_cmp_lt_u32 s7, 2
    s_cselect_b32 s4, s46, s48
    s_cselect_b32 s5, s47, s49
    s_mov_b32 s12, s4
    s_and_b32 s13, s5, 0xffff
    s_mov_b32 s14, 6291456
    s_mov_b32 s15, 0x00020000
    s_mov_b32 s16, s52
    s_and_b32 s17, s53, 0xffff
    s_mov_b32 s18, 268435456
    s_mov_b32 s19, 0x00020000
    s_cmp_lg_u32 s31, 0
    s_cbranch_scc0 gated_mix__softmax_full_mha__linear_kernel_hedgehog__prompt_kernel_p1_side
    s_add_u32 m0, s25, 0
    s_mov_b32 s23, 0
    buffer_load_dwordx4 v1, s[8:11], s23 offen offset:0 lds
    buffer_load_dwordx4 v2, s[8:11], s23 offen offset:1024 lds
    s_add_u32 m0, s26, 49152
    s_mov_b32 s24, 0
    buffer_load_dwordx4 v5, s[12:15], s24 offen offset:0 lds
    buffer_load_dwordx4 v6, s[12:15], s24 offen offset:1024 lds
    buffer_load_dwordx4 v7, s[12:15], s24 offen offset:2048 lds
    buffer_load_dwordx4 v8, s[12:15], s24 offen offset:3072 lds
    s_add_u32 m0, s26, 53248
    s_nop 0
    buffer_load_dwordx4 v9, s[12:15], s24 offen offset:0 lds
    buffer_load_dwordx4 v10, s[12:15], s24 offen offset:1024 lds
    s_add_u32 m0, s25, 2048
    s_mov_b32 s23, 0
    buffer_load_dwordx4 v3, s[8:11], s23 offen offset:0 lds
    buffer_load_dwordx4 v4, s[8:11], s23 offen offset:1024 lds
    s_add_u32 m0, s26, 73728
    s_mov_b32 s24, 196608
    buffer_load_dwordx4 v5, s[12:15], s24 offen offset:0 lds
    buffer_load_dwordx4 v6, s[12:15], s24 offen offset:1024 lds
    buffer_load_dwordx4 v7, s[12:15], s24 offen offset:2048 lds
    buffer_load_dwordx4 v8, s[12:15], s24 offen offset:3072 lds
    s_add_u32 m0, s26, 77824
    s_nop 0
    buffer_load_dwordx4 v9, s[12:15], s24 offen offset:0 lds
    buffer_load_dwordx4 v10, s[12:15], s24 offen offset:1024 lds
    s_add_u32 m0, s25, 16384
    s_mov_b32 s23, 128
    buffer_load_dwordx4 v1, s[8:11], s23 offen offset:0 lds
    buffer_load_dwordx4 v2, s[8:11], s23 offen offset:1024 lds
    s_add_u32 m0, s26, 98304
    s_mov_b32 s24, 393216
    buffer_load_dwordx4 v5, s[12:15], s24 offen offset:0 lds
    buffer_load_dwordx4 v6, s[12:15], s24 offen offset:1024 lds
    buffer_load_dwordx4 v7, s[12:15], s24 offen offset:2048 lds
    buffer_load_dwordx4 v8, s[12:15], s24 offen offset:3072 lds
    s_add_u32 m0, s26, 102400
    s_nop 0
    buffer_load_dwordx4 v9, s[12:15], s24 offen offset:0 lds
    buffer_load_dwordx4 v10, s[12:15], s24 offen offset:1024 lds
    s_add_u32 m0, s25, 18432
    s_mov_b32 s23, 128
    buffer_load_dwordx4 v3, s[8:11], s23 offen offset:0 lds
    buffer_load_dwordx4 v4, s[8:11], s23 offen offset:1024 lds
    s_and_b32 s7, s22, 3
    s_mul_i32 s3, s2, 3
    s_add_u32 s3, s3, s7
    s_cmp_ge_u32 s3, 384
    s_cselect_b32 s4, 384, 0
    s_cselect_b32 s80, s48, s46
    s_cselect_b32 s81, s49, s47
    s_sub_u32 s3, s3, s4
    s_lshl_b32 s3, s3, 10
    s_lshl_b32 s4, s2, 14
    s_cmp_eq_u32 s7, 3
    s_cselect_b32 s80, s44, s80
    s_cselect_b32 s81, s45, s81
    s_cselect_b32 s76, s4, s3
    s_mov_b32 s5, 393216
    s_cselect_b32 s77, 128, s5
    s_mov_b32 s5, 6291456
    s_cselect_b32 s74, 4194304, s5
    s_mov_b32 s72, s80
    s_and_b32 s73, s81, 0xffff
    s_mov_b32 s75, 0x00020000
    v_lshlrev_b32 v20, 4, v19
    v_lshrrev_b32 v21, 3, v19
    v_lshlrev_b32 v21, 11, v21
    v_and_b32 v22, 7, v19
    v_lshl_add_u32 v21, v22, 4, v21
    s_cmp_eq_u32 s7, 3
    s_cselect_b64 vcc, -1, 0
    v_cndmask_b32 v18, v20, v21, vcc
    s_branch gated_mix__softmax_full_mha__linear_kernel_hedgehog__prompt_kernel_p1_joined
gated_mix__softmax_full_mha__linear_kernel_hedgehog__prompt_kernel_p1_side:
    s_and_b32 s7, s22, 3
    s_and_b32 s7, s22, 3
    s_mul_i32 s3, s2, 3
    s_add_u32 s3, s3, s7
    s_cmp_ge_u32 s3, 384
    s_cselect_b32 s4, 384, 0
    s_cselect_b32 s80, s48, s46
    s_cselect_b32 s81, s49, s47
    s_sub_u32 s3, s3, s4
    s_lshl_b32 s3, s3, 10
    s_lshl_b32 s4, s2, 14
    s_cmp_eq_u32 s7, 3
    s_cselect_b32 s80, s44, s80
    s_cselect_b32 s81, s45, s81
    s_cselect_b32 s76, s4, s3
    s_mov_b32 s5, 393216
    s_cselect_b32 s77, 128, s5
    s_mov_b32 s5, 6291456
    s_cselect_b32 s74, 4194304, s5
    s_mov_b32 s72, s80
    s_and_b32 s73, s81, 0xffff
    s_mov_b32 s75, 0x00020000
    v_lshlrev_b32 v20, 4, v19
    v_lshrrev_b32 v21, 3, v19
    v_lshlrev_b32 v21, 11, v21
    v_and_b32 v22, 7, v19
    v_lshl_add_u32 v21, v22, 4, v21
    s_cmp_eq_u32 s7, 3
    s_cselect_b64 vcc, -1, 0
    v_cndmask_b32 v18, v20, v21, vcc
    s_mov_b32 s60, s56
    s_and_b32 s61, s57, 0xffff
    s_mov_b32 s62, 65536
    s_mov_b32 s63, 0x00020000
    s_mov_b32 s64, s58
    s_and_b32 s65, s59, 0xffff
    s_mov_b32 s66, 2048
    s_mov_b32 s67, 0x00020000
    s_and_b32 s7, s22, 3
    v_lshlrev_b32 v20, 5, v19
    buffer_load_dwordx4 v[32:35], v20, s[64:67], 0 offen
    buffer_load_dwordx4 v[36:39], v20, s[64:67], 0 offen offset:16
    s_lshl_b32 s3, s20, 7
    s_lshl_b32 s4, s21, 3
    s_add_u32 s3, s3, s4
    s_lshl_b32 s4, s7, 1
    s_add_u32 s78, s3, s4
    s_lshl_b32 s3, s78, 11
    buffer_load_dwordx4 v[40:43], v20, s[8:11], s3 offen offset:0
    buffer_load_dwordx4 v[44:47], v20, s[8:11], s3 offen offset:16
    buffer_load_dwordx4 v[48:51], v20, s[8:11], s3 offen offset:2048
    buffer_load_dwordx4 v[52:55], v20, s[8:11], s3 offen offset:2064
    v_lshlrev_b32 v20, 4, v19
    s_lshl_b32 s3, s21, 12
    s_lshl_b32 s5, s7, 10
    s_add_u32 s3, s3, s5
    s_add_u32 m0, s5, 147456
    s_nop 0
    buffer_load_dwordx4 v20, s[60:63], s3 offen lds
    s_cmp_lg_u32 s22, 4
    s_cbranch_scc1 gated_mix__softmax_full_mha__linear_kernel_hedgehog__prompt_kernel_p1_noflag
    s_and_b32 s3, s2, 7
    s_lshr_b32 s4, s2, 3
    s_lshl_b32 s3, s3, 2
    s_lshr_b32 s5, s4, 3
    s_add_u32 s3, s3, s5
    s_and_b32 s4, s4, 7
    s_lshl_b32 s4, s4, 12
    s_lshl_b32 s3, s3, 2
    s_add_u32 s3, s3, s4
    s_add_u32 s3, s3, 24117248
    s_lshl_b32 s4, s21, 7
    s_lshl_b32 s5, s20, 2
    s_add_u32 s4, s4, s5
    s_add_u32 s5, s4, 24150016
    s_add_u32 s4, s4, 24154112
    v_mov_b32 v20, s3
    v_writelane_b32 v20, s5, 1
    v_writelane_b32 v20, s4, 2
    s_add_u32 s3, s3, 128
    v_writelane_b32 v20, s3, 3
    v_mov_b32 v21, 0
    s_mov_b64 exec, 15
    buffer_store_dword v21, v20, s[16:19], 0 offen sc1
    s_mov_b64 exec, -1
gated_mix__softmax_full_mha__linear_kernel_hedgehog__prompt_kernel_p1_noflag:
    buffer_load_dwordx4 v[244:247], v18, s[72:75], s76 offen
    s_add_u32 s76, s76, s77
    buffer_load_dwordx4 v[244:247], v18, s[72:75], s76 offen
    s_add_u32 s76, s76, s77
    buffer_load_dwordx4 v[244:247], v18, s[72:75], s76 offen
    s_add_u32 s76, s76, s77
    buffer_load_dwordx4 v[244:247], v18, s[72:75], s76 offen
    s_add_u32 s76, s76, s77
gated_mix__softmax_full_mha__linear_kernel_hedgehog__prompt_kernel_p1_joined:
    v_mov_b32 v20, 163776
    v_mov_b32 v21, 0
    ds_write_b32 v20, v21
    v_and_b32 v20, 15, v19
    v_lshlrev_b32 v20, 7, v20
    s_lshl_b32 s3, s27, 13
    v_add_u32 v20, s3, v20
    v_lshrrev_b32 v21, 4, v19
    v_bfe_u32 v22, v19, 1, 3
    v_add_u32 v23, 0, v21
    v_xor_b32 v23, v23, v22
    v_lshl_add_u32 v12, v23, 4, v20
    v_add_u32 v23, 4, v21
    v_xor_b32 v23, v23, v22
    v_lshl_add_u32 v13, v23, 4, v20
    v_bfe_u32 v22, v19, 2, 2
    v_lshl_add_u32 v23, v21, 3, v22
    v_lshlrev_b32 v23, 7, v23
    v_and_b32 v24, 1, v19
    v_lshl_add_u32 v23, v24, 3, v23
    v_bfe_u32 v24, v19, 1, 1
    s_lshl_b32 s3, s28, 2
    v_add_u32 v24, s3, v24
    v_and_b32 v25, 2, v22
    v_bfe_u32 v26, v19, 4, 1
    v_lshl_or_b32 v25, v26, 2, v25
    s_mul_i32 s3, s29, 12288
    s_add_u32 s3, s3, 49152
    v_add_u32 v26, 0, v24
    v_xor_b32 v26, v26, v25
    v_lshl_add_u32 v26, v26, 4, v23
    v_add_u32 v14, s3, v26
    v_add_u32 v16, 49152, v14
    v_add_u32 v26, 2, v24
    v_xor_b32 v26, v26, v25
    v_lshl_add_u32 v26, v26, 4, v23
    v_add_u32 v15, s3, v26
    v_add_u32 v17, 49152, v15
    v_mov_b32 v64, 0
    v_mov_b32 v65, 0
    v_mov_b32 v66, 0
    v_mov_b32 v67, 0
    v_mov_b32 v68, 0
    v_mov_b32 v69, 0
    v_mov_b32 v70, 0
    v_mov_b32 v71, 0
    v_mov_b32 v72, 0
    v_mov_b32 v73, 0
    v_mov_b32 v74, 0
    v_mov_b32 v75, 0
    v_mov_b32 v76, 0
    v_mov_b32 v77, 0
    v_mov_b32 v78, 0
    v_mov_b32 v79, 0
    v_mov_b32 v80, 0
    v_mov_b32 v81, 0
    v_mov_b32 v82, 0
    v_mov_b32 v83, 0
    v_mov_b32 v84, 0
    v_mov_b32 v85, 0
    v_mov_b32 v86, 0
    v_mov_b32 v87, 0
    v_mov_b32 v88, 0
    v_mov_b32 v89, 0
    v_mov_b32 v90, 0
    v_mov_b32 v91, 0
    v_mov_b32 v92, 0
    v_mov_b32 v93, 0
    v_mov_b32 v94, 0
    v_mov_b32 v95, 0
    v_mov_b32 v96, 0
    v_mov_b32 v97, 0
    v_mov_b32 v98, 0
    v_mov_b32 v99, 0
    v_mov_b32 v100, 0
    v_mov_b32 v101, 0
    v_mov_b32 v102, 0
    v_mov_b32 v103, 0
    v_mov_b32 v104, 0
    v_mov_b32 v105, 0
    v_mov_b32 v106, 0
    v_mov_b32 v107, 0
    v_mov_b32 v108, 0
    v_mov_b32 v109, 0
    v_mov_b32 v110, 0
    v_mov_b32 v111, 0
    v_mov_b32 v112, 0
    v_mov_b32 v113, 0
    v_mov_b32 v114, 0
    v_mov_b32 v115, 0
    v_mov_b32 v116, 0
    v_mov_b32 v117, 0
    v_mov_b32 v118, 0
    v_mov_b32 v119, 0
    v_mov_b32 v120, 0
    v_mov_b32 v121, 0
    v_mov_b32 v122, 0
    v_mov_b32 v123, 0
    v_mov_b32 v124, 0
    v_mov_b32 v125, 0
    v_mov_b32 v126, 0
    v_mov_b32 v127, 0
    v_mov_b32 v128, 0
    v_mov_b32 v129, 0
    v_mov_b32 v130, 0
    v_mov_b32 v131, 0
    v_mov_b32 v132, 0
    v_mov_b32 v133, 0
    v_mov_b32 v134, 0
    v_mov_b32 v135, 0
    v_mov_b32 v136, 0
    v_mov_b32 v137, 0
    v_mov_b32 v138, 0
    v_mov_b32 v139, 0
    v_mov_b32 v140, 0
    v_mov_b32 v141, 0
    v_mov_b32 v142, 0
    v_mov_b32 v143, 0
    v_mov_b32 v144, 0
    v_mov_b32 v145, 0
    v_mov_b32 v146, 0
    v_mov_b32 v147, 0
    v_mov_b32 v148, 0
    v_mov_b32 v149, 0
    v_mov_b32 v150, 0
    v_mov_b32 v151, 0
    v_mov_b32 v152, 0
    v_mov_b32 v153, 0
    v_mov_b32 v154, 0
    v_mov_b32 v155, 0
    v_mov_b32 v156, 0
    v_mov_b32 v157, 0
    v_mov_b32 v158, 0
    v_mov_b32 v159, 0
    s_cmp_lg_u32 s31, 0
    s_cbranch_scc0 gated_mix__softmax_full_mha__linear_kernel_hedgehog__prompt_kernel_p1_b0_o
    s_waitcnt vmcnt(16)
    s_branch gated_mix__softmax_full_mha__linear_kernel_hedgehog__prompt_kernel_p1_b0_e
gated_mix__softmax_full_mha__linear_kernel_hedgehog__prompt_kernel_p1_b0_o:
    s_waitcnt vmcnt(5)
    v_mov_b32 v24, 0
    v_mov_b32 v25, 0
    v_dot2_f32_bf16 v24, v40, v32, v24
    v_dot2_f32_bf16 v25, v48, v32, v25
    v_dot2_f32_bf16 v24, v41, v33, v24
    v_dot2_f32_bf16 v25, v49, v33, v25
    v_dot2_f32_bf16 v24, v42, v34, v24
    v_dot2_f32_bf16 v25, v50, v34, v25
    v_dot2_f32_bf16 v24, v43, v35, v24
    v_dot2_f32_bf16 v25, v51, v35, v25
    v_dot2_f32_bf16 v24, v44, v36, v24
    v_dot2_f32_bf16 v25, v52, v36, v25
    v_dot2_f32_bf16 v24, v45, v37, v24
    v_dot2_f32_bf16 v25, v53, v37, v25
    v_dot2_f32_bf16 v24, v46, v38, v24
    v_dot2_f32_bf16 v25, v54, v38, v25
    v_dot2_f32_bf16 v24, v47, v39, v24
    v_dot2_f32_bf16 v25, v55, v39, v25
    s_nop 1
    v_add_f32_dpp v24, v24, v24 quad_perm:[1,0,3,2] row_mask:0xf bank_mask:0xf
    v_add_f32_dpp v25, v25, v25 quad_perm:[1,0,3,2] row_mask:0xf bank_mask:0xf
    s_nop 1
    v_add_f32_dpp v24, v24, v24 quad_perm:[2,3,0,1] row_mask:0xf bank_mask:0xf
    v_add_f32_dpp v25, v25, v25 quad_perm:[2,3,0,1] row_mask:0xf bank_mask:0xf
    s_nop 1
    v_add_f32_dpp v24, v24, v24 row_half_mirror row_mask:0xf bank_mask:0xf
    v_add_f32_dpp v25, v25, v25 row_half_mirror row_mask:0xf bank_mask:0xf
    s_nop 1
    v_add_f32_dpp v24, v24, v24 row_mirror row_mask:0xf bank_mask:0xf
    v_add_f32_dpp v25, v25, v25 row_mirror row_mask:0xf bank_mask:0xf
    v_mov_b32 v28, v24
    v_mov_b32 v29, v25
    s_nop 1
    v_permlane16_swap_b32 v24, v28
    v_permlane16_swap_b32 v25, v29
    s_nop 1
    v_add_f32 v24, v24, v28
    v_add_f32 v25, v25, v29
    v_mov_b32 v28, v24
    v_mov_b32 v29, v25
    s_nop 1
    v_permlane32_swap_b32 v24, v28
    v_permlane32_swap_b32 v25, v29
    s_nop 1
    v_add_f32 v24, v24, v28
    v_add_f32 v25, v25, v29
    v_and_b32 v28, 1, v19
    v_cmp_eq_u32 vcc, 1, v28
    s_nop 1
    v_cndmask_b32 v24, v24, v25, vcc
    v_mul_f32 v24, 3216550459, v24
    v_exp_f32 v24, v24
    s_nop 0
    v_add_f32 v24, 1.0, v24
    v_rcp_f32 v24, v24
    v_lshlrev_b32 v28, 2, v19
    s_lshl_b32 s3, s78, 2
    s_add_u32 s3, s3, 23068672
    s_mov_b64 exec, 3
    buffer_store_dword v24, v28, s[16:19], s3 offen sc1
    s_mov_b64 exec, -1
gated_mix__softmax_full_mha__linear_kernel_hedgehog__prompt_kernel_p1_b0_e:
    s_barrier
    ds_read_b128 v[160:163], v12 offset:0
    ds_read_b64_tr_b16 v[176:177], v14 offset:0
    ds_read_b64_tr_b16 v[178:179], v14 offset:512
    ds_read_b64_tr_b16 v[180:181], v15 offset:0
    ds_read_b64_tr_b16 v[182:183], v15 offset:512
    ds_read_b64_tr_b16 v[184:185], v14 offset:4096
    ds_read_b64_tr_b16 v[186:187], v14 offset:4608
    ds_read_b64_tr_b16 v[188:189], v15 offset:4096
    ds_read_b64_tr_b16 v[190:191], v15 offset:4608
    ds_read_b64_tr_b16 v[192:193], v14 offset:8192
    ds_read_b64_tr_b16 v[194:195], v14 offset:8704
    ds_read_b64_tr_b16 v[196:197], v15 offset:8192
    ds_read_b64_tr_b16 v[198:199], v15 offset:8704
    ds_read_b128 v[164:167], v12 offset:2048
    ds_read_b128 v[168:171], v12 offset:4096
    ds_read_b128 v[172:175], v12 offset:6144
    s_cmp_lg_u32 s31, 0
    s_cbranch_scc0 gated_mix__softmax_full_mha__linear_kernel_hedgehog__prompt_kernel_p1_g0_e
    s_add_u32 m0, s26, 122880
    s_mov_b32 s24, 589824
    buffer_load_dwordx4 v5, s[12:15], s24 offen offset:0 lds
    buffer_load_dwordx4 v6, s[12:15], s24 offen offset:1024 lds
    buffer_load_dwordx4 v7, s[12:15], s24 offen offset:2048 lds
    buffer_load_dwordx4 v8, s[12:15], s24 offen offset:3072 lds
    s_add_u32 m0, s26, 126976
    s_nop 0
    buffer_load_dwordx4 v9, s[12:15], s24 offen offset:0 lds
    buffer_load_dwordx4 v10, s[12:15], s24 offen offset:1024 lds
    s_add_u32 m0, s25, 32768
    s_mov_b32 s23, 256
    buffer_load_dwordx4 v1, s[8:11], s23 offen offset:0 lds
    buffer_load_dwordx4 v2, s[8:11], s23 offen offset:1024 lds
gated_mix__softmax_full_mha__linear_kernel_hedgehog__prompt_kernel_p1_g0_e:
    s_waitcnt lgkmcnt(0)
    v_mfma_f32_16x16x32_bf16 v[64:67], v[176:179], v[160:163], v[64:67]
    s_cmp_lg_u32 s31, 0
    s_cbranch_scc0 gated_mix__softmax_full_mha__linear_kernel_hedgehog__prompt_kernel_p1_w0_e
    s_waitcnt vmcnt(16)
gated_mix__softmax_full_mha__linear_kernel_hedgehog__prompt_kernel_p1_w0_e:
    s_barrier
    v_mfma_f32_16x16x32_bf16 v[80:83], v[180:183], v[160:163], v[80:83]
    ds_read_b128 v[200:203], v13 offset:0
    v_mfma_f32_16x16x32_bf16 v[96:99], v[184:187], v[160:163], v[96:99]
    ds_read_b64_tr_b16 v[216:217], v14 offset:24576
    v_mfma_f32_16x16x32_bf16 v[112:115], v[188:191], v[160:163], v[112:115]
    ds_read_b64_tr_b16 v[218:219], v14 offset:25088
    v_mfma_f32_16x16x32_bf16 v[128:131], v[160:163], v[192:195], v[128:131]
    s_cmp_lg_u32 s31, 0
    s_cbranch_scc0 gated_mix__softmax_full_mha__linear_kernel_hedgehog__prompt_kernel_p1_d0_o
    s_add_u32 m0, s26, 49152
    s_mov_b32 s24, 786432
    buffer_load_dwordx4 v5, s[12:15], s24 offen offset:0 lds
    buffer_load_dwordx4 v6, s[12:15], s24 offen offset:1024 lds
    buffer_load_dwordx4 v7, s[12:15], s24 offen offset:2048 lds
    buffer_load_dwordx4 v8, s[12:15], s24 offen offset:3072 lds
    s_add_u32 m0, s26, 53248
    s_nop 0
    buffer_load_dwordx4 v9, s[12:15], s24 offen offset:0 lds
    buffer_load_dwordx4 v10, s[12:15], s24 offen offset:1024 lds
    s_branch gated_mix__softmax_full_mha__linear_kernel_hedgehog__prompt_kernel_p1_d0_e
gated_mix__softmax_full_mha__linear_kernel_hedgehog__prompt_kernel_p1_d0_o:
    buffer_load_dwordx4 v[244:247], v18, s[72:75], s76 offen
    s_add_u32 s76, s76, s77
    buffer_load_dwordx4 v[244:247], v18, s[72:75], s76 offen
    s_add_u32 s76, s76, s77
    buffer_load_dwordx4 v[244:247], v18, s[72:75], s76 offen
    s_add_u32 s76, s76, s77
gated_mix__softmax_full_mha__linear_kernel_hedgehog__prompt_kernel_p1_d0_e:
    v_mfma_f32_16x16x32_bf16 v[144:147], v[160:163], v[196:199], v[144:147]
    ds_read_b64_tr_b16 v[220:221], v15 offset:24576
    v_mfma_f32_16x16x32_bf16 v[68:71], v[176:179], v[164:167], v[68:71]
    ds_read_b64_tr_b16 v[222:223], v15 offset:25088
    v_mfma_f32_16x16x32_bf16 v[84:87], v[180:183], v[164:167], v[84:87]
    ds_read_b64_tr_b16 v[224:225], v14 offset:28672
    v_mfma_f32_16x16x32_bf16 v[100:103], v[184:187], v[164:167], v[100:103]
    v_mfma_f32_16x16x32_bf16 v[116:119], v[188:191], v[164:167], v[116:119]
    ds_read_b64_tr_b16 v[226:227], v14 offset:29184
    v_mfma_f32_16x16x32_bf16 v[132:135], v[164:167], v[192:195], v[132:135]
    ds_read_b64_tr_b16 v[228:229], v15 offset:28672
    v_mfma_f32_16x16x32_bf16 v[148:151], v[164:167], v[196:199], v[148:151]
    v_mfma_f32_16x16x32_bf16 v[72:75], v[176:179], v[168:171], v[72:75]
    ds_read_b64_tr_b16 v[230:231], v15 offset:29184
    v_mfma_f32_16x16x32_bf16 v[88:91], v[180:183], v[168:171], v[88:91]
    ds_read_b64_tr_b16 v[232:233], v14 offset:32768
    v_mfma_f32_16x16x32_bf16 v[104:107], v[184:187], v[168:171], v[104:107]
    ds_read_b64_tr_b16 v[234:235], v14 offset:33280
    s_cmp_lg_u32 s31, 0
    s_cbranch_scc0 gated_mix__softmax_full_mha__linear_kernel_hedgehog__prompt_kernel_p1_e0_e
    s_add_u32 m0, s25, 34816
    s_mov_b32 s23, 256
    buffer_load_dwordx4 v3, s[8:11], s23 offen offset:0 lds
    buffer_load_dwordx4 v4, s[8:11], s23 offen offset:1024 lds
gated_mix__softmax_full_mha__linear_kernel_hedgehog__prompt_kernel_p1_e0_e:
    v_mfma_f32_16x16x32_bf16 v[120:123], v[188:191], v[168:171], v[120:123]
    v_mfma_f32_16x16x32_bf16 v[136:139], v[168:171], v[192:195], v[136:139]
    ds_read_b64_tr_b16 v[236:237], v15 offset:32768
    v_mfma_f32_16x16x32_bf16 v[152:155], v[168:171], v[196:199], v[152:155]
    ds_read_b64_tr_b16 v[238:239], v15 offset:33280
    v_mfma_f32_16x16x32_bf16 v[76:79], v[176:179], v[172:175], v[76:79]
    ds_read_b128 v[204:207], v13 offset:2048
    v_mfma_f32_16x16x32_bf16 v[92:95], v[180:183], v[172:175], v[92:95]
    v_mfma_f32_16x16x32_bf16 v[108:111], v[184:187], v[172:175], v[108:111]
    ds_read_b128 v[208:211], v13 offset:4096
    v_mfma_f32_16x16x32_bf16 v[124:127], v[188:191], v[172:175], v[124:127]
    ds_read_b128 v[212:215], v13 offset:6144
    v_mfma_f32_16x16x32_bf16 v[140:143], v[172:175], v[192:195], v[140:143]
    v_mfma_f32_16x16x32_bf16 v[156:159], v[172:175], v[196:199], v[156:159]
    s_waitcnt lgkmcnt(0)
    v_mfma_f32_16x16x32_bf16 v[64:67], v[216:219], v[200:203], v[64:67]
    s_cmp_lg_u32 s31, 0
    s_cbranch_scc0 gated_mix__softmax_full_mha__linear_kernel_hedgehog__prompt_kernel_p1_w1_e
    s_waitcnt vmcnt(16)
gated_mix__softmax_full_mha__linear_kernel_hedgehog__prompt_kernel_p1_w1_e:
    s_barrier
    v_mfma_f32_16x16x32_bf16 v[80:83], v[220:223], v[200:203], v[80:83]
    ds_read_b128 v[160:163], v12 offset:16384
    v_mfma_f32_16x16x32_bf16 v[96:99], v[224:227], v[200:203], v[96:99]
    ds_read_b64_tr_b16 v[176:177], v16 offset:0
    v_mfma_f32_16x16x32_bf16 v[112:115], v[228:231], v[200:203], v[112:115]
    ds_read_b64_tr_b16 v[178:179], v16 offset:512
    v_mfma_f32_16x16x32_bf16 v[128:131], v[200:203], v[232:235], v[128:131]
    s_cmp_lg_u32 s31, 0
    s_cbranch_scc0 gated_mix__softmax_full_mha__linear_kernel_hedgehog__prompt_kernel_p1_d1_o
    s_add_u32 m0, s26, 73728
    s_mov_b32 s24, 983040
    buffer_load_dwordx4 v5, s[12:15], s24 offen offset:0 lds
    buffer_load_dwordx4 v6, s[12:15], s24 offen offset:1024 lds
    buffer_load_dwordx4 v7, s[12:15], s24 offen offset:2048 lds
    buffer_load_dwordx4 v8, s[12:15], s24 offen offset:3072 lds
    s_add_u32 m0, s26, 77824
    s_nop 0
    buffer_load_dwordx4 v9, s[12:15], s24 offen offset:0 lds
    buffer_load_dwordx4 v10, s[12:15], s24 offen offset:1024 lds
    s_branch gated_mix__softmax_full_mha__linear_kernel_hedgehog__prompt_kernel_p1_d1_e
gated_mix__softmax_full_mha__linear_kernel_hedgehog__prompt_kernel_p1_d1_o:
    buffer_load_dwordx4 v[244:247], v18, s[72:75], s76 offen
    s_add_u32 s76, s76, s77
    buffer_load_dwordx4 v[244:247], v18, s[72:75], s76 offen
    s_add_u32 s76, s76, s77
    buffer_load_dwordx4 v[244:247], v18, s[72:75], s76 offen
    s_add_u32 s76, s76, s77
gated_mix__softmax_full_mha__linear_kernel_hedgehog__prompt_kernel_p1_d1_e:
    v_mfma_f32_16x16x32_bf16 v[144:147], v[200:203], v[236:239], v[144:147]
    ds_read_b64_tr_b16 v[180:181], v17 offset:0
    v_mfma_f32_16x16x32_bf16 v[68:71], v[216:219], v[204:207], v[68:71]
    ds_read_b64_tr_b16 v[182:183], v17 offset:512
    v_mfma_f32_16x16x32_bf16 v[84:87], v[220:223], v[204:207], v[84:87]
    ds_read_b64_tr_b16 v[184:185], v16 offset:4096
    v_mfma_f32_16x16x32_bf16 v[100:103], v[224:227], v[204:207], v[100:103]
    v_mfma_f32_16x16x32_bf16 v[116:119], v[228:231], v[204:207], v[116:119]
    ds_read_b64_tr_b16 v[186:187], v16 offset:4608
    v_mfma_f32_16x16x32_bf16 v[132:135], v[204:207], v[232:235], v[132:135]
    ds_read_b64_tr_b16 v[188:189], v17 offset:4096
    v_mfma_f32_16x16x32_bf16 v[148:151], v[204:207], v[236:239], v[148:151]
    v_mfma_f32_16x16x32_bf16 v[72:75], v[216:219], v[208:211], v[72:75]
    ds_read_b64_tr_b16 v[190:191], v17 offset:4608
    v_mfma_f32_16x16x32_bf16 v[88:91], v[220:223], v[208:211], v[88:91]
    ds_read_b64_tr_b16 v[192:193], v16 offset:8192
    v_mfma_f32_16x16x32_bf16 v[104:107], v[224:227], v[208:211], v[104:107]
    ds_read_b64_tr_b16 v[194:195], v16 offset:8704
    s_cmp_lg_u32 s31, 0
    s_cbranch_scc0 gated_mix__softmax_full_mha__linear_kernel_hedgehog__prompt_kernel_p1_e1_e
    s_add_u32 m0, s25, 0
    s_mov_b32 s23, 384
    buffer_load_dwordx4 v1, s[8:11], s23 offen offset:0 lds
    buffer_load_dwordx4 v2, s[8:11], s23 offen offset:1024 lds
gated_mix__softmax_full_mha__linear_kernel_hedgehog__prompt_kernel_p1_e1_e:
    v_mfma_f32_16x16x32_bf16 v[120:123], v[228:231], v[208:211], v[120:123]
    v_mfma_f32_16x16x32_bf16 v[136:139], v[208:211], v[232:235], v[136:139]
    ds_read_b64_tr_b16 v[196:197], v17 offset:8192
    v_mfma_f32_16x16x32_bf16 v[152:155], v[208:211], v[236:239], v[152:155]
    ds_read_b64_tr_b16 v[198:199], v17 offset:8704
    v_mfma_f32_16x16x32_bf16 v[76:79], v[216:219], v[212:215], v[76:79]
    ds_read_b128 v[164:167], v12 offset:18432
    v_mfma_f32_16x16x32_bf16 v[92:95], v[220:223], v[212:215], v[92:95]
    v_mfma_f32_16x16x32_bf16 v[108:111], v[224:227], v[212:215], v[108:111]
    ds_read_b128 v[168:171], v12 offset:20480
    v_mfma_f32_16x16x32_bf16 v[124:127], v[228:231], v[212:215], v[124:127]
    ds_read_b128 v[172:175], v12 offset:22528
    v_mfma_f32_16x16x32_bf16 v[140:143], v[212:215], v[232:235], v[140:143]
    v_mfma_f32_16x16x32_bf16 v[156:159], v[212:215], v[236:239], v[156:159]
    s_waitcnt lgkmcnt(0)
    v_mfma_f32_16x16x32_bf16 v[64:67], v[176:179], v[160:163], v[64:67]
    s_cmp_lg_u32 s31, 0
    s_cbranch_scc0 gated_mix__softmax_full_mha__linear_kernel_hedgehog__prompt_kernel_p1_w2_e
    s_waitcnt vmcnt(16)
gated_mix__softmax_full_mha__linear_kernel_hedgehog__prompt_kernel_p1_w2_e:
    s_barrier
    v_mfma_f32_16x16x32_bf16 v[80:83], v[180:183], v[160:163], v[80:83]
    ds_read_b128 v[200:203], v13 offset:16384
    v_mfma_f32_16x16x32_bf16 v[96:99], v[184:187], v[160:163], v[96:99]
    ds_read_b64_tr_b16 v[216:217], v16 offset:24576
    v_mfma_f32_16x16x32_bf16 v[112:115], v[188:191], v[160:163], v[112:115]
    ds_read_b64_tr_b16 v[218:219], v16 offset:25088
    v_mfma_f32_16x16x32_bf16 v[128:131], v[160:163], v[192:195], v[128:131]
    s_cmp_lg_u32 s31, 0
    s_cbranch_scc0 gated_mix__softmax_full_mha__linear_kernel_hedgehog__prompt_kernel_p1_d2_o
    s_add_u32 m0, s26, 98304
    s_mov_b32 s24, 1179648
    buffer_load_dwordx4 v5, s[12:15], s24 offen offset:0 lds
    buffer_load_dwordx4 v6, s[12:15], s24 offen offset:1024 lds
    buffer_load_dwordx4 v7, s[12:15], s24 offen offset:2048 lds
    buffer_load_dwordx4 v8, s[12:15], s24 offen offset:3072 lds
    s_add_u32 m0, s26, 102400
    s_nop 0
    buffer_load_dwordx4 v9, s[12:15], s24 offen offset:0 lds
    buffer_load_dwordx4 v10, s[12:15], s24 offen offset:1024 lds
    s_branch gated_mix__softmax_full_mha__linear_kernel_hedgehog__prompt_kernel_p1_d2_e
gated_mix__softmax_full_mha__linear_kernel_hedgehog__prompt_kernel_p1_d2_o:
    buffer_load_dwordx4 v[244:247], v18, s[72:75], s76 offen
    s_add_u32 s76, s76, s77
    buffer_load_dwordx4 v[244:247], v18, s[72:75], s76 offen
    s_add_u32 s76, s76, s77
    buffer_load_dwordx4 v[244:247], v18, s[72:75], s76 offen
    s_add_u32 s76, s76, s77
gated_mix__softmax_full_mha__linear_kernel_hedgehog__prompt_kernel_p1_d2_e:
    v_mfma_f32_16x16x32_bf16 v[144:147], v[160:163], v[196:199], v[144:147]
    ds_read_b64_tr_b16 v[220:221], v17 offset:24576
    v_mfma_f32_16x16x32_bf16 v[68:71], v[176:179], v[164:167], v[68:71]
    ds_read_b64_tr_b16 v[222:223], v17 offset:25088
    v_mfma_f32_16x16x32_bf16 v[84:87], v[180:183], v[164:167], v[84:87]
    ds_read_b64_tr_b16 v[224:225], v16 offset:28672
    v_mfma_f32_16x16x32_bf16 v[100:103], v[184:187], v[164:167], v[100:103]
    v_mfma_f32_16x16x32_bf16 v[116:119], v[188:191], v[164:167], v[116:119]
    ds_read_b64_tr_b16 v[226:227], v16 offset:29184
    v_mfma_f32_16x16x32_bf16 v[132:135], v[164:167], v[192:195], v[132:135]
    ds_read_b64_tr_b16 v[228:229], v17 offset:28672
    v_mfma_f32_16x16x32_bf16 v[148:151], v[164:167], v[196:199], v[148:151]
    v_mfma_f32_16x16x32_bf16 v[72:75], v[176:179], v[168:171], v[72:75]
    ds_read_b64_tr_b16 v[230:231], v17 offset:29184
    v_mfma_f32_16x16x32_bf16 v[88:91], v[180:183], v[168:171], v[88:91]
    ds_read_b64_tr_b16 v[232:233], v16 offset:32768
    v_mfma_f32_16x16x32_bf16 v[104:107], v[184:187], v[168:171], v[104:107]
    ds_read_b64_tr_b16 v[234:235], v16 offset:33280
    s_cmp_lg_u32 s31, 0
    s_cbranch_scc0 gated_mix__softmax_full_mha__linear_kernel_hedgehog__prompt_kernel_p1_e2_e
    s_add_u32 m0, s25, 2048
    s_mov_b32 s23, 384
    buffer_load_dwordx4 v3, s[8:11], s23 offen offset:0 lds
    buffer_load_dwordx4 v4, s[8:11], s23 offen offset:1024 lds
gated_mix__softmax_full_mha__linear_kernel_hedgehog__prompt_kernel_p1_e2_e:
    v_mfma_f32_16x16x32_bf16 v[120:123], v[188:191], v[168:171], v[120:123]
    v_mfma_f32_16x16x32_bf16 v[136:139], v[168:171], v[192:195], v[136:139]
    ds_read_b64_tr_b16 v[236:237], v17 offset:32768
    v_mfma_f32_16x16x32_bf16 v[152:155], v[168:171], v[196:199], v[152:155]
    ds_read_b64_tr_b16 v[238:239], v17 offset:33280
    v_mfma_f32_16x16x32_bf16 v[76:79], v[176:179], v[172:175], v[76:79]
    ds_read_b128 v[204:207], v13 offset:18432
    v_mfma_f32_16x16x32_bf16 v[92:95], v[180:183], v[172:175], v[92:95]
    v_mfma_f32_16x16x32_bf16 v[108:111], v[184:187], v[172:175], v[108:111]
    ds_read_b128 v[208:211], v13 offset:20480
    v_mfma_f32_16x16x32_bf16 v[124:127], v[188:191], v[172:175], v[124:127]
    ds_read_b128 v[212:215], v13 offset:22528
    v_mfma_f32_16x16x32_bf16 v[140:143], v[172:175], v[192:195], v[140:143]
    v_mfma_f32_16x16x32_bf16 v[156:159], v[172:175], v[196:199], v[156:159]
    s_waitcnt lgkmcnt(0)
    v_mfma_f32_16x16x32_bf16 v[64:67], v[216:219], v[200:203], v[64:67]
    s_cmp_lg_u32 s31, 0
    s_cbranch_scc0 gated_mix__softmax_full_mha__linear_kernel_hedgehog__prompt_kernel_p1_w3_e
    s_waitcnt vmcnt(16)
gated_mix__softmax_full_mha__linear_kernel_hedgehog__prompt_kernel_p1_w3_e:
    s_barrier
    v_mfma_f32_16x16x32_bf16 v[80:83], v[220:223], v[200:203], v[80:83]
    ds_read_b128 v[160:163], v12 offset:32768
    v_mfma_f32_16x16x32_bf16 v[96:99], v[224:227], v[200:203], v[96:99]
    ds_read_b64_tr_b16 v[176:177], v14 offset:0
    v_mfma_f32_16x16x32_bf16 v[112:115], v[228:231], v[200:203], v[112:115]
    ds_read_b64_tr_b16 v[178:179], v14 offset:512
    v_mfma_f32_16x16x32_bf16 v[128:131], v[200:203], v[232:235], v[128:131]
    s_cmp_lg_u32 s31, 0
    s_cbranch_scc0 gated_mix__softmax_full_mha__linear_kernel_hedgehog__prompt_kernel_p1_d3_o
    s_add_u32 m0, s26, 122880
    s_mov_b32 s24, 1376256
    buffer_load_dwordx4 v5, s[12:15], s24 offen offset:0 lds
    buffer_load_dwordx4 v6, s[12:15], s24 offen offset:1024 lds
    buffer_load_dwordx4 v7, s[12:15], s24 offen offset:2048 lds
    buffer_load_dwordx4 v8, s[12:15], s24 offen offset:3072 lds
    s_add_u32 m0, s26, 126976
    s_nop 0
    buffer_load_dwordx4 v9, s[12:15], s24 offen offset:0 lds
    buffer_load_dwordx4 v10, s[12:15], s24 offen offset:1024 lds
    s_branch gated_mix__softmax_full_mha__linear_kernel_hedgehog__prompt_kernel_p1_d3_e
gated_mix__softmax_full_mha__linear_kernel_hedgehog__prompt_kernel_p1_d3_o:
    buffer_load_dwordx4 v[244:247], v18, s[72:75], s76 offen
    s_add_u32 s76, s76, s77
    buffer_load_dwordx4 v[244:247], v18, s[72:75], s76 offen
    s_add_u32 s76, s76, s77
    buffer_load_dwordx4 v[244:247], v18, s[72:75], s76 offen
    s_add_u32 s76, s76, s77
gated_mix__softmax_full_mha__linear_kernel_hedgehog__prompt_kernel_p1_d3_e:
    v_mfma_f32_16x16x32_bf16 v[144:147], v[200:203], v[236:239], v[144:147]
    ds_read_b64_tr_b16 v[180:181], v15 offset:0
    v_mfma_f32_16x16x32_bf16 v[68:71], v[216:219], v[204:207], v[68:71]
    ds_read_b64_tr_b16 v[182:183], v15 offset:512
    v_mfma_f32_16x16x32_bf16 v[84:87], v[220:223], v[204:207], v[84:87]
    ds_read_b64_tr_b16 v[184:185], v14 offset:4096
    v_mfma_f32_16x16x32_bf16 v[100:103], v[224:227], v[204:207], v[100:103]
    v_mfma_f32_16x16x32_bf16 v[116:119], v[228:231], v[204:207], v[116:119]
    ds_read_b64_tr_b16 v[186:187], v14 offset:4608
    v_mfma_f32_16x16x32_bf16 v[132:135], v[204:207], v[232:235], v[132:135]
    ds_read_b64_tr_b16 v[188:189], v15 offset:4096
    v_mfma_f32_16x16x32_bf16 v[148:151], v[204:207], v[236:239], v[148:151]
    v_mfma_f32_16x16x32_bf16 v[72:75], v[216:219], v[208:211], v[72:75]
    ds_read_b64_tr_b16 v[190:191], v15 offset:4608
    v_mfma_f32_16x16x32_bf16 v[88:91], v[220:223], v[208:211], v[88:91]
    ds_read_b64_tr_b16 v[192:193], v14 offset:8192
    v_mfma_f32_16x16x32_bf16 v[104:107], v[224:227], v[208:211], v[104:107]
    ds_read_b64_tr_b16 v[194:195], v14 offset:8704
    s_cmp_lg_u32 s31, 0
    s_cbranch_scc0 gated_mix__softmax_full_mha__linear_kernel_hedgehog__prompt_kernel_p1_e3_e
    s_add_u32 m0, s25, 16384
    s_mov_b32 s23, 512
    buffer_load_dwordx4 v1, s[8:11], s23 offen offset:0 lds
    buffer_load_dwordx4 v2, s[8:11], s23 offen offset:1024 lds
gated_mix__softmax_full_mha__linear_kernel_hedgehog__prompt_kernel_p1_e3_e:
    v_mfma_f32_16x16x32_bf16 v[120:123], v[228:231], v[208:211], v[120:123]
    v_mfma_f32_16x16x32_bf16 v[136:139], v[208:211], v[232:235], v[136:139]
    ds_read_b64_tr_b16 v[196:197], v15 offset:8192
    v_mfma_f32_16x16x32_bf16 v[152:155], v[208:211], v[236:239], v[152:155]
    ds_read_b64_tr_b16 v[198:199], v15 offset:8704
    v_mfma_f32_16x16x32_bf16 v[76:79], v[216:219], v[212:215], v[76:79]
    ds_read_b128 v[164:167], v12 offset:34816
    v_mfma_f32_16x16x32_bf16 v[92:95], v[220:223], v[212:215], v[92:95]
    v_mfma_f32_16x16x32_bf16 v[108:111], v[224:227], v[212:215], v[108:111]
    ds_read_b128 v[168:171], v12 offset:36864
    v_mfma_f32_16x16x32_bf16 v[124:127], v[228:231], v[212:215], v[124:127]
    ds_read_b128 v[172:175], v12 offset:38912
    v_mfma_f32_16x16x32_bf16 v[140:143], v[212:215], v[232:235], v[140:143]
    v_mfma_f32_16x16x32_bf16 v[156:159], v[212:215], v[236:239], v[156:159]
    s_waitcnt lgkmcnt(0)
    v_mfma_f32_16x16x32_bf16 v[64:67], v[176:179], v[160:163], v[64:67]
    s_cmp_lg_u32 s31, 0
    s_cbranch_scc0 gated_mix__softmax_full_mha__linear_kernel_hedgehog__prompt_kernel_p1_w4_e
    s_waitcnt vmcnt(16)
gated_mix__softmax_full_mha__linear_kernel_hedgehog__prompt_kernel_p1_w4_e:
    s_barrier
    v_mfma_f32_16x16x32_bf16 v[80:83], v[180:183], v[160:163], v[80:83]
    ds_read_b128 v[200:203], v13 offset:32768
    v_mfma_f32_16x16x32_bf16 v[96:99], v[184:187], v[160:163], v[96:99]
    ds_read_b64_tr_b16 v[216:217], v14 offset:24576
    v_mfma_f32_16x16x32_bf16 v[112:115], v[188:191], v[160:163], v[112:115]
    ds_read_b64_tr_b16 v[218:219], v14 offset:25088
    v_mfma_f32_16x16x32_bf16 v[128:131], v[160:163], v[192:195], v[128:131]
    s_cmp_lg_u32 s31, 0
    s_cbranch_scc0 gated_mix__softmax_full_mha__linear_kernel_hedgehog__prompt_kernel_p1_d4_e
    s_add_u32 m0, s26, 49152
    s_mov_b32 s24, 1572864
    buffer_load_dwordx4 v5, s[12:15], s24 offen offset:0 lds
    buffer_load_dwordx4 v6, s[12:15], s24 offen offset:1024 lds
    buffer_load_dwordx4 v7, s[12:15], s24 offen offset:2048 lds
    buffer_load_dwordx4 v8, s[12:15], s24 offen offset:3072 lds
    s_add_u32 m0, s26, 53248
    s_nop 0
    buffer_load_dwordx4 v9, s[12:15], s24 offen offset:0 lds
    buffer_load_dwordx4 v10, s[12:15], s24 offen offset:1024 lds
gated_mix__softmax_full_mha__linear_kernel_hedgehog__prompt_kernel_p1_d4_e:
    v_mfma_f32_16x16x32_bf16 v[144:147], v[160:163], v[196:199], v[144:147]
    ds_read_b64_tr_b16 v[220:221], v15 offset:24576
    v_mfma_f32_16x16x32_bf16 v[68:71], v[176:179], v[164:167], v[68:71]
    ds_read_b64_tr_b16 v[222:223], v15 offset:25088
    v_mfma_f32_16x16x32_bf16 v[84:87], v[180:183], v[164:167], v[84:87]
    ds_read_b64_tr_b16 v[224:225], v14 offset:28672
    v_mfma_f32_16x16x32_bf16 v[100:103], v[184:187], v[164:167], v[100:103]
    v_mfma_f32_16x16x32_bf16 v[116:119], v[188:191], v[164:167], v[116:119]
    ds_read_b64_tr_b16 v[226:227], v14 offset:29184
    v_mfma_f32_16x16x32_bf16 v[132:135], v[164:167], v[192:195], v[132:135]
    ds_read_b64_tr_b16 v[228:229], v15 offset:28672
    v_mfma_f32_16x16x32_bf16 v[148:151], v[164:167], v[196:199], v[148:151]
    v_mfma_f32_16x16x32_bf16 v[72:75], v[176:179], v[168:171], v[72:75]
    ds_read_b64_tr_b16 v[230:231], v15 offset:29184
    v_mfma_f32_16x16x32_bf16 v[88:91], v[180:183], v[168:171], v[88:91]
    ds_read_b64_tr_b16 v[232:233], v14 offset:32768
    v_mfma_f32_16x16x32_bf16 v[104:107], v[184:187], v[168:171], v[104:107]
    ds_read_b64_tr_b16 v[234:235], v14 offset:33280
    s_cmp_lg_u32 s31, 0
    s_cbranch_scc0 gated_mix__softmax_full_mha__linear_kernel_hedgehog__prompt_kernel_p1_e4_e
    s_add_u32 m0, s25, 18432
    s_mov_b32 s23, 512
    buffer_load_dwordx4 v3, s[8:11], s23 offen offset:0 lds
    buffer_load_dwordx4 v4, s[8:11], s23 offen offset:1024 lds
gated_mix__softmax_full_mha__linear_kernel_hedgehog__prompt_kernel_p1_e4_e:
    v_mfma_f32_16x16x32_bf16 v[120:123], v[188:191], v[168:171], v[120:123]
    v_mfma_f32_16x16x32_bf16 v[136:139], v[168:171], v[192:195], v[136:139]
    ds_read_b64_tr_b16 v[236:237], v15 offset:32768
    v_mfma_f32_16x16x32_bf16 v[152:155], v[168:171], v[196:199], v[152:155]
    ds_read_b64_tr_b16 v[238:239], v15 offset:33280
    v_mfma_f32_16x16x32_bf16 v[76:79], v[176:179], v[172:175], v[76:79]
    ds_read_b128 v[204:207], v13 offset:34816
    v_mfma_f32_16x16x32_bf16 v[92:95], v[180:183], v[172:175], v[92:95]
    v_mfma_f32_16x16x32_bf16 v[108:111], v[184:187], v[172:175], v[108:111]
    ds_read_b128 v[208:211], v13 offset:36864
    v_mfma_f32_16x16x32_bf16 v[124:127], v[188:191], v[172:175], v[124:127]
    ds_read_b128 v[212:215], v13 offset:38912
    v_mfma_f32_16x16x32_bf16 v[140:143], v[172:175], v[192:195], v[140:143]
    v_mfma_f32_16x16x32_bf16 v[156:159], v[172:175], v[196:199], v[156:159]
    s_waitcnt lgkmcnt(0)
    v_mfma_f32_16x16x32_bf16 v[64:67], v[216:219], v[200:203], v[64:67]
    s_cmp_lg_u32 s31, 0
    s_cbranch_scc0 gated_mix__softmax_full_mha__linear_kernel_hedgehog__prompt_kernel_p1_w5_e
    s_waitcnt vmcnt(16)
gated_mix__softmax_full_mha__linear_kernel_hedgehog__prompt_kernel_p1_w5_e:
    s_barrier
    v_mfma_f32_16x16x32_bf16 v[80:83], v[220:223], v[200:203], v[80:83]
    ds_read_b128 v[160:163], v12 offset:0
    v_mfma_f32_16x16x32_bf16 v[96:99], v[224:227], v[200:203], v[96:99]
    ds_read_b64_tr_b16 v[176:177], v16 offset:0
    v_mfma_f32_16x16x32_bf16 v[112:115], v[228:231], v[200:203], v[112:115]
    ds_read_b64_tr_b16 v[178:179], v16 offset:512
    v_mfma_f32_16x16x32_bf16 v[128:131], v[200:203], v[232:235], v[128:131]
    s_cmp_lg_u32 s31, 0
    s_cbranch_scc0 gated_mix__softmax_full_mha__linear_kernel_hedgehog__prompt_kernel_p1_d5_e
    s_add_u32 m0, s26, 73728
    s_mov_b32 s24, 1769472
    buffer_load_dwordx4 v5, s[12:15], s24 offen offset:0 lds
    buffer_load_dwordx4 v6, s[12:15], s24 offen offset:1024 lds
    buffer_load_dwordx4 v7, s[12:15], s24 offen offset:2048 lds
    buffer_load_dwordx4 v8, s[12:15], s24 offen offset:3072 lds
    s_add_u32 m0, s26, 77824
    s_nop 0
    buffer_load_dwordx4 v9, s[12:15], s24 offen offset:0 lds
    buffer_load_dwordx4 v10, s[12:15], s24 offen offset:1024 lds
gated_mix__softmax_full_mha__linear_kernel_hedgehog__prompt_kernel_p1_d5_e:
    v_mfma_f32_16x16x32_bf16 v[144:147], v[200:203], v[236:239], v[144:147]
    ds_read_b64_tr_b16 v[180:181], v17 offset:0
    v_mfma_f32_16x16x32_bf16 v[68:71], v[216:219], v[204:207], v[68:71]
    ds_read_b64_tr_b16 v[182:183], v17 offset:512
    v_mfma_f32_16x16x32_bf16 v[84:87], v[220:223], v[204:207], v[84:87]
    ds_read_b64_tr_b16 v[184:185], v16 offset:4096
    v_mfma_f32_16x16x32_bf16 v[100:103], v[224:227], v[204:207], v[100:103]
    v_mfma_f32_16x16x32_bf16 v[116:119], v[228:231], v[204:207], v[116:119]
    ds_read_b64_tr_b16 v[186:187], v16 offset:4608
    v_mfma_f32_16x16x32_bf16 v[132:135], v[204:207], v[232:235], v[132:135]
    ds_read_b64_tr_b16 v[188:189], v17 offset:4096
    v_mfma_f32_16x16x32_bf16 v[148:151], v[204:207], v[236:239], v[148:151]
    v_mfma_f32_16x16x32_bf16 v[72:75], v[216:219], v[208:211], v[72:75]
    ds_read_b64_tr_b16 v[190:191], v17 offset:4608
    v_mfma_f32_16x16x32_bf16 v[88:91], v[220:223], v[208:211], v[88:91]
    ds_read_b64_tr_b16 v[192:193], v16 offset:8192
    v_mfma_f32_16x16x32_bf16 v[104:107], v[224:227], v[208:211], v[104:107]
    ds_read_b64_tr_b16 v[194:195], v16 offset:8704
    s_cmp_lg_u32 s31, 0
    s_cbranch_scc0 gated_mix__softmax_full_mha__linear_kernel_hedgehog__prompt_kernel_p1_e5_e
    s_add_u32 m0, s25, 32768
    s_mov_b32 s23, 640
    buffer_load_dwordx4 v1, s[8:11], s23 offen offset:0 lds
    buffer_load_dwordx4 v2, s[8:11], s23 offen offset:1024 lds
gated_mix__softmax_full_mha__linear_kernel_hedgehog__prompt_kernel_p1_e5_e:
    v_mfma_f32_16x16x32_bf16 v[120:123], v[228:231], v[208:211], v[120:123]
    v_mfma_f32_16x16x32_bf16 v[136:139], v[208:211], v[232:235], v[136:139]
    ds_read_b64_tr_b16 v[196:197], v17 offset:8192
    v_mfma_f32_16x16x32_bf16 v[152:155], v[208:211], v[236:239], v[152:155]
    ds_read_b64_tr_b16 v[198:199], v17 offset:8704
    v_mfma_f32_16x16x32_bf16 v[76:79], v[216:219], v[212:215], v[76:79]
    ds_read_b128 v[164:167], v12 offset:2048
    v_mfma_f32_16x16x32_bf16 v[92:95], v[220:223], v[212:215], v[92:95]
    v_mfma_f32_16x16x32_bf16 v[108:111], v[224:227], v[212:215], v[108:111]
    ds_read_b128 v[168:171], v12 offset:4096
    v_mfma_f32_16x16x32_bf16 v[124:127], v[228:231], v[212:215], v[124:127]
    ds_read_b128 v[172:175], v12 offset:6144
    v_mfma_f32_16x16x32_bf16 v[140:143], v[212:215], v[232:235], v[140:143]
    v_mfma_f32_16x16x32_bf16 v[156:159], v[212:215], v[236:239], v[156:159]
    s_waitcnt lgkmcnt(0)
    v_mfma_f32_16x16x32_bf16 v[64:67], v[176:179], v[160:163], v[64:67]
    s_cmp_lg_u32 s31, 0
    s_cbranch_scc0 gated_mix__softmax_full_mha__linear_kernel_hedgehog__prompt_kernel_p1_w6_e
    s_waitcnt vmcnt(16)
gated_mix__softmax_full_mha__linear_kernel_hedgehog__prompt_kernel_p1_w6_e:
    s_barrier
    v_mfma_f32_16x16x32_bf16 v[80:83], v[180:183], v[160:163], v[80:83]
    ds_read_b128 v[200:203], v13 offset:0
    v_mfma_f32_16x16x32_bf16 v[96:99], v[184:187], v[160:163], v[96:99]
    ds_read_b64_tr_b16 v[216:217], v16 offset:24576
    v_mfma_f32_16x16x32_bf16 v[112:115], v[188:191], v[160:163], v[112:115]
    ds_read_b64_tr_b16 v[218:219], v16 offset:25088
    v_mfma_f32_16x16x32_bf16 v[128:131], v[160:163], v[192:195], v[128:131]
    s_cmp_lg_u32 s31, 0
    s_cbranch_scc0 gated_mix__softmax_full_mha__linear_kernel_hedgehog__prompt_kernel_p1_d6_e
    s_add_u32 m0, s26, 98304
    s_mov_b32 s24, 1966080
    buffer_load_dwordx4 v5, s[12:15], s24 offen offset:0 lds
    buffer_load_dwordx4 v6, s[12:15], s24 offen offset:1024 lds
    buffer_load_dwordx4 v7, s[12:15], s24 offen offset:2048 lds
    buffer_load_dwordx4 v8, s[12:15], s24 offen offset:3072 lds
    s_add_u32 m0, s26, 102400
    s_nop 0
    buffer_load_dwordx4 v9, s[12:15], s24 offen offset:0 lds
    buffer_load_dwordx4 v10, s[12:15], s24 offen offset:1024 lds
gated_mix__softmax_full_mha__linear_kernel_hedgehog__prompt_kernel_p1_d6_e:
    v_mfma_f32_16x16x32_bf16 v[144:147], v[160:163], v[196:199], v[144:147]
    ds_read_b64_tr_b16 v[220:221], v17 offset:24576
    v_mfma_f32_16x16x32_bf16 v[68:71], v[176:179], v[164:167], v[68:71]
    ds_read_b64_tr_b16 v[222:223], v17 offset:25088
    v_mfma_f32_16x16x32_bf16 v[84:87], v[180:183], v[164:167], v[84:87]
    ds_read_b64_tr_b16 v[224:225], v16 offset:28672
    v_mfma_f32_16x16x32_bf16 v[100:103], v[184:187], v[164:167], v[100:103]
    v_mfma_f32_16x16x32_bf16 v[116:119], v[188:191], v[164:167], v[116:119]
    ds_read_b64_tr_b16 v[226:227], v16 offset:29184
    v_mfma_f32_16x16x32_bf16 v[132:135], v[164:167], v[192:195], v[132:135]
    ds_read_b64_tr_b16 v[228:229], v17 offset:28672
    v_mfma_f32_16x16x32_bf16 v[148:151], v[164:167], v[196:199], v[148:151]
    v_mfma_f32_16x16x32_bf16 v[72:75], v[176:179], v[168:171], v[72:75]
    ds_read_b64_tr_b16 v[230:231], v17 offset:29184
    v_mfma_f32_16x16x32_bf16 v[88:91], v[180:183], v[168:171], v[88:91]
    ds_read_b64_tr_b16 v[232:233], v16 offset:32768
    v_mfma_f32_16x16x32_bf16 v[104:107], v[184:187], v[168:171], v[104:107]
    ds_read_b64_tr_b16 v[234:235], v16 offset:33280
    s_cmp_lg_u32 s31, 0
    s_cbranch_scc0 gated_mix__softmax_full_mha__linear_kernel_hedgehog__prompt_kernel_p1_e6_e
    s_add_u32 m0, s25, 34816
    s_mov_b32 s23, 640
    buffer_load_dwordx4 v3, s[8:11], s23 offen offset:0 lds
    buffer_load_dwordx4 v4, s[8:11], s23 offen offset:1024 lds
gated_mix__softmax_full_mha__linear_kernel_hedgehog__prompt_kernel_p1_e6_e:
    v_mfma_f32_16x16x32_bf16 v[120:123], v[188:191], v[168:171], v[120:123]
    v_mfma_f32_16x16x32_bf16 v[136:139], v[168:171], v[192:195], v[136:139]
    ds_read_b64_tr_b16 v[236:237], v17 offset:32768
    v_mfma_f32_16x16x32_bf16 v[152:155], v[168:171], v[196:199], v[152:155]
    ds_read_b64_tr_b16 v[238:239], v17 offset:33280
    v_mfma_f32_16x16x32_bf16 v[76:79], v[176:179], v[172:175], v[76:79]
    ds_read_b128 v[204:207], v13 offset:2048
    v_mfma_f32_16x16x32_bf16 v[92:95], v[180:183], v[172:175], v[92:95]
    v_mfma_f32_16x16x32_bf16 v[108:111], v[184:187], v[172:175], v[108:111]
    ds_read_b128 v[208:211], v13 offset:4096
    v_mfma_f32_16x16x32_bf16 v[124:127], v[188:191], v[172:175], v[124:127]
    ds_read_b128 v[212:215], v13 offset:6144
    v_mfma_f32_16x16x32_bf16 v[140:143], v[172:175], v[192:195], v[140:143]
    v_mfma_f32_16x16x32_bf16 v[156:159], v[172:175], v[196:199], v[156:159]
    s_waitcnt lgkmcnt(0)
    v_mfma_f32_16x16x32_bf16 v[64:67], v[216:219], v[200:203], v[64:67]
    s_cmp_lg_u32 s31, 0
    s_cbranch_scc0 gated_mix__softmax_full_mha__linear_kernel_hedgehog__prompt_kernel_p1_w7_e
    s_waitcnt vmcnt(16)
gated_mix__softmax_full_mha__linear_kernel_hedgehog__prompt_kernel_p1_w7_e:
    s_barrier
    v_mfma_f32_16x16x32_bf16 v[80:83], v[220:223], v[200:203], v[80:83]
    ds_read_b128 v[160:163], v12 offset:16384
    v_mfma_f32_16x16x32_bf16 v[96:99], v[224:227], v[200:203], v[96:99]
    ds_read_b64_tr_b16 v[176:177], v14 offset:0
    v_mfma_f32_16x16x32_bf16 v[112:115], v[228:231], v[200:203], v[112:115]
    ds_read_b64_tr_b16 v[178:179], v14 offset:512
    v_mfma_f32_16x16x32_bf16 v[128:131], v[200:203], v[232:235], v[128:131]
    s_cmp_lg_u32 s31, 0
    s_cbranch_scc0 gated_mix__softmax_full_mha__linear_kernel_hedgehog__prompt_kernel_p1_d7_e
    s_add_u32 m0, s26, 122880
    s_mov_b32 s24, 2162688
    buffer_load_dwordx4 v5, s[12:15], s24 offen offset:0 lds
    buffer_load_dwordx4 v6, s[12:15], s24 offen offset:1024 lds
    buffer_load_dwordx4 v7, s[12:15], s24 offen offset:2048 lds
    buffer_load_dwordx4 v8, s[12:15], s24 offen offset:3072 lds
    s_add_u32 m0, s26, 126976
    s_nop 0
    buffer_load_dwordx4 v9, s[12:15], s24 offen offset:0 lds
    buffer_load_dwordx4 v10, s[12:15], s24 offen offset:1024 lds
gated_mix__softmax_full_mha__linear_kernel_hedgehog__prompt_kernel_p1_d7_e:
    v_mfma_f32_16x16x32_bf16 v[144:147], v[200:203], v[236:239], v[144:147]
    ds_read_b64_tr_b16 v[180:181], v15 offset:0
    v_mfma_f32_16x16x32_bf16 v[68:71], v[216:219], v[204:207], v[68:71]
    ds_read_b64_tr_b16 v[182:183], v15 offset:512
    v_mfma_f32_16x16x32_bf16 v[84:87], v[220:223], v[204:207], v[84:87]
    ds_read_b64_tr_b16 v[184:185], v14 offset:4096
    v_mfma_f32_16x16x32_bf16 v[100:103], v[224:227], v[204:207], v[100:103]
    v_mfma_f32_16x16x32_bf16 v[116:119], v[228:231], v[204:207], v[116:119]
    ds_read_b64_tr_b16 v[186:187], v14 offset:4608
    v_mfma_f32_16x16x32_bf16 v[132:135], v[204:207], v[232:235], v[132:135]
    ds_read_b64_tr_b16 v[188:189], v15 offset:4096
    v_mfma_f32_16x16x32_bf16 v[148:151], v[204:207], v[236:239], v[148:151]
    v_mfma_f32_16x16x32_bf16 v[72:75], v[216:219], v[208:211], v[72:75]
    ds_read_b64_tr_b16 v[190:191], v15 offset:4608
    v_mfma_f32_16x16x32_bf16 v[88:91], v[220:223], v[208:211], v[88:91]
    ds_read_b64_tr_b16 v[192:193], v14 offset:8192
    v_mfma_f32_16x16x32_bf16 v[104:107], v[224:227], v[208:211], v[104:107]
    ds_read_b64_tr_b16 v[194:195], v14 offset:8704
    s_cmp_lg_u32 s31, 0
    s_cbranch_scc0 gated_mix__softmax_full_mha__linear_kernel_hedgehog__prompt_kernel_p1_e7_e
    s_add_u32 m0, s25, 0
    s_mov_b32 s23, 768
    buffer_load_dwordx4 v1, s[8:11], s23 offen offset:0 lds
    buffer_load_dwordx4 v2, s[8:11], s23 offen offset:1024 lds
gated_mix__softmax_full_mha__linear_kernel_hedgehog__prompt_kernel_p1_e7_e:
    v_mfma_f32_16x16x32_bf16 v[120:123], v[228:231], v[208:211], v[120:123]
    v_mfma_f32_16x16x32_bf16 v[136:139], v[208:211], v[232:235], v[136:139]
    ds_read_b64_tr_b16 v[196:197], v15 offset:8192
    v_mfma_f32_16x16x32_bf16 v[152:155], v[208:211], v[236:239], v[152:155]
    ds_read_b64_tr_b16 v[198:199], v15 offset:8704
    v_mfma_f32_16x16x32_bf16 v[76:79], v[216:219], v[212:215], v[76:79]
    ds_read_b128 v[164:167], v12 offset:18432
    v_mfma_f32_16x16x32_bf16 v[92:95], v[220:223], v[212:215], v[92:95]
    v_mfma_f32_16x16x32_bf16 v[108:111], v[224:227], v[212:215], v[108:111]
    ds_read_b128 v[168:171], v12 offset:20480
    v_mfma_f32_16x16x32_bf16 v[124:127], v[228:231], v[212:215], v[124:127]
    ds_read_b128 v[172:175], v12 offset:22528
    v_mfma_f32_16x16x32_bf16 v[140:143], v[212:215], v[232:235], v[140:143]
    v_mfma_f32_16x16x32_bf16 v[156:159], v[212:215], v[236:239], v[156:159]
    s_waitcnt lgkmcnt(0)
    v_mfma_f32_16x16x32_bf16 v[64:67], v[176:179], v[160:163], v[64:67]
    s_cmp_lg_u32 s31, 0
    s_cbranch_scc0 gated_mix__softmax_full_mha__linear_kernel_hedgehog__prompt_kernel_p1_w8_e
    s_waitcnt vmcnt(16)
gated_mix__softmax_full_mha__linear_kernel_hedgehog__prompt_kernel_p1_w8_e:
    s_barrier
    v_mfma_f32_16x16x32_bf16 v[80:83], v[180:183], v[160:163], v[80:83]
    ds_read_b128 v[200:203], v13 offset:16384
    v_mfma_f32_16x16x32_bf16 v[96:99], v[184:187], v[160:163], v[96:99]
    ds_read_b64_tr_b16 v[216:217], v14 offset:24576
    v_mfma_f32_16x16x32_bf16 v[112:115], v[188:191], v[160:163], v[112:115]
    ds_read_b64_tr_b16 v[218:219], v14 offset:25088
    v_mfma_f32_16x16x32_bf16 v[128:131], v[160:163], v[192:195], v[128:131]
    s_cmp_lg_u32 s31, 0
    s_cbranch_scc0 gated_mix__softmax_full_mha__linear_kernel_hedgehog__prompt_kernel_p1_d8_e
    s_add_u32 m0, s26, 49152
    s_mov_b32 s24, 2359296
    buffer_load_dwordx4 v5, s[12:15], s24 offen offset:0 lds
    buffer_load_dwordx4 v6, s[12:15], s24 offen offset:1024 lds
    buffer_load_dwordx4 v7, s[12:15], s24 offen offset:2048 lds
    buffer_load_dwordx4 v8, s[12:15], s24 offen offset:3072 lds
    s_add_u32 m0, s26, 53248
    s_nop 0
    buffer_load_dwordx4 v9, s[12:15], s24 offen offset:0 lds
    buffer_load_dwordx4 v10, s[12:15], s24 offen offset:1024 lds
gated_mix__softmax_full_mha__linear_kernel_hedgehog__prompt_kernel_p1_d8_e:
    v_mfma_f32_16x16x32_bf16 v[144:147], v[160:163], v[196:199], v[144:147]
    ds_read_b64_tr_b16 v[220:221], v15 offset:24576
    v_mfma_f32_16x16x32_bf16 v[68:71], v[176:179], v[164:167], v[68:71]
    ds_read_b64_tr_b16 v[222:223], v15 offset:25088
    v_mfma_f32_16x16x32_bf16 v[84:87], v[180:183], v[164:167], v[84:87]
    ds_read_b64_tr_b16 v[224:225], v14 offset:28672
    v_mfma_f32_16x16x32_bf16 v[100:103], v[184:187], v[164:167], v[100:103]
    v_mfma_f32_16x16x32_bf16 v[116:119], v[188:191], v[164:167], v[116:119]
    ds_read_b64_tr_b16 v[226:227], v14 offset:29184
    v_mfma_f32_16x16x32_bf16 v[132:135], v[164:167], v[192:195], v[132:135]
    ds_read_b64_tr_b16 v[228:229], v15 offset:28672
    v_mfma_f32_16x16x32_bf16 v[148:151], v[164:167], v[196:199], v[148:151]
    v_mfma_f32_16x16x32_bf16 v[72:75], v[176:179], v[168:171], v[72:75]
    ds_read_b64_tr_b16 v[230:231], v15 offset:29184
    v_mfma_f32_16x16x32_bf16 v[88:91], v[180:183], v[168:171], v[88:91]
    ds_read_b64_tr_b16 v[232:233], v14 offset:32768
    v_mfma_f32_16x16x32_bf16 v[104:107], v[184:187], v[168:171], v[104:107]
    ds_read_b64_tr_b16 v[234:235], v14 offset:33280
    s_cmp_lg_u32 s31, 0
    s_cbranch_scc0 gated_mix__softmax_full_mha__linear_kernel_hedgehog__prompt_kernel_p1_e8_e
    s_add_u32 m0, s25, 2048
    s_mov_b32 s23, 768
    buffer_load_dwordx4 v3, s[8:11], s23 offen offset:0 lds
    buffer_load_dwordx4 v4, s[8:11], s23 offen offset:1024 lds
gated_mix__softmax_full_mha__linear_kernel_hedgehog__prompt_kernel_p1_e8_e:
    v_mfma_f32_16x16x32_bf16 v[120:123], v[188:191], v[168:171], v[120:123]
    v_mfma_f32_16x16x32_bf16 v[136:139], v[168:171], v[192:195], v[136:139]
    ds_read_b64_tr_b16 v[236:237], v15 offset:32768
    v_mfma_f32_16x16x32_bf16 v[152:155], v[168:171], v[196:199], v[152:155]
    ds_read_b64_tr_b16 v[238:239], v15 offset:33280
    v_mfma_f32_16x16x32_bf16 v[76:79], v[176:179], v[172:175], v[76:79]
    ds_read_b128 v[204:207], v13 offset:18432
    v_mfma_f32_16x16x32_bf16 v[92:95], v[180:183], v[172:175], v[92:95]
    v_mfma_f32_16x16x32_bf16 v[108:111], v[184:187], v[172:175], v[108:111]
    ds_read_b128 v[208:211], v13 offset:20480
    v_mfma_f32_16x16x32_bf16 v[124:127], v[188:191], v[172:175], v[124:127]
    ds_read_b128 v[212:215], v13 offset:22528
    v_mfma_f32_16x16x32_bf16 v[140:143], v[172:175], v[192:195], v[140:143]
    v_mfma_f32_16x16x32_bf16 v[156:159], v[172:175], v[196:199], v[156:159]
    s_waitcnt lgkmcnt(0)
    v_mfma_f32_16x16x32_bf16 v[64:67], v[216:219], v[200:203], v[64:67]
    s_cmp_lg_u32 s31, 0
    s_cbranch_scc0 gated_mix__softmax_full_mha__linear_kernel_hedgehog__prompt_kernel_p1_w9_e
    s_waitcnt vmcnt(16)
gated_mix__softmax_full_mha__linear_kernel_hedgehog__prompt_kernel_p1_w9_e:
    s_barrier
    v_mfma_f32_16x16x32_bf16 v[80:83], v[220:223], v[200:203], v[80:83]
    ds_read_b128 v[160:163], v12 offset:32768
    v_mfma_f32_16x16x32_bf16 v[96:99], v[224:227], v[200:203], v[96:99]
    ds_read_b64_tr_b16 v[176:177], v16 offset:0
    v_mfma_f32_16x16x32_bf16 v[112:115], v[228:231], v[200:203], v[112:115]
    ds_read_b64_tr_b16 v[178:179], v16 offset:512
    v_mfma_f32_16x16x32_bf16 v[128:131], v[200:203], v[232:235], v[128:131]
    s_cmp_lg_u32 s31, 0
    s_cbranch_scc0 gated_mix__softmax_full_mha__linear_kernel_hedgehog__prompt_kernel_p1_d9_e
    s_add_u32 m0, s26, 73728
    s_mov_b32 s24, 2555904
    buffer_load_dwordx4 v5, s[12:15], s24 offen offset:0 lds
    buffer_load_dwordx4 v6, s[12:15], s24 offen offset:1024 lds
    buffer_load_dwordx4 v7, s[12:15], s24 offen offset:2048 lds
    buffer_load_dwordx4 v8, s[12:15], s24 offen offset:3072 lds
    s_add_u32 m0, s26, 77824
    s_nop 0
    buffer_load_dwordx4 v9, s[12:15], s24 offen offset:0 lds
    buffer_load_dwordx4 v10, s[12:15], s24 offen offset:1024 lds
gated_mix__softmax_full_mha__linear_kernel_hedgehog__prompt_kernel_p1_d9_e:
    v_mfma_f32_16x16x32_bf16 v[144:147], v[200:203], v[236:239], v[144:147]
    ds_read_b64_tr_b16 v[180:181], v17 offset:0
    v_mfma_f32_16x16x32_bf16 v[68:71], v[216:219], v[204:207], v[68:71]
    ds_read_b64_tr_b16 v[182:183], v17 offset:512
    v_mfma_f32_16x16x32_bf16 v[84:87], v[220:223], v[204:207], v[84:87]
    ds_read_b64_tr_b16 v[184:185], v16 offset:4096
    v_mfma_f32_16x16x32_bf16 v[100:103], v[224:227], v[204:207], v[100:103]
    v_mfma_f32_16x16x32_bf16 v[116:119], v[228:231], v[204:207], v[116:119]
    ds_read_b64_tr_b16 v[186:187], v16 offset:4608
    v_mfma_f32_16x16x32_bf16 v[132:135], v[204:207], v[232:235], v[132:135]
    ds_read_b64_tr_b16 v[188:189], v17 offset:4096
    v_mfma_f32_16x16x32_bf16 v[148:151], v[204:207], v[236:239], v[148:151]
    v_mfma_f32_16x16x32_bf16 v[72:75], v[216:219], v[208:211], v[72:75]
    ds_read_b64_tr_b16 v[190:191], v17 offset:4608
    v_mfma_f32_16x16x32_bf16 v[88:91], v[220:223], v[208:211], v[88:91]
    ds_read_b64_tr_b16 v[192:193], v16 offset:8192
    v_mfma_f32_16x16x32_bf16 v[104:107], v[224:227], v[208:211], v[104:107]
    ds_read_b64_tr_b16 v[194:195], v16 offset:8704
    s_cmp_lg_u32 s31, 0
    s_cbranch_scc0 gated_mix__softmax_full_mha__linear_kernel_hedgehog__prompt_kernel_p1_e9_e
    s_add_u32 m0, s25, 16384
    s_mov_b32 s23, 896
    buffer_load_dwordx4 v1, s[8:11], s23 offen offset:0 lds
    buffer_load_dwordx4 v2, s[8:11], s23 offen offset:1024 lds
gated_mix__softmax_full_mha__linear_kernel_hedgehog__prompt_kernel_p1_e9_e:
    v_mfma_f32_16x16x32_bf16 v[120:123], v[228:231], v[208:211], v[120:123]
    v_mfma_f32_16x16x32_bf16 v[136:139], v[208:211], v[232:235], v[136:139]
    ds_read_b64_tr_b16 v[196:197], v17 offset:8192
    v_mfma_f32_16x16x32_bf16 v[152:155], v[208:211], v[236:239], v[152:155]
    ds_read_b64_tr_b16 v[198:199], v17 offset:8704
    v_mfma_f32_16x16x32_bf16 v[76:79], v[216:219], v[212:215], v[76:79]
    ds_read_b128 v[164:167], v12 offset:34816
    v_mfma_f32_16x16x32_bf16 v[92:95], v[220:223], v[212:215], v[92:95]
    v_mfma_f32_16x16x32_bf16 v[108:111], v[224:227], v[212:215], v[108:111]
    ds_read_b128 v[168:171], v12 offset:36864
    v_mfma_f32_16x16x32_bf16 v[124:127], v[228:231], v[212:215], v[124:127]
    ds_read_b128 v[172:175], v12 offset:38912
    v_mfma_f32_16x16x32_bf16 v[140:143], v[212:215], v[232:235], v[140:143]
    v_mfma_f32_16x16x32_bf16 v[156:159], v[212:215], v[236:239], v[156:159]
    s_waitcnt lgkmcnt(0)
    v_mfma_f32_16x16x32_bf16 v[64:67], v[176:179], v[160:163], v[64:67]
    s_cmp_lg_u32 s31, 0
    s_cbranch_scc0 gated_mix__softmax_full_mha__linear_kernel_hedgehog__prompt_kernel_p1_w10_e
    s_waitcnt vmcnt(16)
gated_mix__softmax_full_mha__linear_kernel_hedgehog__prompt_kernel_p1_w10_e:
    s_barrier
    v_mfma_f32_16x16x32_bf16 v[80:83], v[180:183], v[160:163], v[80:83]
    ds_read_b128 v[200:203], v13 offset:32768
    v_mfma_f32_16x16x32_bf16 v[96:99], v[184:187], v[160:163], v[96:99]
    ds_read_b64_tr_b16 v[216:217], v16 offset:24576
    v_mfma_f32_16x16x32_bf16 v[112:115], v[188:191], v[160:163], v[112:115]
    ds_read_b64_tr_b16 v[218:219], v16 offset:25088
    v_mfma_f32_16x16x32_bf16 v[128:131], v[160:163], v[192:195], v[128:131]
    s_cmp_lg_u32 s31, 0
    s_cbranch_scc0 gated_mix__softmax_full_mha__linear_kernel_hedgehog__prompt_kernel_p1_d10_e
    s_add_u32 m0, s26, 98304
    s_mov_b32 s24, 2752512
    buffer_load_dwordx4 v5, s[12:15], s24 offen offset:0 lds
    buffer_load_dwordx4 v6, s[12:15], s24 offen offset:1024 lds
    buffer_load_dwordx4 v7, s[12:15], s24 offen offset:2048 lds
    buffer_load_dwordx4 v8, s[12:15], s24 offen offset:3072 lds
    s_add_u32 m0, s26, 102400
    s_nop 0
    buffer_load_dwordx4 v9, s[12:15], s24 offen offset:0 lds
    buffer_load_dwordx4 v10, s[12:15], s24 offen offset:1024 lds
gated_mix__softmax_full_mha__linear_kernel_hedgehog__prompt_kernel_p1_d10_e:
    v_mfma_f32_16x16x32_bf16 v[144:147], v[160:163], v[196:199], v[144:147]
    ds_read_b64_tr_b16 v[220:221], v17 offset:24576
    v_mfma_f32_16x16x32_bf16 v[68:71], v[176:179], v[164:167], v[68:71]
    ds_read_b64_tr_b16 v[222:223], v17 offset:25088
    v_mfma_f32_16x16x32_bf16 v[84:87], v[180:183], v[164:167], v[84:87]
    ds_read_b64_tr_b16 v[224:225], v16 offset:28672
    v_mfma_f32_16x16x32_bf16 v[100:103], v[184:187], v[164:167], v[100:103]
    v_mfma_f32_16x16x32_bf16 v[116:119], v[188:191], v[164:167], v[116:119]
    ds_read_b64_tr_b16 v[226:227], v16 offset:29184
    v_mfma_f32_16x16x32_bf16 v[132:135], v[164:167], v[192:195], v[132:135]
    ds_read_b64_tr_b16 v[228:229], v17 offset:28672
    v_mfma_f32_16x16x32_bf16 v[148:151], v[164:167], v[196:199], v[148:151]
    v_mfma_f32_16x16x32_bf16 v[72:75], v[176:179], v[168:171], v[72:75]
    ds_read_b64_tr_b16 v[230:231], v17 offset:29184
    v_mfma_f32_16x16x32_bf16 v[88:91], v[180:183], v[168:171], v[88:91]
    ds_read_b64_tr_b16 v[232:233], v16 offset:32768
    v_mfma_f32_16x16x32_bf16 v[104:107], v[184:187], v[168:171], v[104:107]
    ds_read_b64_tr_b16 v[234:235], v16 offset:33280
    s_cmp_lg_u32 s31, 0
    s_cbranch_scc0 gated_mix__softmax_full_mha__linear_kernel_hedgehog__prompt_kernel_p1_e10_e
    s_add_u32 m0, s25, 18432
    s_mov_b32 s23, 896
    buffer_load_dwordx4 v3, s[8:11], s23 offen offset:0 lds
    buffer_load_dwordx4 v4, s[8:11], s23 offen offset:1024 lds
gated_mix__softmax_full_mha__linear_kernel_hedgehog__prompt_kernel_p1_e10_e:
    v_mfma_f32_16x16x32_bf16 v[120:123], v[188:191], v[168:171], v[120:123]
    v_mfma_f32_16x16x32_bf16 v[136:139], v[168:171], v[192:195], v[136:139]
    ds_read_b64_tr_b16 v[236:237], v17 offset:32768
    v_mfma_f32_16x16x32_bf16 v[152:155], v[168:171], v[196:199], v[152:155]
    ds_read_b64_tr_b16 v[238:239], v17 offset:33280
    v_mfma_f32_16x16x32_bf16 v[76:79], v[176:179], v[172:175], v[76:79]
    ds_read_b128 v[204:207], v13 offset:34816
    v_mfma_f32_16x16x32_bf16 v[92:95], v[180:183], v[172:175], v[92:95]
    v_mfma_f32_16x16x32_bf16 v[108:111], v[184:187], v[172:175], v[108:111]
    ds_read_b128 v[208:211], v13 offset:36864
    v_mfma_f32_16x16x32_bf16 v[124:127], v[188:191], v[172:175], v[124:127]
    ds_read_b128 v[212:215], v13 offset:38912
    v_mfma_f32_16x16x32_bf16 v[140:143], v[172:175], v[192:195], v[140:143]
    v_mfma_f32_16x16x32_bf16 v[156:159], v[172:175], v[196:199], v[156:159]
    s_waitcnt lgkmcnt(0)
    v_mfma_f32_16x16x32_bf16 v[64:67], v[216:219], v[200:203], v[64:67]
    s_cmp_lg_u32 s31, 0
    s_cbranch_scc0 gated_mix__softmax_full_mha__linear_kernel_hedgehog__prompt_kernel_p1_w11_e
    s_waitcnt vmcnt(16)
gated_mix__softmax_full_mha__linear_kernel_hedgehog__prompt_kernel_p1_w11_e:
    s_barrier
    v_mfma_f32_16x16x32_bf16 v[80:83], v[220:223], v[200:203], v[80:83]
    ds_read_b128 v[160:163], v12 offset:0
    v_mfma_f32_16x16x32_bf16 v[96:99], v[224:227], v[200:203], v[96:99]
    ds_read_b64_tr_b16 v[176:177], v14 offset:0
    v_mfma_f32_16x16x32_bf16 v[112:115], v[228:231], v[200:203], v[112:115]
    ds_read_b64_tr_b16 v[178:179], v14 offset:512
    v_mfma_f32_16x16x32_bf16 v[128:131], v[200:203], v[232:235], v[128:131]
    s_cmp_lg_u32 s31, 0
    s_cbranch_scc0 gated_mix__softmax_full_mha__linear_kernel_hedgehog__prompt_kernel_p1_d11_o
    s_add_u32 m0, s26, 122880
    s_mov_b32 s24, 2949120
    buffer_load_dwordx4 v5, s[12:15], s24 offen offset:0 lds
    buffer_load_dwordx4 v6, s[12:15], s24 offen offset:1024 lds
    buffer_load_dwordx4 v7, s[12:15], s24 offen offset:2048 lds
    buffer_load_dwordx4 v8, s[12:15], s24 offen offset:3072 lds
    s_add_u32 m0, s26, 126976
    s_nop 0
    buffer_load_dwordx4 v9, s[12:15], s24 offen offset:0 lds
    buffer_load_dwordx4 v10, s[12:15], s24 offen offset:1024 lds
    s_branch gated_mix__softmax_full_mha__linear_kernel_hedgehog__prompt_kernel_p1_d11_e
gated_mix__softmax_full_mha__linear_kernel_hedgehog__prompt_kernel_p1_d11_o:
    s_waitcnt vmcnt(0)
gated_mix__softmax_full_mha__linear_kernel_hedgehog__prompt_kernel_p1_d11_e:
    v_mfma_f32_16x16x32_bf16 v[144:147], v[200:203], v[236:239], v[144:147]
    ds_read_b64_tr_b16 v[180:181], v15 offset:0
    v_mfma_f32_16x16x32_bf16 v[68:71], v[216:219], v[204:207], v[68:71]
    ds_read_b64_tr_b16 v[182:183], v15 offset:512
    v_mfma_f32_16x16x32_bf16 v[84:87], v[220:223], v[204:207], v[84:87]
    ds_read_b64_tr_b16 v[184:185], v14 offset:4096
    v_mfma_f32_16x16x32_bf16 v[100:103], v[224:227], v[204:207], v[100:103]
    v_mfma_f32_16x16x32_bf16 v[116:119], v[228:231], v[204:207], v[116:119]
    ds_read_b64_tr_b16 v[186:187], v14 offset:4608
    v_mfma_f32_16x16x32_bf16 v[132:135], v[204:207], v[232:235], v[132:135]
    ds_read_b64_tr_b16 v[188:189], v15 offset:4096
    v_mfma_f32_16x16x32_bf16 v[148:151], v[204:207], v[236:239], v[148:151]
    v_mfma_f32_16x16x32_bf16 v[72:75], v[216:219], v[208:211], v[72:75]
    ds_read_b64_tr_b16 v[190:191], v15 offset:4608
    v_mfma_f32_16x16x32_bf16 v[88:91], v[220:223], v[208:211], v[88:91]
    ds_read_b64_tr_b16 v[192:193], v14 offset:8192
    v_mfma_f32_16x16x32_bf16 v[104:107], v[224:227], v[208:211], v[104:107]
    ds_read_b64_tr_b16 v[194:195], v14 offset:8704
    s_cmp_lg_u32 s31, 0
    s_cbranch_scc0 gated_mix__softmax_full_mha__linear_kernel_hedgehog__prompt_kernel_p1_e11_e
    s_add_u32 m0, s25, 32768
    s_mov_b32 s23, 1024
    buffer_load_dwordx4 v1, s[8:11], s23 offen offset:0 lds
    buffer_load_dwordx4 v2, s[8:11], s23 offen offset:1024 lds
gated_mix__softmax_full_mha__linear_kernel_hedgehog__prompt_kernel_p1_e11_e:
    v_mfma_f32_16x16x32_bf16 v[120:123], v[228:231], v[208:211], v[120:123]
    v_mfma_f32_16x16x32_bf16 v[136:139], v[208:211], v[232:235], v[136:139]
    ds_read_b64_tr_b16 v[196:197], v15 offset:8192
    v_mfma_f32_16x16x32_bf16 v[152:155], v[208:211], v[236:239], v[152:155]
    ds_read_b64_tr_b16 v[198:199], v15 offset:8704
    v_mfma_f32_16x16x32_bf16 v[76:79], v[216:219], v[212:215], v[76:79]
    ds_read_b128 v[164:167], v12 offset:2048
    v_mfma_f32_16x16x32_bf16 v[92:95], v[220:223], v[212:215], v[92:95]
    v_mfma_f32_16x16x32_bf16 v[108:111], v[224:227], v[212:215], v[108:111]
    ds_read_b128 v[168:171], v12 offset:4096
    v_mfma_f32_16x16x32_bf16 v[124:127], v[228:231], v[212:215], v[124:127]
    ds_read_b128 v[172:175], v12 offset:6144
    v_mfma_f32_16x16x32_bf16 v[140:143], v[212:215], v[232:235], v[140:143]
    v_mfma_f32_16x16x32_bf16 v[156:159], v[212:215], v[236:239], v[156:159]
    s_waitcnt lgkmcnt(0)
    v_mfma_f32_16x16x32_bf16 v[64:67], v[176:179], v[160:163], v[64:67]
    s_cmp_lg_u32 s31, 0
    s_cbranch_scc0 gated_mix__softmax_full_mha__linear_kernel_hedgehog__prompt_kernel_p1_w12_e
    s_waitcnt vmcnt(16)
gated_mix__softmax_full_mha__linear_kernel_hedgehog__prompt_kernel_p1_w12_e:
    s_barrier
    v_mfma_f32_16x16x32_bf16 v[80:83], v[180:183], v[160:163], v[80:83]
    ds_read_b128 v[200:203], v13 offset:0
    v_mfma_f32_16x16x32_bf16 v[96:99], v[184:187], v[160:163], v[96:99]
    ds_read_b64_tr_b16 v[216:217], v14 offset:24576
    v_mfma_f32_16x16x32_bf16 v[112:115], v[188:191], v[160:163], v[112:115]
    ds_read_b64_tr_b16 v[218:219], v14 offset:25088
    v_mfma_f32_16x16x32_bf16 v[128:131], v[160:163], v[192:195], v[128:131]
    s_cmp_lg_u32 s31, 0
    s_cbranch_scc0 gated_mix__softmax_full_mha__linear_kernel_hedgehog__prompt_kernel_p1_d12_o
    s_add_u32 m0, s26, 49152
    s_mov_b32 s24, 3145728
    buffer_load_dwordx4 v5, s[12:15], s24 offen offset:0 lds
    buffer_load_dwordx4 v6, s[12:15], s24 offen offset:1024 lds
    buffer_load_dwordx4 v7, s[12:15], s24 offen offset:2048 lds
    buffer_load_dwordx4 v8, s[12:15], s24 offen offset:3072 lds
    s_add_u32 m0, s26, 53248
    s_nop 0
    buffer_load_dwordx4 v9, s[12:15], s24 offen offset:0 lds
    buffer_load_dwordx4 v10, s[12:15], s24 offen offset:1024 lds
    s_branch gated_mix__softmax_full_mha__linear_kernel_hedgehog__prompt_kernel_p1_d12_e
gated_mix__softmax_full_mha__linear_kernel_hedgehog__prompt_kernel_p1_d12_o:
    s_cmp_lg_u32 s22, 4
    s_cbranch_scc1 gated_mix__softmax_full_mha__linear_kernel_hedgehog__prompt_kernel_p1_nocnt
    s_waitcnt lgkmcnt(0)
    s_mov_b32 s84, s100
    s_and_b32 s85, s101, 0xffff
    s_mov_b32 s86, 256
    s_mov_b32 s87, 0x00020000
    s_and_b32 s3, s2, 7
    s_lshl_b32 s3, s3, 5
    s_mov_b64 exec, 1
    v_mov_b32 v20, s3
    v_mov_b32 v21, 1
    buffer_atomic_add v21, v20, s[84:87], 0 offen
    s_mov_b64 exec, -1
gated_mix__softmax_full_mha__linear_kernel_hedgehog__prompt_kernel_p1_nocnt:
gated_mix__softmax_full_mha__linear_kernel_hedgehog__prompt_kernel_p1_d12_e:
    v_mfma_f32_16x16x32_bf16 v[144:147], v[160:163], v[196:199], v[144:147]
    ds_read_b64_tr_b16 v[220:221], v15 offset:24576
    v_mfma_f32_16x16x32_bf16 v[68:71], v[176:179], v[164:167], v[68:71]
    ds_read_b64_tr_b16 v[222:223], v15 offset:25088
    v_mfma_f32_16x16x32_bf16 v[84:87], v[180:183], v[164:167], v[84:87]
    ds_read_b64_tr_b16 v[224:225], v14 offset:28672
    v_mfma_f32_16x16x32_bf16 v[100:103], v[184:187], v[164:167], v[100:103]
    v_mfma_f32_16x16x32_bf16 v[116:119], v[188:191], v[164:167], v[116:119]
    ds_read_b64_tr_b16 v[226:227], v14 offset:29184
    v_mfma_f32_16x16x32_bf16 v[132:135], v[164:167], v[192:195], v[132:135]
    ds_read_b64_tr_b16 v[228:229], v15 offset:28672
    v_mfma_f32_16x16x32_bf16 v[148:151], v[164:167], v[196:199], v[148:151]
    v_mfma_f32_16x16x32_bf16 v[72:75], v[176:179], v[168:171], v[72:75]
    ds_read_b64_tr_b16 v[230:231], v15 offset:29184
    v_mfma_f32_16x16x32_bf16 v[88:91], v[180:183], v[168:171], v[88:91]
    ds_read_b64_tr_b16 v[232:233], v14 offset:32768
    v_mfma_f32_16x16x32_bf16 v[104:107], v[184:187], v[168:171], v[104:107]
    ds_read_b64_tr_b16 v[234:235], v14 offset:33280
    s_cmp_lg_u32 s31, 0
    s_cbranch_scc0 gated_mix__softmax_full_mha__linear_kernel_hedgehog__prompt_kernel_p1_e12_e
    s_add_u32 m0, s25, 34816
    s_mov_b32 s23, 1024
    buffer_load_dwordx4 v3, s[8:11], s23 offen offset:0 lds
    buffer_load_dwordx4 v4, s[8:11], s23 offen offset:1024 lds
gated_mix__softmax_full_mha__linear_kernel_hedgehog__prompt_kernel_p1_e12_e:
    v_mfma_f32_16x16x32_bf16 v[120:123], v[188:191], v[168:171], v[120:123]
    v_mfma_f32_16x16x32_bf16 v[136:139], v[168:171], v[192:195], v[136:139]
    ds_read_b64_tr_b16 v[236:237], v15 offset:32768
    v_mfma_f32_16x16x32_bf16 v[152:155], v[168:171], v[196:199], v[152:155]
    ds_read_b64_tr_b16 v[238:239], v15 offset:33280
    v_mfma_f32_16x16x32_bf16 v[76:79], v[176:179], v[172:175], v[76:79]
    ds_read_b128 v[204:207], v13 offset:2048
    v_mfma_f32_16x16x32_bf16 v[92:95], v[180:183], v[172:175], v[92:95]
    v_mfma_f32_16x16x32_bf16 v[108:111], v[184:187], v[172:175], v[108:111]
    ds_read_b128 v[208:211], v13 offset:4096
    v_mfma_f32_16x16x32_bf16 v[124:127], v[188:191], v[172:175], v[124:127]
    ds_read_b128 v[212:215], v13 offset:6144
    v_mfma_f32_16x16x32_bf16 v[140:143], v[172:175], v[192:195], v[140:143]
    v_mfma_f32_16x16x32_bf16 v[156:159], v[172:175], v[196:199], v[156:159]
    s_waitcnt lgkmcnt(0)
    v_mfma_f32_16x16x32_bf16 v[64:67], v[216:219], v[200:203], v[64:67]
    s_cmp_lg_u32 s31, 0
    s_cbranch_scc0 gated_mix__softmax_full_mha__linear_kernel_hedgehog__prompt_kernel_p1_w13_e
    s_waitcnt vmcnt(16)
gated_mix__softmax_full_mha__linear_kernel_hedgehog__prompt_kernel_p1_w13_e:
    s_barrier
    v_mfma_f32_16x16x32_bf16 v[80:83], v[220:223], v[200:203], v[80:83]
    ds_read_b128 v[160:163], v12 offset:16384
    v_mfma_f32_16x16x32_bf16 v[96:99], v[224:227], v[200:203], v[96:99]
    ds_read_b64_tr_b16 v[176:177], v16 offset:0
    v_mfma_f32_16x16x32_bf16 v[112:115], v[228:231], v[200:203], v[112:115]
    ds_read_b64_tr_b16 v[178:179], v16 offset:512
    v_mfma_f32_16x16x32_bf16 v[128:131], v[200:203], v[232:235], v[128:131]
    s_cmp_lg_u32 s31, 0
    s_cbranch_scc0 gated_mix__softmax_full_mha__linear_kernel_hedgehog__prompt_kernel_p1_d13_e
    s_add_u32 m0, s26, 73728
    s_mov_b32 s24, 3342336
    buffer_load_dwordx4 v5, s[12:15], s24 offen offset:0 lds
    buffer_load_dwordx4 v6, s[12:15], s24 offen offset:1024 lds
    buffer_load_dwordx4 v7, s[12:15], s24 offen offset:2048 lds
    buffer_load_dwordx4 v8, s[12:15], s24 offen offset:3072 lds
    s_add_u32 m0, s26, 77824
    s_nop 0
    buffer_load_dwordx4 v9, s[12:15], s24 offen offset:0 lds
    buffer_load_dwordx4 v10, s[12:15], s24 offen offset:1024 lds
gated_mix__softmax_full_mha__linear_kernel_hedgehog__prompt_kernel_p1_d13_e:
    v_mfma_f32_16x16x32_bf16 v[144:147], v[200:203], v[236:239], v[144:147]
    ds_read_b64_tr_b16 v[180:181], v17 offset:0
    v_mfma_f32_16x16x32_bf16 v[68:71], v[216:219], v[204:207], v[68:71]
    ds_read_b64_tr_b16 v[182:183], v17 offset:512
    v_mfma_f32_16x16x32_bf16 v[84:87], v[220:223], v[204:207], v[84:87]
    ds_read_b64_tr_b16 v[184:185], v16 offset:4096
    v_mfma_f32_16x16x32_bf16 v[100:103], v[224:227], v[204:207], v[100:103]
    v_mfma_f32_16x16x32_bf16 v[116:119], v[228:231], v[204:207], v[116:119]
    ds_read_b64_tr_b16 v[186:187], v16 offset:4608
    v_mfma_f32_16x16x32_bf16 v[132:135], v[204:207], v[232:235], v[132:135]
    ds_read_b64_tr_b16 v[188:189], v17 offset:4096
    v_mfma_f32_16x16x32_bf16 v[148:151], v[204:207], v[236:239], v[148:151]
    v_mfma_f32_16x16x32_bf16 v[72:75], v[216:219], v[208:211], v[72:75]
    ds_read_b64_tr_b16 v[190:191], v17 offset:4608
    v_mfma_f32_16x16x32_bf16 v[88:91], v[220:223], v[208:211], v[88:91]
    ds_read_b64_tr_b16 v[192:193], v16 offset:8192
    v_mfma_f32_16x16x32_bf16 v[104:107], v[224:227], v[208:211], v[104:107]
    ds_read_b64_tr_b16 v[194:195], v16 offset:8704
    s_cmp_lg_u32 s31, 0
    s_cbranch_scc0 gated_mix__softmax_full_mha__linear_kernel_hedgehog__prompt_kernel_p1_e13_e
    s_add_u32 m0, s25, 0
    s_mov_b32 s23, 1152
    buffer_load_dwordx4 v1, s[8:11], s23 offen offset:0 lds
    buffer_load_dwordx4 v2, s[8:11], s23 offen offset:1024 lds
gated_mix__softmax_full_mha__linear_kernel_hedgehog__prompt_kernel_p1_e13_e:
    v_mfma_f32_16x16x32_bf16 v[120:123], v[228:231], v[208:211], v[120:123]
    v_mfma_f32_16x16x32_bf16 v[136:139], v[208:211], v[232:235], v[136:139]
    ds_read_b64_tr_b16 v[196:197], v17 offset:8192
    v_mfma_f32_16x16x32_bf16 v[152:155], v[208:211], v[236:239], v[152:155]
    ds_read_b64_tr_b16 v[198:199], v17 offset:8704
    v_mfma_f32_16x16x32_bf16 v[76:79], v[216:219], v[212:215], v[76:79]
    ds_read_b128 v[164:167], v12 offset:18432
    v_mfma_f32_16x16x32_bf16 v[92:95], v[220:223], v[212:215], v[92:95]
    v_mfma_f32_16x16x32_bf16 v[108:111], v[224:227], v[212:215], v[108:111]
    ds_read_b128 v[168:171], v12 offset:20480
    v_mfma_f32_16x16x32_bf16 v[124:127], v[228:231], v[212:215], v[124:127]
    ds_read_b128 v[172:175], v12 offset:22528
    v_mfma_f32_16x16x32_bf16 v[140:143], v[212:215], v[232:235], v[140:143]
    v_mfma_f32_16x16x32_bf16 v[156:159], v[212:215], v[236:239], v[156:159]
    s_waitcnt lgkmcnt(0)
    v_mfma_f32_16x16x32_bf16 v[64:67], v[176:179], v[160:163], v[64:67]
    s_cmp_lg_u32 s31, 0
    s_cbranch_scc0 gated_mix__softmax_full_mha__linear_kernel_hedgehog__prompt_kernel_p1_w14_e
    s_waitcnt vmcnt(16)
gated_mix__softmax_full_mha__linear_kernel_hedgehog__prompt_kernel_p1_w14_e:
    s_barrier
    v_mfma_f32_16x16x32_bf16 v[80:83], v[180:183], v[160:163], v[80:83]
    ds_read_b128 v[200:203], v13 offset:16384
    v_mfma_f32_16x16x32_bf16 v[96:99], v[184:187], v[160:163], v[96:99]
    ds_read_b64_tr_b16 v[216:217], v16 offset:24576
    v_mfma_f32_16x16x32_bf16 v[112:115], v[188:191], v[160:163], v[112:115]
    ds_read_b64_tr_b16 v[218:219], v16 offset:25088
    v_mfma_f32_16x16x32_bf16 v[128:131], v[160:163], v[192:195], v[128:131]
    s_cmp_lg_u32 s31, 0
    s_cbranch_scc0 gated_mix__softmax_full_mha__linear_kernel_hedgehog__prompt_kernel_p1_d14_e
    s_add_u32 m0, s26, 98304
    s_mov_b32 s24, 3538944
    buffer_load_dwordx4 v5, s[12:15], s24 offen offset:0 lds
    buffer_load_dwordx4 v6, s[12:15], s24 offen offset:1024 lds
    buffer_load_dwordx4 v7, s[12:15], s24 offen offset:2048 lds
    buffer_load_dwordx4 v8, s[12:15], s24 offen offset:3072 lds
    s_add_u32 m0, s26, 102400
    s_nop 0
    buffer_load_dwordx4 v9, s[12:15], s24 offen offset:0 lds
    buffer_load_dwordx4 v10, s[12:15], s24 offen offset:1024 lds
gated_mix__softmax_full_mha__linear_kernel_hedgehog__prompt_kernel_p1_d14_e:
    v_mfma_f32_16x16x32_bf16 v[144:147], v[160:163], v[196:199], v[144:147]
    ds_read_b64_tr_b16 v[220:221], v17 offset:24576
    v_mfma_f32_16x16x32_bf16 v[68:71], v[176:179], v[164:167], v[68:71]
    ds_read_b64_tr_b16 v[222:223], v17 offset:25088
    v_mfma_f32_16x16x32_bf16 v[84:87], v[180:183], v[164:167], v[84:87]
    ds_read_b64_tr_b16 v[224:225], v16 offset:28672
    v_mfma_f32_16x16x32_bf16 v[100:103], v[184:187], v[164:167], v[100:103]
    v_mfma_f32_16x16x32_bf16 v[116:119], v[188:191], v[164:167], v[116:119]
    ds_read_b64_tr_b16 v[226:227], v16 offset:29184
    v_mfma_f32_16x16x32_bf16 v[132:135], v[164:167], v[192:195], v[132:135]
    ds_read_b64_tr_b16 v[228:229], v17 offset:28672
    v_mfma_f32_16x16x32_bf16 v[148:151], v[164:167], v[196:199], v[148:151]
    v_mfma_f32_16x16x32_bf16 v[72:75], v[176:179], v[168:171], v[72:75]
    ds_read_b64_tr_b16 v[230:231], v17 offset:29184
    v_mfma_f32_16x16x32_bf16 v[88:91], v[180:183], v[168:171], v[88:91]
    ds_read_b64_tr_b16 v[232:233], v16 offset:32768
    v_mfma_f32_16x16x32_bf16 v[104:107], v[184:187], v[168:171], v[104:107]
    ds_read_b64_tr_b16 v[234:235], v16 offset:33280
    s_cmp_lg_u32 s31, 0
    s_cbranch_scc0 gated_mix__softmax_full_mha__linear_kernel_hedgehog__prompt_kernel_p1_e14_e
    s_add_u32 m0, s25, 2048
    s_mov_b32 s23, 1152
    buffer_load_dwordx4 v3, s[8:11], s23 offen offset:0 lds
    buffer_load_dwordx4 v4, s[8:11], s23 offen offset:1024 lds
gated_mix__softmax_full_mha__linear_kernel_hedgehog__prompt_kernel_p1_e14_e:
    v_mfma_f32_16x16x32_bf16 v[120:123], v[188:191], v[168:171], v[120:123]
    v_mfma_f32_16x16x32_bf16 v[136:139], v[168:171], v[192:195], v[136:139]
    ds_read_b64_tr_b16 v[236:237], v17 offset:32768
    v_mfma_f32_16x16x32_bf16 v[152:155], v[168:171], v[196:199], v[152:155]
    ds_read_b64_tr_b16 v[238:239], v17 offset:33280
    v_mfma_f32_16x16x32_bf16 v[76:79], v[176:179], v[172:175], v[76:79]
    ds_read_b128 v[204:207], v13 offset:18432
    v_mfma_f32_16x16x32_bf16 v[92:95], v[180:183], v[172:175], v[92:95]
    v_mfma_f32_16x16x32_bf16 v[108:111], v[184:187], v[172:175], v[108:111]
    ds_read_b128 v[208:211], v13 offset:20480
    v_mfma_f32_16x16x32_bf16 v[124:127], v[188:191], v[172:175], v[124:127]
    ds_read_b128 v[212:215], v13 offset:22528
    v_mfma_f32_16x16x32_bf16 v[140:143], v[172:175], v[192:195], v[140:143]
    v_mfma_f32_16x16x32_bf16 v[156:159], v[172:175], v[196:199], v[156:159]
    s_waitcnt lgkmcnt(0)
    v_mfma_f32_16x16x32_bf16 v[64:67], v[216:219], v[200:203], v[64:67]
    s_cmp_lg_u32 s31, 0
    s_cbranch_scc0 gated_mix__softmax_full_mha__linear_kernel_hedgehog__prompt_kernel_p1_w15_e
    s_waitcnt vmcnt(16)
gated_mix__softmax_full_mha__linear_kernel_hedgehog__prompt_kernel_p1_w15_e:
    s_barrier
    v_mfma_f32_16x16x32_bf16 v[80:83], v[220:223], v[200:203], v[80:83]
    ds_read_b128 v[160:163], v12 offset:32768
    v_mfma_f32_16x16x32_bf16 v[96:99], v[224:227], v[200:203], v[96:99]
    ds_read_b64_tr_b16 v[176:177], v14 offset:0
    v_mfma_f32_16x16x32_bf16 v[112:115], v[228:231], v[200:203], v[112:115]
    ds_read_b64_tr_b16 v[178:179], v14 offset:512
    v_mfma_f32_16x16x32_bf16 v[128:131], v[200:203], v[232:235], v[128:131]
    s_cmp_lg_u32 s31, 0
    s_cbranch_scc0 gated_mix__softmax_full_mha__linear_kernel_hedgehog__prompt_kernel_p1_d15_e
    s_add_u32 m0, s26, 122880
    s_mov_b32 s24, 3735552
    buffer_load_dwordx4 v5, s[12:15], s24 offen offset:0 lds
    buffer_load_dwordx4 v6, s[12:15], s24 offen offset:1024 lds
    buffer_load_dwordx4 v7, s[12:15], s24 offen offset:2048 lds
    buffer_load_dwordx4 v8, s[12:15], s24 offen offset:3072 lds
    s_add_u32 m0, s26, 126976
    s_nop 0
    buffer_load_dwordx4 v9, s[12:15], s24 offen offset:0 lds
    buffer_load_dwordx4 v10, s[12:15], s24 offen offset:1024 lds
gated_mix__softmax_full_mha__linear_kernel_hedgehog__prompt_kernel_p1_d15_e:
    v_mfma_f32_16x16x32_bf16 v[144:147], v[200:203], v[236:239], v[144:147]
    ds_read_b64_tr_b16 v[180:181], v15 offset:0
    v_mfma_f32_16x16x32_bf16 v[68:71], v[216:219], v[204:207], v[68:71]
    ds_read_b64_tr_b16 v[182:183], v15 offset:512
    v_mfma_f32_16x16x32_bf16 v[84:87], v[220:223], v[204:207], v[84:87]
    ds_read_b64_tr_b16 v[184:185], v14 offset:4096
    v_mfma_f32_16x16x32_bf16 v[100:103], v[224:227], v[204:207], v[100:103]
    v_mfma_f32_16x16x32_bf16 v[116:119], v[228:231], v[204:207], v[116:119]
    ds_read_b64_tr_b16 v[186:187], v14 offset:4608
    v_mfma_f32_16x16x32_bf16 v[132:135], v[204:207], v[232:235], v[132:135]
    ds_read_b64_tr_b16 v[188:189], v15 offset:4096
    v_mfma_f32_16x16x32_bf16 v[148:151], v[204:207], v[236:239], v[148:151]
    v_mfma_f32_16x16x32_bf16 v[72:75], v[216:219], v[208:211], v[72:75]
    ds_read_b64_tr_b16 v[190:191], v15 offset:4608
    v_mfma_f32_16x16x32_bf16 v[88:91], v[220:223], v[208:211], v[88:91]
    ds_read_b64_tr_b16 v[192:193], v14 offset:8192
    v_mfma_f32_16x16x32_bf16 v[104:107], v[224:227], v[208:211], v[104:107]
    ds_read_b64_tr_b16 v[194:195], v14 offset:8704
    s_cmp_lg_u32 s31, 0
    s_cbranch_scc0 gated_mix__softmax_full_mha__linear_kernel_hedgehog__prompt_kernel_p1_e15_e
    s_add_u32 m0, s25, 16384
    s_mov_b32 s23, 1280
    buffer_load_dwordx4 v1, s[8:11], s23 offen offset:0 lds
    buffer_load_dwordx4 v2, s[8:11], s23 offen offset:1024 lds
gated_mix__softmax_full_mha__linear_kernel_hedgehog__prompt_kernel_p1_e15_e:
    v_mfma_f32_16x16x32_bf16 v[120:123], v[228:231], v[208:211], v[120:123]
    v_mfma_f32_16x16x32_bf16 v[136:139], v[208:211], v[232:235], v[136:139]
    ds_read_b64_tr_b16 v[196:197], v15 offset:8192
    v_mfma_f32_16x16x32_bf16 v[152:155], v[208:211], v[236:239], v[152:155]
    ds_read_b64_tr_b16 v[198:199], v15 offset:8704
    v_mfma_f32_16x16x32_bf16 v[76:79], v[216:219], v[212:215], v[76:79]
    ds_read_b128 v[164:167], v12 offset:34816
    v_mfma_f32_16x16x32_bf16 v[92:95], v[220:223], v[212:215], v[92:95]
    v_mfma_f32_16x16x32_bf16 v[108:111], v[224:227], v[212:215], v[108:111]
    ds_read_b128 v[168:171], v12 offset:36864
    v_mfma_f32_16x16x32_bf16 v[124:127], v[228:231], v[212:215], v[124:127]
    ds_read_b128 v[172:175], v12 offset:38912
    v_mfma_f32_16x16x32_bf16 v[140:143], v[212:215], v[232:235], v[140:143]
    v_mfma_f32_16x16x32_bf16 v[156:159], v[212:215], v[236:239], v[156:159]
    s_waitcnt lgkmcnt(0)
    v_mfma_f32_16x16x32_bf16 v[64:67], v[176:179], v[160:163], v[64:67]
    s_cmp_lg_u32 s31, 0
    s_cbranch_scc0 gated_mix__softmax_full_mha__linear_kernel_hedgehog__prompt_kernel_p1_w16_e
    s_waitcnt vmcnt(16)
gated_mix__softmax_full_mha__linear_kernel_hedgehog__prompt_kernel_p1_w16_e:
    s_barrier
    v_mfma_f32_16x16x32_bf16 v[80:83], v[180:183], v[160:163], v[80:83]
    ds_read_b128 v[200:203], v13 offset:32768
    v_mfma_f32_16x16x32_bf16 v[96:99], v[184:187], v[160:163], v[96:99]
    ds_read_b64_tr_b16 v[216:217], v14 offset:24576
    v_mfma_f32_16x16x32_bf16 v[112:115], v[188:191], v[160:163], v[112:115]
    ds_read_b64_tr_b16 v[218:219], v14 offset:25088
    v_mfma_f32_16x16x32_bf16 v[128:131], v[160:163], v[192:195], v[128:131]
    s_cmp_lg_u32 s31, 0
    s_cbranch_scc0 gated_mix__softmax_full_mha__linear_kernel_hedgehog__prompt_kernel_p1_d16_e
    s_add_u32 m0, s26, 49152
    s_mov_b32 s24, 3932160
    buffer_load_dwordx4 v5, s[12:15], s24 offen offset:0 lds
    buffer_load_dwordx4 v6, s[12:15], s24 offen offset:1024 lds
    buffer_load_dwordx4 v7, s[12:15], s24 offen offset:2048 lds
    buffer_load_dwordx4 v8, s[12:15], s24 offen offset:3072 lds
    s_add_u32 m0, s26, 53248
    s_nop 0
    buffer_load_dwordx4 v9, s[12:15], s24 offen offset:0 lds
    buffer_load_dwordx4 v10, s[12:15], s24 offen offset:1024 lds
gated_mix__softmax_full_mha__linear_kernel_hedgehog__prompt_kernel_p1_d16_e:
    v_mfma_f32_16x16x32_bf16 v[144:147], v[160:163], v[196:199], v[144:147]
    ds_read_b64_tr_b16 v[220:221], v15 offset:24576
    v_mfma_f32_16x16x32_bf16 v[68:71], v[176:179], v[164:167], v[68:71]
    ds_read_b64_tr_b16 v[222:223], v15 offset:25088
    v_mfma_f32_16x16x32_bf16 v[84:87], v[180:183], v[164:167], v[84:87]
    ds_read_b64_tr_b16 v[224:225], v14 offset:28672
    v_mfma_f32_16x16x32_bf16 v[100:103], v[184:187], v[164:167], v[100:103]
    v_mfma_f32_16x16x32_bf16 v[116:119], v[188:191], v[164:167], v[116:119]
    ds_read_b64_tr_b16 v[226:227], v14 offset:29184
    v_mfma_f32_16x16x32_bf16 v[132:135], v[164:167], v[192:195], v[132:135]
    ds_read_b64_tr_b16 v[228:229], v15 offset:28672
    v_mfma_f32_16x16x32_bf16 v[148:151], v[164:167], v[196:199], v[148:151]
    v_mfma_f32_16x16x32_bf16 v[72:75], v[176:179], v[168:171], v[72:75]
    ds_read_b64_tr_b16 v[230:231], v15 offset:29184
    v_mfma_f32_16x16x32_bf16 v[88:91], v[180:183], v[168:171], v[88:91]
    ds_read_b64_tr_b16 v[232:233], v14 offset:32768
    v_mfma_f32_16x16x32_bf16 v[104:107], v[184:187], v[168:171], v[104:107]
    ds_read_b64_tr_b16 v[234:235], v14 offset:33280
    s_cmp_lg_u32 s31, 0
    s_cbranch_scc0 gated_mix__softmax_full_mha__linear_kernel_hedgehog__prompt_kernel_p1_e16_e
    s_add_u32 m0, s25, 18432
    s_mov_b32 s23, 1280
    buffer_load_dwordx4 v3, s[8:11], s23 offen offset:0 lds
    buffer_load_dwordx4 v4, s[8:11], s23 offen offset:1024 lds
gated_mix__softmax_full_mha__linear_kernel_hedgehog__prompt_kernel_p1_e16_e:
    v_mfma_f32_16x16x32_bf16 v[120:123], v[188:191], v[168:171], v[120:123]
    v_mfma_f32_16x16x32_bf16 v[136:139], v[168:171], v[192:195], v[136:139]
    ds_read_b64_tr_b16 v[236:237], v15 offset:32768
    v_mfma_f32_16x16x32_bf16 v[152:155], v[168:171], v[196:199], v[152:155]
    ds_read_b64_tr_b16 v[238:239], v15 offset:33280
    v_mfma_f32_16x16x32_bf16 v[76:79], v[176:179], v[172:175], v[76:79]
    ds_read_b128 v[204:207], v13 offset:34816
    v_mfma_f32_16x16x32_bf16 v[92:95], v[180:183], v[172:175], v[92:95]
    v_mfma_f32_16x16x32_bf16 v[108:111], v[184:187], v[172:175], v[108:111]
    ds_read_b128 v[208:211], v13 offset:36864
    v_mfma_f32_16x16x32_bf16 v[124:127], v[188:191], v[172:175], v[124:127]
    ds_read_b128 v[212:215], v13 offset:38912
    v_mfma_f32_16x16x32_bf16 v[140:143], v[172:175], v[192:195], v[140:143]
    v_mfma_f32_16x16x32_bf16 v[156:159], v[172:175], v[196:199], v[156:159]
    s_waitcnt lgkmcnt(0)
    v_mfma_f32_16x16x32_bf16 v[64:67], v[216:219], v[200:203], v[64:67]
    s_cmp_lg_u32 s31, 0
    s_cbranch_scc0 gated_mix__softmax_full_mha__linear_kernel_hedgehog__prompt_kernel_p1_w17_e
    s_waitcnt vmcnt(16)
gated_mix__softmax_full_mha__linear_kernel_hedgehog__prompt_kernel_p1_w17_e:
    s_barrier
    v_mfma_f32_16x16x32_bf16 v[80:83], v[220:223], v[200:203], v[80:83]
    ds_read_b128 v[160:163], v12 offset:0
    v_mfma_f32_16x16x32_bf16 v[96:99], v[224:227], v[200:203], v[96:99]
    ds_read_b64_tr_b16 v[176:177], v16 offset:0
    v_mfma_f32_16x16x32_bf16 v[112:115], v[228:231], v[200:203], v[112:115]
    ds_read_b64_tr_b16 v[178:179], v16 offset:512
    v_mfma_f32_16x16x32_bf16 v[128:131], v[200:203], v[232:235], v[128:131]
    s_cmp_lg_u32 s31, 0
    s_cbranch_scc0 gated_mix__softmax_full_mha__linear_kernel_hedgehog__prompt_kernel_p1_d17_e
    s_add_u32 m0, s26, 73728
    s_mov_b32 s24, 4128768
    buffer_load_dwordx4 v5, s[12:15], s24 offen offset:0 lds
    buffer_load_dwordx4 v6, s[12:15], s24 offen offset:1024 lds
    buffer_load_dwordx4 v7, s[12:15], s24 offen offset:2048 lds
    buffer_load_dwordx4 v8, s[12:15], s24 offen offset:3072 lds
    s_add_u32 m0, s26, 77824
    s_nop 0
    buffer_load_dwordx4 v9, s[12:15], s24 offen offset:0 lds
    buffer_load_dwordx4 v10, s[12:15], s24 offen offset:1024 lds
gated_mix__softmax_full_mha__linear_kernel_hedgehog__prompt_kernel_p1_d17_e:
    v_mfma_f32_16x16x32_bf16 v[144:147], v[200:203], v[236:239], v[144:147]
    ds_read_b64_tr_b16 v[180:181], v17 offset:0
    v_mfma_f32_16x16x32_bf16 v[68:71], v[216:219], v[204:207], v[68:71]
    ds_read_b64_tr_b16 v[182:183], v17 offset:512
    v_mfma_f32_16x16x32_bf16 v[84:87], v[220:223], v[204:207], v[84:87]
    ds_read_b64_tr_b16 v[184:185], v16 offset:4096
    v_mfma_f32_16x16x32_bf16 v[100:103], v[224:227], v[204:207], v[100:103]
    v_mfma_f32_16x16x32_bf16 v[116:119], v[228:231], v[204:207], v[116:119]
    ds_read_b64_tr_b16 v[186:187], v16 offset:4608
    v_mfma_f32_16x16x32_bf16 v[132:135], v[204:207], v[232:235], v[132:135]
    ds_read_b64_tr_b16 v[188:189], v17 offset:4096
    v_mfma_f32_16x16x32_bf16 v[148:151], v[204:207], v[236:239], v[148:151]
    v_mfma_f32_16x16x32_bf16 v[72:75], v[216:219], v[208:211], v[72:75]
    ds_read_b64_tr_b16 v[190:191], v17 offset:4608
    v_mfma_f32_16x16x32_bf16 v[88:91], v[220:223], v[208:211], v[88:91]
    ds_read_b64_tr_b16 v[192:193], v16 offset:8192
    v_mfma_f32_16x16x32_bf16 v[104:107], v[224:227], v[208:211], v[104:107]
    ds_read_b64_tr_b16 v[194:195], v16 offset:8704
    s_cmp_lg_u32 s31, 0
    s_cbranch_scc0 gated_mix__softmax_full_mha__linear_kernel_hedgehog__prompt_kernel_p1_e17_e
    s_add_u32 m0, s25, 32768
    s_mov_b32 s23, 1408
    buffer_load_dwordx4 v1, s[8:11], s23 offen offset:0 lds
    buffer_load_dwordx4 v2, s[8:11], s23 offen offset:1024 lds
gated_mix__softmax_full_mha__linear_kernel_hedgehog__prompt_kernel_p1_e17_e:
    v_mfma_f32_16x16x32_bf16 v[120:123], v[228:231], v[208:211], v[120:123]
    v_mfma_f32_16x16x32_bf16 v[136:139], v[208:211], v[232:235], v[136:139]
    ds_read_b64_tr_b16 v[196:197], v17 offset:8192
    v_mfma_f32_16x16x32_bf16 v[152:155], v[208:211], v[236:239], v[152:155]
    ds_read_b64_tr_b16 v[198:199], v17 offset:8704
    v_mfma_f32_16x16x32_bf16 v[76:79], v[216:219], v[212:215], v[76:79]
    ds_read_b128 v[164:167], v12 offset:2048
    v_mfma_f32_16x16x32_bf16 v[92:95], v[220:223], v[212:215], v[92:95]
    v_mfma_f32_16x16x32_bf16 v[108:111], v[224:227], v[212:215], v[108:111]
    ds_read_b128 v[168:171], v12 offset:4096
    v_mfma_f32_16x16x32_bf16 v[124:127], v[228:231], v[212:215], v[124:127]
    ds_read_b128 v[172:175], v12 offset:6144
    v_mfma_f32_16x16x32_bf16 v[140:143], v[212:215], v[232:235], v[140:143]
    v_mfma_f32_16x16x32_bf16 v[156:159], v[212:215], v[236:239], v[156:159]
    s_waitcnt lgkmcnt(0)
    v_mfma_f32_16x16x32_bf16 v[64:67], v[176:179], v[160:163], v[64:67]
    s_cmp_lg_u32 s31, 0
    s_cbranch_scc0 gated_mix__softmax_full_mha__linear_kernel_hedgehog__prompt_kernel_p1_w18_e
    s_waitcnt vmcnt(16)
gated_mix__softmax_full_mha__linear_kernel_hedgehog__prompt_kernel_p1_w18_e:
    s_barrier
    v_mfma_f32_16x16x32_bf16 v[80:83], v[180:183], v[160:163], v[80:83]
    ds_read_b128 v[200:203], v13 offset:0
    v_mfma_f32_16x16x32_bf16 v[96:99], v[184:187], v[160:163], v[96:99]
    ds_read_b64_tr_b16 v[216:217], v16 offset:24576
    v_mfma_f32_16x16x32_bf16 v[112:115], v[188:191], v[160:163], v[112:115]
    ds_read_b64_tr_b16 v[218:219], v16 offset:25088
    v_mfma_f32_16x16x32_bf16 v[128:131], v[160:163], v[192:195], v[128:131]
    s_cmp_lg_u32 s31, 0
    s_cbranch_scc0 gated_mix__softmax_full_mha__linear_kernel_hedgehog__prompt_kernel_p1_d18_e
    s_add_u32 m0, s26, 98304
    s_mov_b32 s24, 4325376
    buffer_load_dwordx4 v5, s[12:15], s24 offen offset:0 lds
    buffer_load_dwordx4 v6, s[12:15], s24 offen offset:1024 lds
    buffer_load_dwordx4 v7, s[12:15], s24 offen offset:2048 lds
    buffer_load_dwordx4 v8, s[12:15], s24 offen offset:3072 lds
    s_add_u32 m0, s26, 102400
    s_nop 0
    buffer_load_dwordx4 v9, s[12:15], s24 offen offset:0 lds
    buffer_load_dwordx4 v10, s[12:15], s24 offen offset:1024 lds
gated_mix__softmax_full_mha__linear_kernel_hedgehog__prompt_kernel_p1_d18_e:
    v_mfma_f32_16x16x32_bf16 v[144:147], v[160:163], v[196:199], v[144:147]
    ds_read_b64_tr_b16 v[220:221], v17 offset:24576
    v_mfma_f32_16x16x32_bf16 v[68:71], v[176:179], v[164:167], v[68:71]
    ds_read_b64_tr_b16 v[222:223], v17 offset:25088
    v_mfma_f32_16x16x32_bf16 v[84:87], v[180:183], v[164:167], v[84:87]
    ds_read_b64_tr_b16 v[224:225], v16 offset:28672
    v_mfma_f32_16x16x32_bf16 v[100:103], v[184:187], v[164:167], v[100:103]
    v_mfma_f32_16x16x32_bf16 v[116:119], v[188:191], v[164:167], v[116:119]
    ds_read_b64_tr_b16 v[226:227], v16 offset:29184
    v_mfma_f32_16x16x32_bf16 v[132:135], v[164:167], v[192:195], v[132:135]
    ds_read_b64_tr_b16 v[228:229], v17 offset:28672
    v_mfma_f32_16x16x32_bf16 v[148:151], v[164:167], v[196:199], v[148:151]
    v_mfma_f32_16x16x32_bf16 v[72:75], v[176:179], v[168:171], v[72:75]
    ds_read_b64_tr_b16 v[230:231], v17 offset:29184
    v_mfma_f32_16x16x32_bf16 v[88:91], v[180:183], v[168:171], v[88:91]
    ds_read_b64_tr_b16 v[232:233], v16 offset:32768
    v_mfma_f32_16x16x32_bf16 v[104:107], v[184:187], v[168:171], v[104:107]
    ds_read_b64_tr_b16 v[234:235], v16 offset:33280
    s_cmp_lg_u32 s31, 0
    s_cbranch_scc0 gated_mix__softmax_full_mha__linear_kernel_hedgehog__prompt_kernel_p1_e18_e
    s_add_u32 m0, s25, 34816
    s_mov_b32 s23, 1408
    buffer_load_dwordx4 v3, s[8:11], s23 offen offset:0 lds
    buffer_load_dwordx4 v4, s[8:11], s23 offen offset:1024 lds
gated_mix__softmax_full_mha__linear_kernel_hedgehog__prompt_kernel_p1_e18_e:
    v_mfma_f32_16x16x32_bf16 v[120:123], v[188:191], v[168:171], v[120:123]
    v_mfma_f32_16x16x32_bf16 v[136:139], v[168:171], v[192:195], v[136:139]
    ds_read_b64_tr_b16 v[236:237], v17 offset:32768
    v_mfma_f32_16x16x32_bf16 v[152:155], v[168:171], v[196:199], v[152:155]
    ds_read_b64_tr_b16 v[238:239], v17 offset:33280
    v_mfma_f32_16x16x32_bf16 v[76:79], v[176:179], v[172:175], v[76:79]
    ds_read_b128 v[204:207], v13 offset:2048
    v_mfma_f32_16x16x32_bf16 v[92:95], v[180:183], v[172:175], v[92:95]
    v_mfma_f32_16x16x32_bf16 v[108:111], v[184:187], v[172:175], v[108:111]
    ds_read_b128 v[208:211], v13 offset:4096
    v_mfma_f32_16x16x32_bf16 v[124:127], v[188:191], v[172:175], v[124:127]
    ds_read_b128 v[212:215], v13 offset:6144
    v_mfma_f32_16x16x32_bf16 v[140:143], v[172:175], v[192:195], v[140:143]
    v_mfma_f32_16x16x32_bf16 v[156:159], v[172:175], v[196:199], v[156:159]
    s_waitcnt lgkmcnt(0)
    v_mfma_f32_16x16x32_bf16 v[64:67], v[216:219], v[200:203], v[64:67]
    s_cmp_lg_u32 s31, 0
    s_cbranch_scc0 gated_mix__softmax_full_mha__linear_kernel_hedgehog__prompt_kernel_p1_w19_e
    s_waitcnt vmcnt(16)
gated_mix__softmax_full_mha__linear_kernel_hedgehog__prompt_kernel_p1_w19_e:
    s_barrier
    v_mfma_f32_16x16x32_bf16 v[80:83], v[220:223], v[200:203], v[80:83]
    ds_read_b128 v[160:163], v12 offset:16384
    v_mfma_f32_16x16x32_bf16 v[96:99], v[224:227], v[200:203], v[96:99]
    ds_read_b64_tr_b16 v[176:177], v14 offset:0
    v_mfma_f32_16x16x32_bf16 v[112:115], v[228:231], v[200:203], v[112:115]
    ds_read_b64_tr_b16 v[178:179], v14 offset:512
    v_mfma_f32_16x16x32_bf16 v[128:131], v[200:203], v[232:235], v[128:131]
    s_cmp_lg_u32 s31, 0
    s_cbranch_scc0 gated_mix__softmax_full_mha__linear_kernel_hedgehog__prompt_kernel_p1_d19_e
    s_add_u32 m0, s26, 122880
    s_mov_b32 s24, 4521984
    buffer_load_dwordx4 v5, s[12:15], s24 offen offset:0 lds
    buffer_load_dwordx4 v6, s[12:15], s24 offen offset:1024 lds
    buffer_load_dwordx4 v7, s[12:15], s24 offen offset:2048 lds
    buffer_load_dwordx4 v8, s[12:15], s24 offen offset:3072 lds
    s_add_u32 m0, s26, 126976
    s_nop 0
    buffer_load_dwordx4 v9, s[12:15], s24 offen offset:0 lds
    buffer_load_dwordx4 v10, s[12:15], s24 offen offset:1024 lds
gated_mix__softmax_full_mha__linear_kernel_hedgehog__prompt_kernel_p1_d19_e:
    v_mfma_f32_16x16x32_bf16 v[144:147], v[200:203], v[236:239], v[144:147]
    ds_read_b64_tr_b16 v[180:181], v15 offset:0
    v_mfma_f32_16x16x32_bf16 v[68:71], v[216:219], v[204:207], v[68:71]
    ds_read_b64_tr_b16 v[182:183], v15 offset:512
    v_mfma_f32_16x16x32_bf16 v[84:87], v[220:223], v[204:207], v[84:87]
    ds_read_b64_tr_b16 v[184:185], v14 offset:4096
    v_mfma_f32_16x16x32_bf16 v[100:103], v[224:227], v[204:207], v[100:103]
    v_mfma_f32_16x16x32_bf16 v[116:119], v[228:231], v[204:207], v[116:119]
    ds_read_b64_tr_b16 v[186:187], v14 offset:4608
    v_mfma_f32_16x16x32_bf16 v[132:135], v[204:207], v[232:235], v[132:135]
    ds_read_b64_tr_b16 v[188:189], v15 offset:4096
    v_mfma_f32_16x16x32_bf16 v[148:151], v[204:207], v[236:239], v[148:151]
    v_mfma_f32_16x16x32_bf16 v[72:75], v[216:219], v[208:211], v[72:75]
    ds_read_b64_tr_b16 v[190:191], v15 offset:4608
    v_mfma_f32_16x16x32_bf16 v[88:91], v[220:223], v[208:211], v[88:91]
    ds_read_b64_tr_b16 v[192:193], v14 offset:8192
    v_mfma_f32_16x16x32_bf16 v[104:107], v[224:227], v[208:211], v[104:107]
    ds_read_b64_tr_b16 v[194:195], v14 offset:8704
    s_cmp_lg_u32 s31, 0
    s_cbranch_scc0 gated_mix__softmax_full_mha__linear_kernel_hedgehog__prompt_kernel_p1_e19_e
    s_add_u32 m0, s25, 0
    s_mov_b32 s23, 1536
    buffer_load_dwordx4 v1, s[8:11], s23 offen offset:0 lds
    buffer_load_dwordx4 v2, s[8:11], s23 offen offset:1024 lds
gated_mix__softmax_full_mha__linear_kernel_hedgehog__prompt_kernel_p1_e19_e:
    v_mfma_f32_16x16x32_bf16 v[120:123], v[228:231], v[208:211], v[120:123]
    v_mfma_f32_16x16x32_bf16 v[136:139], v[208:211], v[232:235], v[136:139]
    ds_read_b64_tr_b16 v[196:197], v15 offset:8192
    v_mfma_f32_16x16x32_bf16 v[152:155], v[208:211], v[236:239], v[152:155]
    ds_read_b64_tr_b16 v[198:199], v15 offset:8704
    v_mfma_f32_16x16x32_bf16 v[76:79], v[216:219], v[212:215], v[76:79]
    ds_read_b128 v[164:167], v12 offset:18432
    v_mfma_f32_16x16x32_bf16 v[92:95], v[220:223], v[212:215], v[92:95]
    v_mfma_f32_16x16x32_bf16 v[108:111], v[224:227], v[212:215], v[108:111]
    ds_read_b128 v[168:171], v12 offset:20480
    v_mfma_f32_16x16x32_bf16 v[124:127], v[228:231], v[212:215], v[124:127]
    ds_read_b128 v[172:175], v12 offset:22528
    v_mfma_f32_16x16x32_bf16 v[140:143], v[212:215], v[232:235], v[140:143]
    v_mfma_f32_16x16x32_bf16 v[156:159], v[212:215], v[236:239], v[156:159]
    s_waitcnt lgkmcnt(0)
    v_mfma_f32_16x16x32_bf16 v[64:67], v[176:179], v[160:163], v[64:67]
    s_cmp_lg_u32 s31, 0
    s_cbranch_scc0 gated_mix__softmax_full_mha__linear_kernel_hedgehog__prompt_kernel_p1_w20_e
    s_waitcnt vmcnt(16)
gated_mix__softmax_full_mha__linear_kernel_hedgehog__prompt_kernel_p1_w20_e:
    s_barrier
    v_mfma_f32_16x16x32_bf16 v[80:83], v[180:183], v[160:163], v[80:83]
    ds_read_b128 v[200:203], v13 offset:16384
    v_mfma_f32_16x16x32_bf16 v[96:99], v[184:187], v[160:163], v[96:99]
    ds_read_b64_tr_b16 v[216:217], v14 offset:24576
    v_mfma_f32_16x16x32_bf16 v[112:115], v[188:191], v[160:163], v[112:115]
    ds_read_b64_tr_b16 v[218:219], v14 offset:25088
    v_mfma_f32_16x16x32_bf16 v[128:131], v[160:163], v[192:195], v[128:131]
    s_cmp_lg_u32 s31, 0
    s_cbranch_scc0 gated_mix__softmax_full_mha__linear_kernel_hedgehog__prompt_kernel_p1_d20_e
    s_add_u32 m0, s26, 49152
    s_mov_b32 s24, 4718592
    buffer_load_dwordx4 v5, s[12:15], s24 offen offset:0 lds
    buffer_load_dwordx4 v6, s[12:15], s24 offen offset:1024 lds
    buffer_load_dwordx4 v7, s[12:15], s24 offen offset:2048 lds
    buffer_load_dwordx4 v8, s[12:15], s24 offen offset:3072 lds
    s_add_u32 m0, s26, 53248
    s_nop 0
    buffer_load_dwordx4 v9, s[12:15], s24 offen offset:0 lds
    buffer_load_dwordx4 v10, s[12:15], s24 offen offset:1024 lds
gated_mix__softmax_full_mha__linear_kernel_hedgehog__prompt_kernel_p1_d20_e:
    v_mfma_f32_16x16x32_bf16 v[144:147], v[160:163], v[196:199], v[144:147]
    ds_read_b64_tr_b16 v[220:221], v15 offset:24576
    v_mfma_f32_16x16x32_bf16 v[68:71], v[176:179], v[164:167], v[68:71]
    ds_read_b64_tr_b16 v[222:223], v15 offset:25088
    v_mfma_f32_16x16x32_bf16 v[84:87], v[180:183], v[164:167], v[84:87]
    ds_read_b64_tr_b16 v[224:225], v14 offset:28672
    v_mfma_f32_16x16x32_bf16 v[100:103], v[184:187], v[164:167], v[100:103]
    v_mfma_f32_16x16x32_bf16 v[116:119], v[188:191], v[164:167], v[116:119]
    ds_read_b64_tr_b16 v[226:227], v14 offset:29184
    v_mfma_f32_16x16x32_bf16 v[132:135], v[164:167], v[192:195], v[132:135]
    ds_read_b64_tr_b16 v[228:229], v15 offset:28672
    v_mfma_f32_16x16x32_bf16 v[148:151], v[164:167], v[196:199], v[148:151]
    v_mfma_f32_16x16x32_bf16 v[72:75], v[176:179], v[168:171], v[72:75]
    ds_read_b64_tr_b16 v[230:231], v15 offset:29184
    v_mfma_f32_16x16x32_bf16 v[88:91], v[180:183], v[168:171], v[88:91]
    ds_read_b64_tr_b16 v[232:233], v14 offset:32768
    v_mfma_f32_16x16x32_bf16 v[104:107], v[184:187], v[168:171], v[104:107]
    ds_read_b64_tr_b16 v[234:235], v14 offset:33280
    s_cmp_lg_u32 s31, 0
    s_cbranch_scc0 gated_mix__softmax_full_mha__linear_kernel_hedgehog__prompt_kernel_p1_e20_e
    s_add_u32 m0, s25, 2048
    s_mov_b32 s23, 1536
    buffer_load_dwordx4 v3, s[8:11], s23 offen offset:0 lds
    buffer_load_dwordx4 v4, s[8:11], s23 offen offset:1024 lds
gated_mix__softmax_full_mha__linear_kernel_hedgehog__prompt_kernel_p1_e20_e:
    v_mfma_f32_16x16x32_bf16 v[120:123], v[188:191], v[168:171], v[120:123]
    v_mfma_f32_16x16x32_bf16 v[136:139], v[168:171], v[192:195], v[136:139]
    ds_read_b64_tr_b16 v[236:237], v15 offset:32768
    v_mfma_f32_16x16x32_bf16 v[152:155], v[168:171], v[196:199], v[152:155]
    ds_read_b64_tr_b16 v[238:239], v15 offset:33280
    v_mfma_f32_16x16x32_bf16 v[76:79], v[176:179], v[172:175], v[76:79]
    ds_read_b128 v[204:207], v13 offset:18432
    v_mfma_f32_16x16x32_bf16 v[92:95], v[180:183], v[172:175], v[92:95]
    v_mfma_f32_16x16x32_bf16 v[108:111], v[184:187], v[172:175], v[108:111]
    ds_read_b128 v[208:211], v13 offset:20480
    v_mfma_f32_16x16x32_bf16 v[124:127], v[188:191], v[172:175], v[124:127]
    ds_read_b128 v[212:215], v13 offset:22528
    v_mfma_f32_16x16x32_bf16 v[140:143], v[172:175], v[192:195], v[140:143]
    v_mfma_f32_16x16x32_bf16 v[156:159], v[172:175], v[196:199], v[156:159]
    s_waitcnt lgkmcnt(0)
    v_mfma_f32_16x16x32_bf16 v[64:67], v[216:219], v[200:203], v[64:67]
    s_cmp_lg_u32 s31, 0
    s_cbranch_scc0 gated_mix__softmax_full_mha__linear_kernel_hedgehog__prompt_kernel_p1_w21_e
    s_waitcnt vmcnt(16)
gated_mix__softmax_full_mha__linear_kernel_hedgehog__prompt_kernel_p1_w21_e:
    s_barrier
    v_mfma_f32_16x16x32_bf16 v[80:83], v[220:223], v[200:203], v[80:83]
    ds_read_b128 v[160:163], v12 offset:32768
    v_mfma_f32_16x16x32_bf16 v[96:99], v[224:227], v[200:203], v[96:99]
    ds_read_b64_tr_b16 v[176:177], v16 offset:0
    v_mfma_f32_16x16x32_bf16 v[112:115], v[228:231], v[200:203], v[112:115]
    ds_read_b64_tr_b16 v[178:179], v16 offset:512
    v_mfma_f32_16x16x32_bf16 v[128:131], v[200:203], v[232:235], v[128:131]
    s_cmp_lg_u32 s31, 0
    s_cbranch_scc0 gated_mix__softmax_full_mha__linear_kernel_hedgehog__prompt_kernel_p1_d21_e
    s_add_u32 m0, s26, 73728
    s_mov_b32 s24, 4915200
    buffer_load_dwordx4 v5, s[12:15], s24 offen offset:0 lds
    buffer_load_dwordx4 v6, s[12:15], s24 offen offset:1024 lds
    buffer_load_dwordx4 v7, s[12:15], s24 offen offset:2048 lds
    buffer_load_dwordx4 v8, s[12:15], s24 offen offset:3072 lds
    s_add_u32 m0, s26, 77824
    s_nop 0
    buffer_load_dwordx4 v9, s[12:15], s24 offen offset:0 lds
    buffer_load_dwordx4 v10, s[12:15], s24 offen offset:1024 lds
gated_mix__softmax_full_mha__linear_kernel_hedgehog__prompt_kernel_p1_d21_e:
    v_mfma_f32_16x16x32_bf16 v[144:147], v[200:203], v[236:239], v[144:147]
    ds_read_b64_tr_b16 v[180:181], v17 offset:0
    v_mfma_f32_16x16x32_bf16 v[68:71], v[216:219], v[204:207], v[68:71]
    ds_read_b64_tr_b16 v[182:183], v17 offset:512
    v_mfma_f32_16x16x32_bf16 v[84:87], v[220:223], v[204:207], v[84:87]
    ds_read_b64_tr_b16 v[184:185], v16 offset:4096
    v_mfma_f32_16x16x32_bf16 v[100:103], v[224:227], v[204:207], v[100:103]
    v_mfma_f32_16x16x32_bf16 v[116:119], v[228:231], v[204:207], v[116:119]
    ds_read_b64_tr_b16 v[186:187], v16 offset:4608
    v_mfma_f32_16x16x32_bf16 v[132:135], v[204:207], v[232:235], v[132:135]
    ds_read_b64_tr_b16 v[188:189], v17 offset:4096
    v_mfma_f32_16x16x32_bf16 v[148:151], v[204:207], v[236:239], v[148:151]
    v_mfma_f32_16x16x32_bf16 v[72:75], v[216:219], v[208:211], v[72:75]
    ds_read_b64_tr_b16 v[190:191], v17 offset:4608
    v_mfma_f32_16x16x32_bf16 v[88:91], v[220:223], v[208:211], v[88:91]
    ds_read_b64_tr_b16 v[192:193], v16 offset:8192
    v_mfma_f32_16x16x32_bf16 v[104:107], v[224:227], v[208:211], v[104:107]
    ds_read_b64_tr_b16 v[194:195], v16 offset:8704
    s_cmp_lg_u32 s31, 0
    s_cbranch_scc0 gated_mix__softmax_full_mha__linear_kernel_hedgehog__prompt_kernel_p1_e21_e
    s_add_u32 m0, s25, 16384
    s_mov_b32 s23, 1664
    buffer_load_dwordx4 v1, s[8:11], s23 offen offset:0 lds
    buffer_load_dwordx4 v2, s[8:11], s23 offen offset:1024 lds
gated_mix__softmax_full_mha__linear_kernel_hedgehog__prompt_kernel_p1_e21_e:
    v_mfma_f32_16x16x32_bf16 v[120:123], v[228:231], v[208:211], v[120:123]
    v_mfma_f32_16x16x32_bf16 v[136:139], v[208:211], v[232:235], v[136:139]
    ds_read_b64_tr_b16 v[196:197], v17 offset:8192
    v_mfma_f32_16x16x32_bf16 v[152:155], v[208:211], v[236:239], v[152:155]
    ds_read_b64_tr_b16 v[198:199], v17 offset:8704
    v_mfma_f32_16x16x32_bf16 v[76:79], v[216:219], v[212:215], v[76:79]
    ds_read_b128 v[164:167], v12 offset:34816
    v_mfma_f32_16x16x32_bf16 v[92:95], v[220:223], v[212:215], v[92:95]
    v_mfma_f32_16x16x32_bf16 v[108:111], v[224:227], v[212:215], v[108:111]
    ds_read_b128 v[168:171], v12 offset:36864
    v_mfma_f32_16x16x32_bf16 v[124:127], v[228:231], v[212:215], v[124:127]
    ds_read_b128 v[172:175], v12 offset:38912
    v_mfma_f32_16x16x32_bf16 v[140:143], v[212:215], v[232:235], v[140:143]
    v_mfma_f32_16x16x32_bf16 v[156:159], v[212:215], v[236:239], v[156:159]
    s_waitcnt lgkmcnt(0)
    v_mfma_f32_16x16x32_bf16 v[64:67], v[176:179], v[160:163], v[64:67]
    s_cmp_lg_u32 s31, 0
    s_cbranch_scc0 gated_mix__softmax_full_mha__linear_kernel_hedgehog__prompt_kernel_p1_w22_e
    s_waitcnt vmcnt(16)
gated_mix__softmax_full_mha__linear_kernel_hedgehog__prompt_kernel_p1_w22_e:
    s_barrier
    v_mfma_f32_16x16x32_bf16 v[80:83], v[180:183], v[160:163], v[80:83]
    ds_read_b128 v[200:203], v13 offset:32768
    v_mfma_f32_16x16x32_bf16 v[96:99], v[184:187], v[160:163], v[96:99]
    ds_read_b64_tr_b16 v[216:217], v16 offset:24576
    v_mfma_f32_16x16x32_bf16 v[112:115], v[188:191], v[160:163], v[112:115]
    ds_read_b64_tr_b16 v[218:219], v16 offset:25088
    v_mfma_f32_16x16x32_bf16 v[128:131], v[160:163], v[192:195], v[128:131]
    s_cmp_lg_u32 s31, 0
    s_cbranch_scc0 gated_mix__softmax_full_mha__linear_kernel_hedgehog__prompt_kernel_p1_d22_e
    s_add_u32 m0, s26, 98304
    s_mov_b32 s24, 5111808
    buffer_load_dwordx4 v5, s[12:15], s24 offen offset:0 lds
    buffer_load_dwordx4 v6, s[12:15], s24 offen offset:1024 lds
    buffer_load_dwordx4 v7, s[12:15], s24 offen offset:2048 lds
    buffer_load_dwordx4 v8, s[12:15], s24 offen offset:3072 lds
    s_add_u32 m0, s26, 102400
    s_nop 0
    buffer_load_dwordx4 v9, s[12:15], s24 offen offset:0 lds
    buffer_load_dwordx4 v10, s[12:15], s24 offen offset:1024 lds
gated_mix__softmax_full_mha__linear_kernel_hedgehog__prompt_kernel_p1_d22_e:
    v_mfma_f32_16x16x32_bf16 v[144:147], v[160:163], v[196:199], v[144:147]
    ds_read_b64_tr_b16 v[220:221], v17 offset:24576
    v_mfma_f32_16x16x32_bf16 v[68:71], v[176:179], v[164:167], v[68:71]
    ds_read_b64_tr_b16 v[222:223], v17 offset:25088
    v_mfma_f32_16x16x32_bf16 v[84:87], v[180:183], v[164:167], v[84:87]
    ds_read_b64_tr_b16 v[224:225], v16 offset:28672
    v_mfma_f32_16x16x32_bf16 v[100:103], v[184:187], v[164:167], v[100:103]
    v_mfma_f32_16x16x32_bf16 v[116:119], v[188:191], v[164:167], v[116:119]
    ds_read_b64_tr_b16 v[226:227], v16 offset:29184
    v_mfma_f32_16x16x32_bf16 v[132:135], v[164:167], v[192:195], v[132:135]
    ds_read_b64_tr_b16 v[228:229], v17 offset:28672
    v_mfma_f32_16x16x32_bf16 v[148:151], v[164:167], v[196:199], v[148:151]
    v_mfma_f32_16x16x32_bf16 v[72:75], v[176:179], v[168:171], v[72:75]
    ds_read_b64_tr_b16 v[230:231], v17 offset:29184
    v_mfma_f32_16x16x32_bf16 v[88:91], v[180:183], v[168:171], v[88:91]
    ds_read_b64_tr_b16 v[232:233], v16 offset:32768
    v_mfma_f32_16x16x32_bf16 v[104:107], v[184:187], v[168:171], v[104:107]
    ds_read_b64_tr_b16 v[234:235], v16 offset:33280
    s_cmp_lg_u32 s31, 0
    s_cbranch_scc0 gated_mix__softmax_full_mha__linear_kernel_hedgehog__prompt_kernel_p1_e22_e
    s_add_u32 m0, s25, 18432
    s_mov_b32 s23, 1664
    buffer_load_dwordx4 v3, s[8:11], s23 offen offset:0 lds
    buffer_load_dwordx4 v4, s[8:11], s23 offen offset:1024 lds
gated_mix__softmax_full_mha__linear_kernel_hedgehog__prompt_kernel_p1_e22_e:
    v_mfma_f32_16x16x32_bf16 v[120:123], v[188:191], v[168:171], v[120:123]
    v_mfma_f32_16x16x32_bf16 v[136:139], v[168:171], v[192:195], v[136:139]
    ds_read_b64_tr_b16 v[236:237], v17 offset:32768
    v_mfma_f32_16x16x32_bf16 v[152:155], v[168:171], v[196:199], v[152:155]
    ds_read_b64_tr_b16 v[238:239], v17 offset:33280
    v_mfma_f32_16x16x32_bf16 v[76:79], v[176:179], v[172:175], v[76:79]
    ds_read_b128 v[204:207], v13 offset:34816
    v_mfma_f32_16x16x32_bf16 v[92:95], v[180:183], v[172:175], v[92:95]
    v_mfma_f32_16x16x32_bf16 v[108:111], v[184:187], v[172:175], v[108:111]
    ds_read_b128 v[208:211], v13 offset:36864
    v_mfma_f32_16x16x32_bf16 v[124:127], v[188:191], v[172:175], v[124:127]
    ds_read_b128 v[212:215], v13 offset:38912
    v_mfma_f32_16x16x32_bf16 v[140:143], v[172:175], v[192:195], v[140:143]
    v_mfma_f32_16x16x32_bf16 v[156:159], v[172:175], v[196:199], v[156:159]
    s_waitcnt lgkmcnt(0)
    v_mfma_f32_16x16x32_bf16 v[64:67], v[216:219], v[200:203], v[64:67]
    s_cmp_lg_u32 s31, 0
    s_cbranch_scc0 gated_mix__softmax_full_mha__linear_kernel_hedgehog__prompt_kernel_p1_w23_e
    s_waitcnt vmcnt(16)
gated_mix__softmax_full_mha__linear_kernel_hedgehog__prompt_kernel_p1_w23_e:
    s_barrier
    v_mfma_f32_16x16x32_bf16 v[80:83], v[220:223], v[200:203], v[80:83]
    ds_read_b128 v[160:163], v12 offset:0
    v_mfma_f32_16x16x32_bf16 v[96:99], v[224:227], v[200:203], v[96:99]
    ds_read_b64_tr_b16 v[176:177], v14 offset:0
    v_mfma_f32_16x16x32_bf16 v[112:115], v[228:231], v[200:203], v[112:115]
    ds_read_b64_tr_b16 v[178:179], v14 offset:512
    v_mfma_f32_16x16x32_bf16 v[128:131], v[200:203], v[232:235], v[128:131]
    s_cmp_lg_u32 s31, 0
    s_cbranch_scc0 gated_mix__softmax_full_mha__linear_kernel_hedgehog__prompt_kernel_p1_d23_e
    s_add_u32 m0, s26, 122880
    s_mov_b32 s24, 5308416
    buffer_load_dwordx4 v5, s[12:15], s24 offen offset:0 lds
    buffer_load_dwordx4 v6, s[12:15], s24 offen offset:1024 lds
    buffer_load_dwordx4 v7, s[12:15], s24 offen offset:2048 lds
    buffer_load_dwordx4 v8, s[12:15], s24 offen offset:3072 lds
    s_add_u32 m0, s26, 126976
    s_nop 0
    buffer_load_dwordx4 v9, s[12:15], s24 offen offset:0 lds
    buffer_load_dwordx4 v10, s[12:15], s24 offen offset:1024 lds
gated_mix__softmax_full_mha__linear_kernel_hedgehog__prompt_kernel_p1_d23_e:
    v_mfma_f32_16x16x32_bf16 v[144:147], v[200:203], v[236:239], v[144:147]
    ds_read_b64_tr_b16 v[180:181], v15 offset:0
    v_mfma_f32_16x16x32_bf16 v[68:71], v[216:219], v[204:207], v[68:71]
    ds_read_b64_tr_b16 v[182:183], v15 offset:512
    v_mfma_f32_16x16x32_bf16 v[84:87], v[220:223], v[204:207], v[84:87]
    ds_read_b64_tr_b16 v[184:185], v14 offset:4096
    v_mfma_f32_16x16x32_bf16 v[100:103], v[224:227], v[204:207], v[100:103]
    v_mfma_f32_16x16x32_bf16 v[116:119], v[228:231], v[204:207], v[116:119]
    ds_read_b64_tr_b16 v[186:187], v14 offset:4608
    v_mfma_f32_16x16x32_bf16 v[132:135], v[204:207], v[232:235], v[132:135]
    ds_read_b64_tr_b16 v[188:189], v15 offset:4096
    v_mfma_f32_16x16x32_bf16 v[148:151], v[204:207], v[236:239], v[148:151]
    v_mfma_f32_16x16x32_bf16 v[72:75], v[216:219], v[208:211], v[72:75]
    ds_read_b64_tr_b16 v[190:191], v15 offset:4608
    v_mfma_f32_16x16x32_bf16 v[88:91], v[220:223], v[208:211], v[88:91]
    ds_read_b64_tr_b16 v[192:193], v14 offset:8192
    v_mfma_f32_16x16x32_bf16 v[104:107], v[224:227], v[208:211], v[104:107]
    ds_read_b64_tr_b16 v[194:195], v14 offset:8704
    s_cmp_lg_u32 s31, 0
    s_cbranch_scc0 gated_mix__softmax_full_mha__linear_kernel_hedgehog__prompt_kernel_p1_e23_e
    s_add_u32 m0, s25, 32768
    s_mov_b32 s23, 1792
    buffer_load_dwordx4 v1, s[8:11], s23 offen offset:0 lds
    buffer_load_dwordx4 v2, s[8:11], s23 offen offset:1024 lds
gated_mix__softmax_full_mha__linear_kernel_hedgehog__prompt_kernel_p1_e23_e:
    v_mfma_f32_16x16x32_bf16 v[120:123], v[228:231], v[208:211], v[120:123]
    v_mfma_f32_16x16x32_bf16 v[136:139], v[208:211], v[232:235], v[136:139]
    ds_read_b64_tr_b16 v[196:197], v15 offset:8192
    v_mfma_f32_16x16x32_bf16 v[152:155], v[208:211], v[236:239], v[152:155]
    ds_read_b64_tr_b16 v[198:199], v15 offset:8704
    v_mfma_f32_16x16x32_bf16 v[76:79], v[216:219], v[212:215], v[76:79]
    ds_read_b128 v[164:167], v12 offset:2048
    v_mfma_f32_16x16x32_bf16 v[92:95], v[220:223], v[212:215], v[92:95]
    v_mfma_f32_16x16x32_bf16 v[108:111], v[224:227], v[212:215], v[108:111]
    ds_read_b128 v[168:171], v12 offset:4096
    v_mfma_f32_16x16x32_bf16 v[124:127], v[228:231], v[212:215], v[124:127]
    ds_read_b128 v[172:175], v12 offset:6144
    v_mfma_f32_16x16x32_bf16 v[140:143], v[212:215], v[232:235], v[140:143]
    v_mfma_f32_16x16x32_bf16 v[156:159], v[212:215], v[236:239], v[156:159]
    s_waitcnt lgkmcnt(0)
    v_mfma_f32_16x16x32_bf16 v[64:67], v[176:179], v[160:163], v[64:67]
    s_cmp_lg_u32 s31, 0
    s_cbranch_scc0 gated_mix__softmax_full_mha__linear_kernel_hedgehog__prompt_kernel_p1_w24_e
    s_waitcnt vmcnt(16)
gated_mix__softmax_full_mha__linear_kernel_hedgehog__prompt_kernel_p1_w24_e:
    s_barrier
    v_mfma_f32_16x16x32_bf16 v[80:83], v[180:183], v[160:163], v[80:83]
    ds_read_b128 v[200:203], v13 offset:0
    v_mfma_f32_16x16x32_bf16 v[96:99], v[184:187], v[160:163], v[96:99]
    ds_read_b64_tr_b16 v[216:217], v14 offset:24576
    v_mfma_f32_16x16x32_bf16 v[112:115], v[188:191], v[160:163], v[112:115]
    ds_read_b64_tr_b16 v[218:219], v14 offset:25088
    v_mfma_f32_16x16x32_bf16 v[128:131], v[160:163], v[192:195], v[128:131]
    s_cmp_lg_u32 s31, 0
    s_cbranch_scc0 gated_mix__softmax_full_mha__linear_kernel_hedgehog__prompt_kernel_p1_d24_e
    s_add_u32 m0, s26, 49152
    s_mov_b32 s24, 5505024
    buffer_load_dwordx4 v5, s[12:15], s24 offen offset:0 lds
    buffer_load_dwordx4 v6, s[12:15], s24 offen offset:1024 lds
    buffer_load_dwordx4 v7, s[12:15], s24 offen offset:2048 lds
    buffer_load_dwordx4 v8, s[12:15], s24 offen offset:3072 lds
    s_add_u32 m0, s26, 53248
    s_nop 0
    buffer_load_dwordx4 v9, s[12:15], s24 offen offset:0 lds
    buffer_load_dwordx4 v10, s[12:15], s24 offen offset:1024 lds
gated_mix__softmax_full_mha__linear_kernel_hedgehog__prompt_kernel_p1_d24_e:
    v_mfma_f32_16x16x32_bf16 v[144:147], v[160:163], v[196:199], v[144:147]
    ds_read_b64_tr_b16 v[220:221], v15 offset:24576
    v_mfma_f32_16x16x32_bf16 v[68:71], v[176:179], v[164:167], v[68:71]
    ds_read_b64_tr_b16 v[222:223], v15 offset:25088
    v_mfma_f32_16x16x32_bf16 v[84:87], v[180:183], v[164:167], v[84:87]
    ds_read_b64_tr_b16 v[224:225], v14 offset:28672
    v_mfma_f32_16x16x32_bf16 v[100:103], v[184:187], v[164:167], v[100:103]
    v_mfma_f32_16x16x32_bf16 v[116:119], v[188:191], v[164:167], v[116:119]
    ds_read_b64_tr_b16 v[226:227], v14 offset:29184
    v_mfma_f32_16x16x32_bf16 v[132:135], v[164:167], v[192:195], v[132:135]
    ds_read_b64_tr_b16 v[228:229], v15 offset:28672
    v_mfma_f32_16x16x32_bf16 v[148:151], v[164:167], v[196:199], v[148:151]
    v_mfma_f32_16x16x32_bf16 v[72:75], v[176:179], v[168:171], v[72:75]
    ds_read_b64_tr_b16 v[230:231], v15 offset:29184
    v_mfma_f32_16x16x32_bf16 v[88:91], v[180:183], v[168:171], v[88:91]
    ds_read_b64_tr_b16 v[232:233], v14 offset:32768
    v_mfma_f32_16x16x32_bf16 v[104:107], v[184:187], v[168:171], v[104:107]
    ds_read_b64_tr_b16 v[234:235], v14 offset:33280
    s_cmp_lg_u32 s31, 0
    s_cbranch_scc0 gated_mix__softmax_full_mha__linear_kernel_hedgehog__prompt_kernel_p1_e24_e
    s_add_u32 m0, s25, 34816
    s_mov_b32 s23, 1792
    buffer_load_dwordx4 v3, s[8:11], s23 offen offset:0 lds
    buffer_load_dwordx4 v4, s[8:11], s23 offen offset:1024 lds
gated_mix__softmax_full_mha__linear_kernel_hedgehog__prompt_kernel_p1_e24_e:
    v_mfma_f32_16x16x32_bf16 v[120:123], v[188:191], v[168:171], v[120:123]
    v_mfma_f32_16x16x32_bf16 v[136:139], v[168:171], v[192:195], v[136:139]
    ds_read_b64_tr_b16 v[236:237], v15 offset:32768
    v_mfma_f32_16x16x32_bf16 v[152:155], v[168:171], v[196:199], v[152:155]
    ds_read_b64_tr_b16 v[238:239], v15 offset:33280
    v_mfma_f32_16x16x32_bf16 v[76:79], v[176:179], v[172:175], v[76:79]
    ds_read_b128 v[204:207], v13 offset:2048
    v_mfma_f32_16x16x32_bf16 v[92:95], v[180:183], v[172:175], v[92:95]
    v_mfma_f32_16x16x32_bf16 v[108:111], v[184:187], v[172:175], v[108:111]
    ds_read_b128 v[208:211], v13 offset:4096
    v_mfma_f32_16x16x32_bf16 v[124:127], v[188:191], v[172:175], v[124:127]
    ds_read_b128 v[212:215], v13 offset:6144
    v_mfma_f32_16x16x32_bf16 v[140:143], v[172:175], v[192:195], v[140:143]
    v_mfma_f32_16x16x32_bf16 v[156:159], v[172:175], v[196:199], v[156:159]
    s_waitcnt lgkmcnt(0)
    v_mfma_f32_16x16x32_bf16 v[64:67], v[216:219], v[200:203], v[64:67]
    s_cmp_lg_u32 s31, 0
    s_cbranch_scc0 gated_mix__softmax_full_mha__linear_kernel_hedgehog__prompt_kernel_p1_w25_e
    s_waitcnt vmcnt(16)
gated_mix__softmax_full_mha__linear_kernel_hedgehog__prompt_kernel_p1_w25_e:
    s_barrier
    v_mfma_f32_16x16x32_bf16 v[80:83], v[220:223], v[200:203], v[80:83]
    ds_read_b128 v[160:163], v12 offset:16384
    v_mfma_f32_16x16x32_bf16 v[96:99], v[224:227], v[200:203], v[96:99]
    ds_read_b64_tr_b16 v[176:177], v16 offset:0
    v_mfma_f32_16x16x32_bf16 v[112:115], v[228:231], v[200:203], v[112:115]
    ds_read_b64_tr_b16 v[178:179], v16 offset:512
    v_mfma_f32_16x16x32_bf16 v[128:131], v[200:203], v[232:235], v[128:131]
    s_cmp_lg_u32 s31, 0
    s_cbranch_scc0 gated_mix__softmax_full_mha__linear_kernel_hedgehog__prompt_kernel_p1_d25_e
    s_add_u32 m0, s26, 73728
    s_mov_b32 s24, 5701632
    buffer_load_dwordx4 v5, s[12:15], s24 offen offset:0 lds
    buffer_load_dwordx4 v6, s[12:15], s24 offen offset:1024 lds
    buffer_load_dwordx4 v7, s[12:15], s24 offen offset:2048 lds
    buffer_load_dwordx4 v8, s[12:15], s24 offen offset:3072 lds
    s_add_u32 m0, s26, 77824
    s_nop 0
    buffer_load_dwordx4 v9, s[12:15], s24 offen offset:0 lds
    buffer_load_dwordx4 v10, s[12:15], s24 offen offset:1024 lds
gated_mix__softmax_full_mha__linear_kernel_hedgehog__prompt_kernel_p1_d25_e:
    v_mfma_f32_16x16x32_bf16 v[144:147], v[200:203], v[236:239], v[144:147]
    ds_read_b64_tr_b16 v[180:181], v17 offset:0
    v_mfma_f32_16x16x32_bf16 v[68:71], v[216:219], v[204:207], v[68:71]
    ds_read_b64_tr_b16 v[182:183], v17 offset:512
    v_mfma_f32_16x16x32_bf16 v[84:87], v[220:223], v[204:207], v[84:87]
    ds_read_b64_tr_b16 v[184:185], v16 offset:4096
    v_mfma_f32_16x16x32_bf16 v[100:103], v[224:227], v[204:207], v[100:103]
    v_mfma_f32_16x16x32_bf16 v[116:119], v[228:231], v[204:207], v[116:119]
    ds_read_b64_tr_b16 v[186:187], v16 offset:4608
    v_mfma_f32_16x16x32_bf16 v[132:135], v[204:207], v[232:235], v[132:135]
    ds_read_b64_tr_b16 v[188:189], v17 offset:4096
    v_mfma_f32_16x16x32_bf16 v[148:151], v[204:207], v[236:239], v[148:151]
    v_mfma_f32_16x16x32_bf16 v[72:75], v[216:219], v[208:211], v[72:75]
    ds_read_b64_tr_b16 v[190:191], v17 offset:4608
    v_mfma_f32_16x16x32_bf16 v[88:91], v[220:223], v[208:211], v[88:91]
    ds_read_b64_tr_b16 v[192:193], v16 offset:8192
    v_mfma_f32_16x16x32_bf16 v[104:107], v[224:227], v[208:211], v[104:107]
    ds_read_b64_tr_b16 v[194:195], v16 offset:8704
    s_cmp_lg_u32 s31, 0
    s_cbranch_scc0 gated_mix__softmax_full_mha__linear_kernel_hedgehog__prompt_kernel_p1_e25_e
    s_add_u32 m0, s25, 0
    s_mov_b32 s23, 1920
    buffer_load_dwordx4 v1, s[8:11], s23 offen offset:0 lds
    buffer_load_dwordx4 v2, s[8:11], s23 offen offset:1024 lds
gated_mix__softmax_full_mha__linear_kernel_hedgehog__prompt_kernel_p1_e25_e:
    v_mfma_f32_16x16x32_bf16 v[120:123], v[228:231], v[208:211], v[120:123]
    v_mfma_f32_16x16x32_bf16 v[136:139], v[208:211], v[232:235], v[136:139]
    ds_read_b64_tr_b16 v[196:197], v17 offset:8192
    v_mfma_f32_16x16x32_bf16 v[152:155], v[208:211], v[236:239], v[152:155]
    ds_read_b64_tr_b16 v[198:199], v17 offset:8704
    v_mfma_f32_16x16x32_bf16 v[76:79], v[216:219], v[212:215], v[76:79]
    ds_read_b128 v[164:167], v12 offset:18432
    v_mfma_f32_16x16x32_bf16 v[92:95], v[220:223], v[212:215], v[92:95]
    v_mfma_f32_16x16x32_bf16 v[108:111], v[224:227], v[212:215], v[108:111]
    ds_read_b128 v[168:171], v12 offset:20480
    v_mfma_f32_16x16x32_bf16 v[124:127], v[228:231], v[212:215], v[124:127]
    ds_read_b128 v[172:175], v12 offset:22528
    v_mfma_f32_16x16x32_bf16 v[140:143], v[212:215], v[232:235], v[140:143]
    v_mfma_f32_16x16x32_bf16 v[156:159], v[212:215], v[236:239], v[156:159]
    s_waitcnt lgkmcnt(0)
    v_mfma_f32_16x16x32_bf16 v[64:67], v[176:179], v[160:163], v[64:67]
    s_cmp_lg_u32 s31, 0
    s_cbranch_scc0 gated_mix__softmax_full_mha__linear_kernel_hedgehog__prompt_kernel_p1_w26_e
    s_waitcnt vmcnt(16)
gated_mix__softmax_full_mha__linear_kernel_hedgehog__prompt_kernel_p1_w26_e:
    s_barrier
    v_mfma_f32_16x16x32_bf16 v[80:83], v[180:183], v[160:163], v[80:83]
    ds_read_b128 v[200:203], v13 offset:16384
    v_mfma_f32_16x16x32_bf16 v[96:99], v[184:187], v[160:163], v[96:99]
    ds_read_b64_tr_b16 v[216:217], v16 offset:24576
    v_mfma_f32_16x16x32_bf16 v[112:115], v[188:191], v[160:163], v[112:115]
    ds_read_b64_tr_b16 v[218:219], v16 offset:25088
    v_mfma_f32_16x16x32_bf16 v[128:131], v[160:163], v[192:195], v[128:131]
    s_cmp_lg_u32 s31, 0
    s_cbranch_scc0 gated_mix__softmax_full_mha__linear_kernel_hedgehog__prompt_kernel_p1_d26_o
    s_add_u32 m0, s26, 98304
    s_mov_b32 s24, 5898240
    buffer_load_dwordx4 v5, s[12:15], s24 offen offset:0 lds
    buffer_load_dwordx4 v6, s[12:15], s24 offen offset:1024 lds
    buffer_load_dwordx4 v7, s[12:15], s24 offen offset:2048 lds
    buffer_load_dwordx4 v8, s[12:15], s24 offen offset:3072 lds
    s_add_u32 m0, s26, 102400
    s_nop 0
    buffer_load_dwordx4 v9, s[12:15], s24 offen offset:0 lds
    buffer_load_dwordx4 v10, s[12:15], s24 offen offset:1024 lds
    s_branch gated_mix__softmax_full_mha__linear_kernel_hedgehog__prompt_kernel_p1_d26_e
gated_mix__softmax_full_mha__linear_kernel_hedgehog__prompt_kernel_p1_d26_o:
    s_cmp_lg_u32 s22, 5
    s_cbranch_scc1 gated_mix__softmax_full_mha__linear_kernel_hedgehog__prompt_kernel_p1_nochk
    s_waitcnt lgkmcnt(0)
    s_mov_b32 s84, s100
    s_and_b32 s85, s101, 0xffff
    s_mov_b32 s86, 256
    s_mov_b32 s87, 0x00020000
    s_mov_b64 exec, 0xff
    v_and_b32 v20, 7, v0
    v_lshlrev_b32 v20, 5, v20
    s_mov_b32 s3, 131072
gated_mix__softmax_full_mha__linear_kernel_hedgehog__prompt_kernel_p1_clr:
    buffer_load_dword v21, v20, s[84:87], 0 offen sc1
    s_waitcnt vmcnt(0)
    v_cmp_le_u32 vcc, 32, v21
    s_sub_u32 s3, s3, 1
    s_cmp_eq_u32 s3, 0
    s_cbranch_scc1 gated_mix__softmax_full_mha__linear_kernel_hedgehog__prompt_kernel_p1_clrdone
    s_cmp_eq_u64 vcc, exec
    s_cbranch_scc1 gated_mix__softmax_full_mha__linear_kernel_hedgehog__prompt_kernel_p1_clrdone
    s_sleep 2
    s_branch gated_mix__softmax_full_mha__linear_kernel_hedgehog__prompt_kernel_p1_clr
gated_mix__softmax_full_mha__linear_kernel_hedgehog__prompt_kernel_p1_clrdone:
    s_mov_b64 exec, -1
gated_mix__softmax_full_mha__linear_kernel_hedgehog__prompt_kernel_p1_nochk:
gated_mix__softmax_full_mha__linear_kernel_hedgehog__prompt_kernel_p1_d26_e:
    v_mfma_f32_16x16x32_bf16 v[144:147], v[160:163], v[196:199], v[144:147]
    ds_read_b64_tr_b16 v[220:221], v17 offset:24576
    v_mfma_f32_16x16x32_bf16 v[68:71], v[176:179], v[164:167], v[68:71]
    ds_read_b64_tr_b16 v[222:223], v17 offset:25088
    v_mfma_f32_16x16x32_bf16 v[84:87], v[180:183], v[164:167], v[84:87]
    ds_read_b64_tr_b16 v[224:225], v16 offset:28672
    v_mfma_f32_16x16x32_bf16 v[100:103], v[184:187], v[164:167], v[100:103]
    v_mfma_f32_16x16x32_bf16 v[116:119], v[188:191], v[164:167], v[116:119]
    ds_read_b64_tr_b16 v[226:227], v16 offset:29184
    v_mfma_f32_16x16x32_bf16 v[132:135], v[164:167], v[192:195], v[132:135]
    ds_read_b64_tr_b16 v[228:229], v17 offset:28672
    v_mfma_f32_16x16x32_bf16 v[148:151], v[164:167], v[196:199], v[148:151]
    v_mfma_f32_16x16x32_bf16 v[72:75], v[176:179], v[168:171], v[72:75]
    ds_read_b64_tr_b16 v[230:231], v17 offset:29184
    v_mfma_f32_16x16x32_bf16 v[88:91], v[180:183], v[168:171], v[88:91]
    ds_read_b64_tr_b16 v[232:233], v16 offset:32768
    v_mfma_f32_16x16x32_bf16 v[104:107], v[184:187], v[168:171], v[104:107]
    ds_read_b64_tr_b16 v[234:235], v16 offset:33280
    s_cmp_lg_u32 s31, 0
    s_cbranch_scc0 gated_mix__softmax_full_mha__linear_kernel_hedgehog__prompt_kernel_p1_e26_e
    s_add_u32 m0, s25, 2048
    s_mov_b32 s23, 1920
    buffer_load_dwordx4 v3, s[8:11], s23 offen offset:0 lds
    buffer_load_dwordx4 v4, s[8:11], s23 offen offset:1024 lds
gated_mix__softmax_full_mha__linear_kernel_hedgehog__prompt_kernel_p1_e26_e:
    v_mfma_f32_16x16x32_bf16 v[120:123], v[188:191], v[168:171], v[120:123]
    v_mfma_f32_16x16x32_bf16 v[136:139], v[168:171], v[192:195], v[136:139]
    ds_read_b64_tr_b16 v[236:237], v17 offset:32768
    v_mfma_f32_16x16x32_bf16 v[152:155], v[168:171], v[196:199], v[152:155]
    ds_read_b64_tr_b16 v[238:239], v17 offset:33280
    v_mfma_f32_16x16x32_bf16 v[76:79], v[176:179], v[172:175], v[76:79]
    ds_read_b128 v[204:207], v13 offset:18432
    v_mfma_f32_16x16x32_bf16 v[92:95], v[180:183], v[172:175], v[92:95]
    v_mfma_f32_16x16x32_bf16 v[108:111], v[184:187], v[172:175], v[108:111]
    ds_read_b128 v[208:211], v13 offset:20480
    v_mfma_f32_16x16x32_bf16 v[124:127], v[188:191], v[172:175], v[124:127]
    ds_read_b128 v[212:215], v13 offset:22528
    v_mfma_f32_16x16x32_bf16 v[140:143], v[172:175], v[192:195], v[140:143]
    v_mfma_f32_16x16x32_bf16 v[156:159], v[172:175], v[196:199], v[156:159]
    s_waitcnt lgkmcnt(0)
    v_mfma_f32_16x16x32_bf16 v[64:67], v[216:219], v[200:203], v[64:67]
    s_cmp_lg_u32 s31, 0
    s_cbranch_scc0 gated_mix__softmax_full_mha__linear_kernel_hedgehog__prompt_kernel_p1_w27_e
    s_waitcnt vmcnt(16)
gated_mix__softmax_full_mha__linear_kernel_hedgehog__prompt_kernel_p1_w27_e:
    s_barrier
    v_mfma_f32_16x16x32_bf16 v[80:83], v[220:223], v[200:203], v[80:83]
    ds_read_b128 v[160:163], v12 offset:32768
    v_mfma_f32_16x16x32_bf16 v[96:99], v[224:227], v[200:203], v[96:99]
    ds_read_b64_tr_b16 v[176:177], v14 offset:0
    v_mfma_f32_16x16x32_bf16 v[112:115], v[228:231], v[200:203], v[112:115]
    ds_read_b64_tr_b16 v[178:179], v14 offset:512
    v_mfma_f32_16x16x32_bf16 v[128:131], v[200:203], v[232:235], v[128:131]
    s_cmp_lg_u32 s31, 0
    s_cbranch_scc0 gated_mix__softmax_full_mha__linear_kernel_hedgehog__prompt_kernel_p1_d27_e
    s_add_u32 m0, s26, 122880
    s_mov_b32 s24, 6094848
    buffer_load_dwordx4 v5, s[12:15], s24 offen offset:0 lds
    buffer_load_dwordx4 v6, s[12:15], s24 offen offset:1024 lds
    buffer_load_dwordx4 v7, s[12:15], s24 offen offset:2048 lds
    buffer_load_dwordx4 v8, s[12:15], s24 offen offset:3072 lds
    s_add_u32 m0, s26, 126976
    s_nop 0
    buffer_load_dwordx4 v9, s[12:15], s24 offen offset:0 lds
    buffer_load_dwordx4 v10, s[12:15], s24 offen offset:1024 lds
gated_mix__softmax_full_mha__linear_kernel_hedgehog__prompt_kernel_p1_d27_e:
    v_mfma_f32_16x16x32_bf16 v[144:147], v[200:203], v[236:239], v[144:147]
    ds_read_b64_tr_b16 v[180:181], v15 offset:0
    v_mfma_f32_16x16x32_bf16 v[68:71], v[216:219], v[204:207], v[68:71]
    ds_read_b64_tr_b16 v[182:183], v15 offset:512
    v_mfma_f32_16x16x32_bf16 v[84:87], v[220:223], v[204:207], v[84:87]
    ds_read_b64_tr_b16 v[184:185], v14 offset:4096
    v_mfma_f32_16x16x32_bf16 v[100:103], v[224:227], v[204:207], v[100:103]
    v_mfma_f32_16x16x32_bf16 v[116:119], v[228:231], v[204:207], v[116:119]
    ds_read_b64_tr_b16 v[186:187], v14 offset:4608
    v_mfma_f32_16x16x32_bf16 v[132:135], v[204:207], v[232:235], v[132:135]
    ds_read_b64_tr_b16 v[188:189], v15 offset:4096
    v_mfma_f32_16x16x32_bf16 v[148:151], v[204:207], v[236:239], v[148:151]
    v_mfma_f32_16x16x32_bf16 v[72:75], v[216:219], v[208:211], v[72:75]
    ds_read_b64_tr_b16 v[190:191], v15 offset:4608
    v_mfma_f32_16x16x32_bf16 v[88:91], v[220:223], v[208:211], v[88:91]
    ds_read_b64_tr_b16 v[192:193], v14 offset:8192
    v_mfma_f32_16x16x32_bf16 v[104:107], v[224:227], v[208:211], v[104:107]
    ds_read_b64_tr_b16 v[194:195], v14 offset:8704
    v_mfma_f32_16x16x32_bf16 v[120:123], v[228:231], v[208:211], v[120:123]
    v_mfma_f32_16x16x32_bf16 v[136:139], v[208:211], v[232:235], v[136:139]
    ds_read_b64_tr_b16 v[196:197], v15 offset:8192
    v_mfma_f32_16x16x32_bf16 v[152:155], v[208:211], v[236:239], v[152:155]
    ds_read_b64_tr_b16 v[198:199], v15 offset:8704
    v_mfma_f32_16x16x32_bf16 v[76:79], v[216:219], v[212:215], v[76:79]
    ds_read_b128 v[164:167], v12 offset:34816
    v_mfma_f32_16x16x32_bf16 v[92:95], v[220:223], v[212:215], v[92:95]
    v_mfma_f32_16x16x32_bf16 v[108:111], v[224:227], v[212:215], v[108:111]
    ds_read_b128 v[168:171], v12 offset:36864
    v_mfma_f32_16x16x32_bf16 v[124:127], v[228:231], v[212:215], v[124:127]
    ds_read_b128 v[172:175], v12 offset:38912
    v_mfma_f32_16x16x32_bf16 v[140:143], v[212:215], v[232:235], v[140:143]
    v_mfma_f32_16x16x32_bf16 v[156:159], v[212:215], v[236:239], v[156:159]
    s_waitcnt lgkmcnt(0)
    v_mfma_f32_16x16x32_bf16 v[64:67], v[176:179], v[160:163], v[64:67]
    s_cmp_lg_u32 s31, 0
    s_cbranch_scc0 gated_mix__softmax_full_mha__linear_kernel_hedgehog__prompt_kernel_p1_w28_e
    s_waitcnt vmcnt(14)
gated_mix__softmax_full_mha__linear_kernel_hedgehog__prompt_kernel_p1_w28_e:
    s_barrier
    v_mfma_f32_16x16x32_bf16 v[80:83], v[180:183], v[160:163], v[80:83]
    ds_read_b128 v[200:203], v13 offset:32768
    v_mfma_f32_16x16x32_bf16 v[96:99], v[184:187], v[160:163], v[96:99]
    ds_read_b64_tr_b16 v[216:217], v14 offset:24576
    v_mfma_f32_16x16x32_bf16 v[112:115], v[188:191], v[160:163], v[112:115]
    ds_read_b64_tr_b16 v[218:219], v14 offset:25088
    v_mfma_f32_16x16x32_bf16 v[128:131], v[160:163], v[192:195], v[128:131]
    v_mfma_f32_16x16x32_bf16 v[144:147], v[160:163], v[196:199], v[144:147]
    ds_read_b64_tr_b16 v[220:221], v15 offset:24576
    v_mfma_f32_16x16x32_bf16 v[68:71], v[176:179], v[164:167], v[68:71]
    ds_read_b64_tr_b16 v[222:223], v15 offset:25088
    v_mfma_f32_16x16x32_bf16 v[84:87], v[180:183], v[164:167], v[84:87]
    ds_read_b64_tr_b16 v[224:225], v14 offset:28672
    v_mfma_f32_16x16x32_bf16 v[100:103], v[184:187], v[164:167], v[100:103]
    v_mfma_f32_16x16x32_bf16 v[116:119], v[188:191], v[164:167], v[116:119]
    ds_read_b64_tr_b16 v[226:227], v14 offset:29184
    v_mfma_f32_16x16x32_bf16 v[132:135], v[164:167], v[192:195], v[132:135]
    ds_read_b64_tr_b16 v[228:229], v15 offset:28672
    v_mfma_f32_16x16x32_bf16 v[148:151], v[164:167], v[196:199], v[148:151]
    v_mfma_f32_16x16x32_bf16 v[72:75], v[176:179], v[168:171], v[72:75]
    ds_read_b64_tr_b16 v[230:231], v15 offset:29184
    v_mfma_f32_16x16x32_bf16 v[88:91], v[180:183], v[168:171], v[88:91]
    ds_read_b64_tr_b16 v[232:233], v14 offset:32768
    v_mfma_f32_16x16x32_bf16 v[104:107], v[184:187], v[168:171], v[104:107]
    ds_read_b64_tr_b16 v[234:235], v14 offset:33280
    v_mfma_f32_16x16x32_bf16 v[120:123], v[188:191], v[168:171], v[120:123]
    v_mfma_f32_16x16x32_bf16 v[136:139], v[168:171], v[192:195], v[136:139]
    ds_read_b64_tr_b16 v[236:237], v15 offset:32768
    v_mfma_f32_16x16x32_bf16 v[152:155], v[168:171], v[196:199], v[152:155]
    ds_read_b64_tr_b16 v[238:239], v15 offset:33280
    v_mfma_f32_16x16x32_bf16 v[76:79], v[176:179], v[172:175], v[76:79]
    ds_read_b128 v[204:207], v13 offset:34816
    v_mfma_f32_16x16x32_bf16 v[92:95], v[180:183], v[172:175], v[92:95]
    v_mfma_f32_16x16x32_bf16 v[108:111], v[184:187], v[172:175], v[108:111]
    ds_read_b128 v[208:211], v13 offset:36864
    v_mfma_f32_16x16x32_bf16 v[124:127], v[188:191], v[172:175], v[124:127]
    ds_read_b128 v[212:215], v13 offset:38912
    v_mfma_f32_16x16x32_bf16 v[140:143], v[172:175], v[192:195], v[140:143]
    v_mfma_f32_16x16x32_bf16 v[156:159], v[172:175], v[196:199], v[156:159]
    s_waitcnt lgkmcnt(0)
    v_mfma_f32_16x16x32_bf16 v[64:67], v[216:219], v[200:203], v[64:67]
    s_cmp_lg_u32 s31, 0
    s_cbranch_scc0 gated_mix__softmax_full_mha__linear_kernel_hedgehog__prompt_kernel_p1_w29_e
    s_waitcnt vmcnt(6)
gated_mix__softmax_full_mha__linear_kernel_hedgehog__prompt_kernel_p1_w29_e:
    s_barrier
    v_mfma_f32_16x16x32_bf16 v[80:83], v[220:223], v[200:203], v[80:83]
    ds_read_b128 v[160:163], v12 offset:0
    v_mfma_f32_16x16x32_bf16 v[96:99], v[224:227], v[200:203], v[96:99]
    ds_read_b64_tr_b16 v[176:177], v16 offset:0
    v_mfma_f32_16x16x32_bf16 v[112:115], v[228:231], v[200:203], v[112:115]
    ds_read_b64_tr_b16 v[178:179], v16 offset:512
    v_mfma_f32_16x16x32_bf16 v[128:131], v[200:203], v[232:235], v[128:131]
    v_mfma_f32_16x16x32_bf16 v[144:147], v[200:203], v[236:239], v[144:147]
    ds_read_b64_tr_b16 v[180:181], v17 offset:0
    v_mfma_f32_16x16x32_bf16 v[68:71], v[216:219], v[204:207], v[68:71]
    ds_read_b64_tr_b16 v[182:183], v17 offset:512
    v_mfma_f32_16x16x32_bf16 v[84:87], v[220:223], v[204:207], v[84:87]
    ds_read_b64_tr_b16 v[184:185], v16 offset:4096
    v_mfma_f32_16x16x32_bf16 v[100:103], v[224:227], v[204:207], v[100:103]
    v_mfma_f32_16x16x32_bf16 v[116:119], v[228:231], v[204:207], v[116:119]
    ds_read_b64_tr_b16 v[186:187], v16 offset:4608
    v_mfma_f32_16x16x32_bf16 v[132:135], v[204:207], v[232:235], v[132:135]
    ds_read_b64_tr_b16 v[188:189], v17 offset:4096
    v_mfma_f32_16x16x32_bf16 v[148:151], v[204:207], v[236:239], v[148:151]
    v_mfma_f32_16x16x32_bf16 v[72:75], v[216:219], v[208:211], v[72:75]
    ds_read_b64_tr_b16 v[190:191], v17 offset:4608
    v_mfma_f32_16x16x32_bf16 v[88:91], v[220:223], v[208:211], v[88:91]
    ds_read_b64_tr_b16 v[192:193], v16 offset:8192
    v_mfma_f32_16x16x32_bf16 v[104:107], v[224:227], v[208:211], v[104:107]
    ds_read_b64_tr_b16 v[194:195], v16 offset:8704
    v_mfma_f32_16x16x32_bf16 v[120:123], v[228:231], v[208:211], v[120:123]
    v_mfma_f32_16x16x32_bf16 v[136:139], v[208:211], v[232:235], v[136:139]
    ds_read_b64_tr_b16 v[196:197], v17 offset:8192
    v_mfma_f32_16x16x32_bf16 v[152:155], v[208:211], v[236:239], v[152:155]
    ds_read_b64_tr_b16 v[198:199], v17 offset:8704
    v_mfma_f32_16x16x32_bf16 v[76:79], v[216:219], v[212:215], v[76:79]
    ds_read_b128 v[164:167], v12 offset:2048
    v_mfma_f32_16x16x32_bf16 v[92:95], v[220:223], v[212:215], v[92:95]
    v_mfma_f32_16x16x32_bf16 v[108:111], v[224:227], v[212:215], v[108:111]
    ds_read_b128 v[168:171], v12 offset:4096
    v_mfma_f32_16x16x32_bf16 v[124:127], v[228:231], v[212:215], v[124:127]
    ds_read_b128 v[172:175], v12 offset:6144
    v_mfma_f32_16x16x32_bf16 v[140:143], v[212:215], v[232:235], v[140:143]
    v_mfma_f32_16x16x32_bf16 v[156:159], v[212:215], v[236:239], v[156:159]
    s_waitcnt lgkmcnt(0)
    v_mfma_f32_16x16x32_bf16 v[64:67], v[176:179], v[160:163], v[64:67]
    s_cmp_lg_u32 s31, 0
    s_cbranch_scc0 gated_mix__softmax_full_mha__linear_kernel_hedgehog__prompt_kernel_p1_w30_e
    s_waitcnt vmcnt(0)
gated_mix__softmax_full_mha__linear_kernel_hedgehog__prompt_kernel_p1_w30_e:
    s_barrier
    v_mfma_f32_16x16x32_bf16 v[80:83], v[180:183], v[160:163], v[80:83]
    ds_read_b128 v[200:203], v13 offset:0
    v_mfma_f32_16x16x32_bf16 v[96:99], v[184:187], v[160:163], v[96:99]
    ds_read_b64_tr_b16 v[216:217], v16 offset:24576
    v_mfma_f32_16x16x32_bf16 v[112:115], v[188:191], v[160:163], v[112:115]
    ds_read_b64_tr_b16 v[218:219], v16 offset:25088
    v_mfma_f32_16x16x32_bf16 v[128:131], v[160:163], v[192:195], v[128:131]
    v_mfma_f32_16x16x32_bf16 v[144:147], v[160:163], v[196:199], v[144:147]
    ds_read_b64_tr_b16 v[220:221], v17 offset:24576
    v_mfma_f32_16x16x32_bf16 v[68:71], v[176:179], v[164:167], v[68:71]
    ds_read_b64_tr_b16 v[222:223], v17 offset:25088
    v_mfma_f32_16x16x32_bf16 v[84:87], v[180:183], v[164:167], v[84:87]
    ds_read_b64_tr_b16 v[224:225], v16 offset:28672
    v_mfma_f32_16x16x32_bf16 v[100:103], v[184:187], v[164:167], v[100:103]
    v_mfma_f32_16x16x32_bf16 v[116:119], v[188:191], v[164:167], v[116:119]
    ds_read_b64_tr_b16 v[226:227], v16 offset:29184
    v_mfma_f32_16x16x32_bf16 v[132:135], v[164:167], v[192:195], v[132:135]
    ds_read_b64_tr_b16 v[228:229], v17 offset:28672
    v_mfma_f32_16x16x32_bf16 v[148:151], v[164:167], v[196:199], v[148:151]
    v_mfma_f32_16x16x32_bf16 v[72:75], v[176:179], v[168:171], v[72:75]
    ds_read_b64_tr_b16 v[230:231], v17 offset:29184
    v_mfma_f32_16x16x32_bf16 v[88:91], v[180:183], v[168:171], v[88:91]
    ds_read_b64_tr_b16 v[232:233], v16 offset:32768
    v_mfma_f32_16x16x32_bf16 v[104:107], v[184:187], v[168:171], v[104:107]
    ds_read_b64_tr_b16 v[234:235], v16 offset:33280
    v_mfma_f32_16x16x32_bf16 v[120:123], v[188:191], v[168:171], v[120:123]
    v_mfma_f32_16x16x32_bf16 v[136:139], v[168:171], v[192:195], v[136:139]
    ds_read_b64_tr_b16 v[236:237], v17 offset:32768
    v_mfma_f32_16x16x32_bf16 v[152:155], v[168:171], v[196:199], v[152:155]
    ds_read_b64_tr_b16 v[238:239], v17 offset:33280
    v_mfma_f32_16x16x32_bf16 v[76:79], v[176:179], v[172:175], v[76:79]
    ds_read_b128 v[204:207], v13 offset:2048
    v_mfma_f32_16x16x32_bf16 v[92:95], v[180:183], v[172:175], v[92:95]
    v_mfma_f32_16x16x32_bf16 v[108:111], v[184:187], v[172:175], v[108:111]
    ds_read_b128 v[208:211], v13 offset:4096
    v_mfma_f32_16x16x32_bf16 v[124:127], v[188:191], v[172:175], v[124:127]
    ds_read_b128 v[212:215], v13 offset:6144
    v_mfma_f32_16x16x32_bf16 v[140:143], v[172:175], v[192:195], v[140:143]
    v_mfma_f32_16x16x32_bf16 v[156:159], v[172:175], v[196:199], v[156:159]
    s_waitcnt lgkmcnt(0)
    v_mfma_f32_16x16x32_bf16 v[64:67], v[216:219], v[200:203], v[64:67]
    v_mfma_f32_16x16x32_bf16 v[80:83], v[220:223], v[200:203], v[80:83]
    v_mfma_f32_16x16x32_bf16 v[96:99], v[224:227], v[200:203], v[96:99]
    v_mfma_f32_16x16x32_bf16 v[112:115], v[228:231], v[200:203], v[112:115]
    v_mfma_f32_16x16x32_bf16 v[128:131], v[200:203], v[232:235], v[128:131]
    v_mfma_f32_16x16x32_bf16 v[144:147], v[200:203], v[236:239], v[144:147]
    v_mfma_f32_16x16x32_bf16 v[68:71], v[216:219], v[204:207], v[68:71]
    v_mfma_f32_16x16x32_bf16 v[84:87], v[220:223], v[204:207], v[84:87]
    v_mfma_f32_16x16x32_bf16 v[100:103], v[224:227], v[204:207], v[100:103]
    v_mfma_f32_16x16x32_bf16 v[116:119], v[228:231], v[204:207], v[116:119]
    v_mfma_f32_16x16x32_bf16 v[132:135], v[204:207], v[232:235], v[132:135]
    v_mfma_f32_16x16x32_bf16 v[148:151], v[204:207], v[236:239], v[148:151]
    v_mfma_f32_16x16x32_bf16 v[72:75], v[216:219], v[208:211], v[72:75]
    v_mfma_f32_16x16x32_bf16 v[88:91], v[220:223], v[208:211], v[88:91]
    v_mfma_f32_16x16x32_bf16 v[104:107], v[224:227], v[208:211], v[104:107]
    v_mfma_f32_16x16x32_bf16 v[120:123], v[228:231], v[208:211], v[120:123]
    v_mfma_f32_16x16x32_bf16 v[136:139], v[208:211], v[232:235], v[136:139]
    v_mfma_f32_16x16x32_bf16 v[152:155], v[208:211], v[236:239], v[152:155]
    v_mfma_f32_16x16x32_bf16 v[76:79], v[216:219], v[212:215], v[76:79]
    v_mfma_f32_16x16x32_bf16 v[92:95], v[220:223], v[212:215], v[92:95]
    v_mfma_f32_16x16x32_bf16 v[108:111], v[224:227], v[212:215], v[108:111]
    v_mfma_f32_16x16x32_bf16 v[124:127], v[228:231], v[212:215], v[124:127]
    v_mfma_f32_16x16x32_bf16 v[140:143], v[212:215], v[232:235], v[140:143]
    v_mfma_f32_16x16x32_bf16 v[156:159], v[212:215], v[236:239], v[156:159]
    s_waitcnt vmcnt(0)
    s_barrier
    s_cmp_lg_u32 s29, 0
    s_cbranch_scc1 gated_mix__softmax_full_mha__linear_kernel_hedgehog__prompt_kernel_p1_epiB
    v_lshrrev_b32 v21, 4, v19
    v_and_b32 v20, 15, v19
    s_lshl_b32 s3, s30, 17
    s_lshl_b32 s4, s20, 2
    s_lshl_b32 s5, s27, 1
    s_add_u32 s4, s4, s5
    s_lshl_b32 s4, s4, 11
    s_add_u32 s38, s3, s4
    s_add_u32 s39, s38, 4194304
    s_add_u32 s42, s38, 8388608
    v_lshrrev_b32 v22, 1, v21
    v_lshlrev_b32 v22, 10, v22
    v_and_b32 v24, 1, v21
    v_lshl_add_u32 v22, v24, 9, v22
    v_lshl_add_u32 v17, v20, 4, v22
    v_and_b32 v24, 7, v20
    v_lshrrev_b32 v25, 3, v20
    v_lshl_add_u32 v24, v25, 4, v24
    v_lshl_add_u32 v16, v24, 4, v22
    s_mov_b32 s6, 1048744942
    s_mov_b32 s7, 1048744942
    v_cvt_pk_bf16_f32 v96, v96, v97
    v_cvt_pk_bf16_f32 v97, v98, v99
    v_cvt_pk_bf16_f32 v98, v112, v113
    v_cvt_pk_bf16_f32 v99, v114, v115
    buffer_store_dwordx4 v[96:99], v16, s[16:19], s39 offen offset:0 sc1
    v_cvt_pk_bf16_f32 v100, v100, v101
    v_cvt_pk_bf16_f32 v101, v102, v103
    v_cvt_pk_bf16_f32 v102, v116, v117
    v_cvt_pk_bf16_f32 v103, v118, v119
    buffer_store_dwordx4 v[100:103], v16, s[16:19], s39 offen offset:128 sc1
    v_cvt_pk_bf16_f32 v104, v104, v105
    v_cvt_pk_bf16_f32 v105, v106, v107
    v_cvt_pk_bf16_f32 v106, v120, v121
    v_cvt_pk_bf16_f32 v107, v122, v123
    buffer_store_dwordx4 v[104:107], v16, s[16:19], s39 offen offset:2048 sc1
    v_cvt_pk_bf16_f32 v108, v108, v109
    v_cvt_pk_bf16_f32 v109, v110, v111
    v_cvt_pk_bf16_f32 v110, v124, v125
    v_cvt_pk_bf16_f32 v111, v126, v127
    buffer_store_dwordx4 v[108:111], v16, s[16:19], s39 offen offset:2176 sc1
    v_cvt_pk_bf16_f32 v128, v128, v129
    v_cvt_pk_bf16_f32 v129, v130, v131
    v_cvt_pk_bf16_f32 v130, v132, v133
    v_cvt_pk_bf16_f32 v131, v134, v135
    buffer_store_dwordx4 v[128:131], v17, s[16:19], s42 offen offset:0 sc1
    v_cvt_pk_bf16_f32 v144, v144, v145
    v_cvt_pk_bf16_f32 v145, v146, v147
    v_cvt_pk_bf16_f32 v146, v148, v149
    v_cvt_pk_bf16_f32 v147, v150, v151
    buffer_store_dwordx4 v[144:147], v17, s[16:19], s42 offen offset:256 sc1
    v_cvt_pk_bf16_f32 v136, v136, v137
    v_cvt_pk_bf16_f32 v137, v138, v139
    v_cvt_pk_bf16_f32 v138, v140, v141
    v_cvt_pk_bf16_f32 v139, v142, v143
    buffer_store_dwordx4 v[136:139], v17, s[16:19], s42 offen offset:2048 sc1
    v_cvt_pk_bf16_f32 v152, v152, v153
    v_cvt_pk_bf16_f32 v153, v154, v155
    v_cvt_pk_bf16_f32 v154, v156, v157
    v_cvt_pk_bf16_f32 v155, v158, v159
    buffer_store_dwordx4 v[152:155], v17, s[16:19], s42 offen offset:2304 sc1
    v_pk_mul_f32 v[64:65], v[64:65], s[6:7]
    v_pk_mul_f32 v[66:67], v[66:67], s[6:7]
    v_pk_mul_f32 v[80:81], v[80:81], s[6:7]
    v_pk_mul_f32 v[82:83], v[82:83], s[6:7]
    v_cvt_pk_bf16_f32 v64, v64, v65
    v_cvt_pk_bf16_f32 v65, v66, v67
    v_cvt_pk_bf16_f32 v66, v80, v81
    v_cvt_pk_bf16_f32 v67, v82, v83
    buffer_store_dwordx4 v[64:67], v17, s[16:19], s38 offen offset:0 sc1
    v_pk_mul_f32 v[68:69], v[68:69], s[6:7]
    v_pk_mul_f32 v[70:71], v[70:71], s[6:7]
    v_pk_mul_f32 v[84:85], v[84:85], s[6:7]
    v_pk_mul_f32 v[86:87], v[86:87], s[6:7]
    v_cvt_pk_bf16_f32 v68, v68, v69
    v_cvt_pk_bf16_f32 v69, v70, v71
    v_cvt_pk_bf16_f32 v70, v84, v85
    v_cvt_pk_bf16_f32 v71, v86, v87
    buffer_store_dwordx4 v[68:71], v17, s[16:19], s38 offen offset:256 sc1
    v_pk_mul_f32 v[72:73], v[72:73], s[6:7]
    v_pk_mul_f32 v[74:75], v[74:75], s[6:7]
    v_pk_mul_f32 v[88:89], v[88:89], s[6:7]
    v_pk_mul_f32 v[90:91], v[90:91], s[6:7]
    v_cvt_pk_bf16_f32 v72, v72, v73
    v_cvt_pk_bf16_f32 v73, v74, v75
    v_cvt_pk_bf16_f32 v74, v88, v89
    v_cvt_pk_bf16_f32 v75, v90, v91
    buffer_store_dwordx4 v[72:75], v17, s[16:19], s38 offen offset:2048 sc1
    v_pk_mul_f32 v[76:77], v[76:77], s[6:7]
    v_pk_mul_f32 v[78:79], v[78:79], s[6:7]
    v_pk_mul_f32 v[92:93], v[92:93], s[6:7]
    v_pk_mul_f32 v[94:95], v[94:95], s[6:7]
    v_cvt_pk_bf16_f32 v76, v76, v77
    v_cvt_pk_bf16_f32 v77, v78, v79
    v_cvt_pk_bf16_f32 v78, v92, v93
    v_cvt_pk_bf16_f32 v79, v94, v95
    buffer_store_dwordx4 v[76:79], v17, s[16:19], s38 offen offset:2304 sc1
    s_lshl_b32 s95, s21, 7
    s_lshl_b32 s3, s20, 2
    s_add_u32 s95, s95, s3
    s_load_dwordx2 s[4:5], s[0:1], 80
    s_load_dwordx2 s[34:35], s[0:1], 40
    s_load_dwordx2 s[66:67], s[0:1], 16
    s_load_dwordx2 s[68:69], s[0:1], 48
    s_load_dwordx2 s[72:73], s[0:1], 64
    s_and_b32 s3, s2, 7
    s_lshr_b32 s6, s2, 3
    s_lshl_b32 s20, s3, 2
    s_lshr_b32 s7, s6, 3
    s_add_u32 s20, s20, s7
    s_and_b32 s21, s6, 7
    v_lshrrev_b32 v2, 6, v0
    v_and_b32 v3, 63, v0
    v_lshlrev_b32 v1, 4, v3
    v_readfirstlane_b32 s22, v2
    s_waitcnt lgkmcnt(0)
    s_mov_b32 s8, s4
    s_and_b32 s9, s5, 0xffff
    s_mov_b32 s10, 268435456
    s_mov_b32 s11, 0x00020000
    s_mov_b32 s28, s34
    s_and_b32 s29, s35, 0xffff
    s_mov_b32 s30, 65536
    s_mov_b32 s31, 0x00020000
    s_lshl_b32 s3, s20, 17
    s_add_u32 s6, s3, 4194304
    s_add_u32 s12, s4, s6
    s_addc_u32 s13, s5, 0
    s_and_b32 s13, s13, 0xffff
    s_mov_b32 s14, 131072
    s_mov_b32 s15, 0x00020000
    s_add_u32 s6, s3, 8388608
    s_add_u32 s16, s4, s6
    s_addc_u32 s17, s5, 0
    s_and_b32 s17, s17, 0xffff
    s_mov_b32 s18, 131072
    s_mov_b32 s19, 0x00020000
    s_lshl_b32 s26, s22, 11
    s_and_b32 s27, s22, 3
    s_lshr_b32 s32, s22, 2
    s_lshl_b32 s6, s32, 13
    v_add_u32 v7, s6, v1
    s_lshl_b32 s6, s21, 3
    s_lshl_b32 s7, s27, 1
    s_add_u32 s6, s6, s7
    s_lshl_b32 s7, s6, 11
    s_lshl_b32 s3, s20, 17
    s_add_u32 s7, s7, s3
    s_add_u32 s7, s7, 0
    s_mov_b32 s25, 0
    s_mov_b32 s23, s26
    s_waitcnt vmcnt(0)
    s_mov_b64 exec, 1
    v_mov_b32 v20, 163776
    v_mov_b32 v21, 1
    ds_add_rtn_u32 v21, v20, v21
    s_waitcnt lgkmcnt(0)
    v_readfirstlane_b32 s3, v21
    s_cmp_lg_u32 s3, 3
    s_cbranch_scc1 gated_mix__softmax_full_mha__linear_kernel_hedgehog__prompt_kernel_p1_nof1
    s_add_u32 s3, s95, 24150016
    v_mov_b32 v20, 0
    v_mov_b32 v21, 1
    buffer_store_dword v21, v20, s[8:11], s3 offen sc1
gated_mix__softmax_full_mha__linear_kernel_hedgehog__prompt_kernel_p1_nof1:
    s_mov_b64 exec, -1
    s_barrier
    s_cmp_lg_u32 s22, 0
    s_cbranch_scc1 gated_mix__softmax_full_mha__linear_kernel_hedgehog__prompt_kernel_p1_w1
    s_lshr_b32 s37, s20, 1
    s_lshl_b32 s37, s37, 7
    s_add_u32 s37, s37, 24150016
    s_mov_b64 exec, 0xffff
    v_and_b32 v216, 15, v0
    v_lshlrev_b32 v216, 2, v216
    s_mov_b32 s36, 131072
gated_mix__softmax_full_mha__linear_kernel_hedgehog__prompt_kernel_f1:
    buffer_load_dword v217, v216, s[8:11], s37 offen sc1
    s_waitcnt vmcnt(0)
    v_cmp_eq_u32 vcc, 1, v217
    s_sub_u32 s36, s36, 1
    s_cmp_eq_u32 s36, 0
    s_cbranch_scc1 gated_mix__softmax_full_mha__linear_kernel_hedgehog__prompt_kernel_f1_done
    s_cmp_eq_u64 vcc, exec
    s_cbranch_scc1 gated_mix__softmax_full_mha__linear_kernel_hedgehog__prompt_kernel_f1_done
    s_sleep 2
    s_branch gated_mix__softmax_full_mha__linear_kernel_hedgehog__prompt_kernel_f1
gated_mix__softmax_full_mha__linear_kernel_hedgehog__prompt_kernel_f1_done:
    s_mov_b64 exec, -1
gated_mix__softmax_full_mha__linear_kernel_hedgehog__prompt_kernel_p1_w1:
    s_branch gated_mix__softmax_full_mha__linear_kernel_hedgehog__prompt_kernel_p1_epidone
gated_mix__softmax_full_mha__linear_kernel_hedgehog__prompt_kernel_p1_epiB:
    v_lshrrev_b32 v21, 4, v19
    v_and_b32 v20, 15, v19
    s_and_b32 s7, s22, 3
    v_bfe_u32 v22, v19, 2, 2
    v_lshl_add_u32 v22, v21, 2, v22
    v_mul_u32_u24 v23, 136, v22
    v_lshlrev_b32 v22, 6, v22
    v_and_b32 v24, 3, v19
    v_lshl_add_u32 v22, v24, 3, v22
    s_lshl_b32 s3, s28, 11
    s_add_u32 s3, s3, 147456
    v_add_u32 v22, s3, v22
    s_mul_i32 s3, s7, 8704
    v_lshl_add_u32 v23, v24, 3, v23
    v_add_u32 v23, s3, v23
    v_mul_u32_u24 v18, 136, v20
    v_lshl_add_u32 v18, v21, 3, v18
    v_add_u32 v18, s3, v18
    v_lshlrev_b32 v15, 4, v19
    v_cvt_pk_bf16_f32 v96, v96, v97
    v_cvt_pk_bf16_f32 v97, v98, v99
    v_cvt_pk_bf16_f32 v98, v112, v113
    v_cvt_pk_bf16_f32 v99, v114, v115
    v_cvt_pk_bf16_f32 v100, v100, v101
    v_cvt_pk_bf16_f32 v101, v102, v103
    v_cvt_pk_bf16_f32 v102, v116, v117
    v_cvt_pk_bf16_f32 v103, v118, v119
    v_cvt_pk_bf16_f32 v104, v104, v105
    v_cvt_pk_bf16_f32 v105, v106, v107
    v_cvt_pk_bf16_f32 v106, v120, v121
    v_cvt_pk_bf16_f32 v107, v122, v123
    v_cvt_pk_bf16_f32 v108, v108, v109
    v_cvt_pk_bf16_f32 v109, v110, v111
    v_cvt_pk_bf16_f32 v110, v124, v125
    v_cvt_pk_bf16_f32 v111, v126, v127
    v_cvt_pk_bf16_f32 v64, v64, v65
    v_cvt_pk_bf16_f32 v65, v66, v67
    v_cvt_pk_bf16_f32 v66, v80, v81
    v_cvt_pk_bf16_f32 v67, v82, v83
    v_cvt_pk_bf16_f32 v68, v68, v69
    v_cvt_pk_bf16_f32 v69, v70, v71
    v_cvt_pk_bf16_f32 v70, v84, v85
    v_cvt_pk_bf16_f32 v71, v86, v87
    v_cvt_pk_bf16_f32 v72, v72, v73
    v_cvt_pk_bf16_f32 v73, v74, v75
    v_cvt_pk_bf16_f32 v74, v88, v89
    v_cvt_pk_bf16_f32 v75, v90, v91
    v_cvt_pk_bf16_f32 v76, v76, v77
    v_cvt_pk_bf16_f32 v77, v78, v79
    v_cvt_pk_bf16_f32 v78, v92, v93
    v_cvt_pk_bf16_f32 v79, v94, v95
    s_lshl_b32 s3, s30, 17
    s_lshl_b32 s4, s20, 3
    s_lshl_b32 s5, s27, 2
    s_add_u32 s4, s4, s5
    s_lshl_b32 s4, s4, 10
    s_add_u32 s43, s3, s4
    s_add_u32 s43, s43, 12582912
    ds_read_b64_tr_b16 v[48:49], v22 offset:0
    ds_read_b64_tr_b16 v[50:51], v22 offset:1024
    ds_read_b64_tr_b16 v[52:53], v22 offset:32
    ds_read_b64_tr_b16 v[54:55], v22 offset:1056
    v_mov_b32 v56, 0x3f803f80
    v_mov_b32 v57, v56
    v_mov_b32 v58, v56
    v_mov_b32 v59, v56
    v_cvt_pk_bf16_f32 v128, v128, v129
    v_cvt_pk_bf16_f32 v129, v130, v131
    v_cvt_pk_bf16_f32 v130, v132, v133
    v_cvt_pk_bf16_f32 v131, v134, v135
    v_cvt_pk_bf16_f32 v136, v136, v137
    v_cvt_pk_bf16_f32 v137, v138, v139
    v_cvt_pk_bf16_f32 v138, v140, v141
    v_cvt_pk_bf16_f32 v139, v142, v143
    v_cvt_pk_bf16_f32 v144, v144, v145
    v_cvt_pk_bf16_f32 v145, v146, v147
    v_cvt_pk_bf16_f32 v146, v148, v149
    v_cvt_pk_bf16_f32 v147, v150, v151
    v_cvt_pk_bf16_f32 v152, v152, v153
    v_cvt_pk_bf16_f32 v153, v154, v155
    v_cvt_pk_bf16_f32 v154, v156, v157
    v_cvt_pk_bf16_f32 v155, v158, v159
    s_mov_b32 s36, 1069066811
    s_mov_b32 s37, 1069066811
    s_mov_b32 s40, 3216550459
    s_mov_b32 s41, 3216550459
    s_waitcnt lgkmcnt(0)
    v_mfma_f32_16x16x32_bf16 v[160:163], v[48:51], v[96:99], 0
    v_mfma_f32_16x16x32_bf16 v[164:167], v[52:55], v[96:99], 0
    v_mfma_f32_16x16x32_bf16 v[168:171], v[48:51], v[100:103], 0
    v_mfma_f32_16x16x32_bf16 v[172:175], v[52:55], v[100:103], 0
    v_mfma_f32_16x16x32_bf16 v[176:179], v[48:51], v[104:107], 0
    v_mfma_f32_16x16x32_bf16 v[180:183], v[52:55], v[104:107], 0
    v_mfma_f32_16x16x32_bf16 v[184:187], v[48:51], v[108:111], 0
    v_mfma_f32_16x16x32_bf16 v[188:191], v[52:55], v[108:111], 0
    s_nop 7
    v_max3_f32 v24, v160, v161, v162
    v_min3_f32 v32, v160, v161, v162
    v_max3_f32 v26, v168, v169, v170
    v_min3_f32 v34, v168, v169, v170
    v_max3_f32 v28, v176, v177, v178
    v_min3_f32 v36, v176, v177, v178
    v_max3_f32 v30, v184, v185, v186
    v_min3_f32 v38, v184, v185, v186
    v_max3_f32 v24, v24, v163, v164
    v_min3_f32 v32, v32, v163, v164
    v_max3_f32 v26, v26, v171, v172
    v_min3_f32 v34, v34, v171, v172
    v_max3_f32 v28, v28, v179, v180
    v_min3_f32 v36, v36, v179, v180
    v_max3_f32 v30, v30, v187, v188
    v_min3_f32 v38, v38, v187, v188
    v_max3_f32 v24, v24, v165, v166
    v_min3_f32 v32, v32, v165, v166
    v_max3_f32 v26, v26, v173, v174
    v_min3_f32 v34, v34, v173, v174
    v_max3_f32 v28, v28, v181, v182
    v_min3_f32 v36, v36, v181, v182
    v_max3_f32 v30, v30, v189, v190
    v_min3_f32 v38, v38, v189, v190
    v_max_f32 v24, v24, v167
    v_min_f32 v32, v32, v167
    v_max_f32 v26, v26, v175
    v_min_f32 v34, v34, v175
    v_max_f32 v28, v28, v183
    v_min_f32 v36, v36, v183
    v_max_f32 v30, v30, v191
    v_min_f32 v38, v38, v191
    v_sub_f32 v32, 0, v32
    v_sub_f32 v34, 0, v34
    v_sub_f32 v36, 0, v36
    v_sub_f32 v38, 0, v38
    s_nop 1
    v_permlane32_swap_b32 v24, v32
    v_permlane32_swap_b32 v26, v34
    v_permlane32_swap_b32 v28, v36
    v_permlane32_swap_b32 v30, v38
    s_nop 1
    v_max_f32 v24, v24, v32
    v_max_f32 v26, v26, v34
    v_max_f32 v28, v28, v36
    v_max_f32 v30, v30, v38
    v_mov_b32 v40, v24
    v_mov_b32 v41, v26
    v_mov_b32 v42, v28
    v_mov_b32 v43, v30
    s_nop 1
    v_permlane16_swap_b32 v24, v40
    v_permlane16_swap_b32 v26, v41
    v_permlane16_swap_b32 v28, v42
    v_permlane16_swap_b32 v30, v43
    s_nop 1
    v_max_f32 v24, v24, v40
    v_max_f32 v26, v26, v41
    v_max_f32 v28, v28, v42
    v_max_f32 v30, v30, v43
    v_mov_b32 v32, v24
    v_mov_b32 v34, v26
    v_mov_b32 v36, v28
    v_mov_b32 v38, v30
    s_nop 1
    v_permlane32_swap_b32 v24, v32
    v_permlane32_swap_b32 v26, v34
    v_permlane32_swap_b32 v28, v36
    v_permlane32_swap_b32 v30, v38
    s_nop 1
    v_mul_f32 v24, s40, v24
    v_mul_f32 v32, s40, v32
    v_mul_f32 v26, s40, v26
    v_mul_f32 v34, s40, v34
    v_mul_f32 v28, s40, v28
    v_mul_f32 v36, s40, v36
    v_mul_f32 v30, s40, v30
    v_mul_f32 v38, s40, v38
    v_pk_fma_f32 v[192:193], v[160:161], s[36:37], v[24:25] op_sel_hi:[1,1,0]
    v_pk_fma_f32 v[160:161], v[160:161], s[40:41], v[32:33] op_sel_hi:[1,1,0]
    v_pk_fma_f32 v[194:195], v[162:163], s[36:37], v[24:25] op_sel_hi:[1,1,0]
    v_pk_fma_f32 v[162:163], v[162:163], s[40:41], v[32:33] op_sel_hi:[1,1,0]
    v_pk_fma_f32 v[196:197], v[164:165], s[36:37], v[24:25] op_sel_hi:[1,1,0]
    v_pk_fma_f32 v[164:165], v[164:165], s[40:41], v[32:33] op_sel_hi:[1,1,0]
    v_pk_fma_f32 v[198:199], v[166:167], s[36:37], v[24:25] op_sel_hi:[1,1,0]
    v_pk_fma_f32 v[166:167], v[166:167], s[40:41], v[32:33] op_sel_hi:[1,1,0]
    v_pk_fma_f32 v[200:201], v[168:169], s[36:37], v[26:27] op_sel_hi:[1,1,0]
    v_pk_fma_f32 v[168:169], v[168:169], s[40:41], v[34:35] op_sel_hi:[1,1,0]
    v_pk_fma_f32 v[202:203], v[170:171], s[36:37], v[26:27] op_sel_hi:[1,1,0]
    v_pk_fma_f32 v[170:171], v[170:171], s[40:41], v[34:35] op_sel_hi:[1,1,0]
    v_pk_fma_f32 v[204:205], v[172:173], s[36:37], v[26:27] op_sel_hi:[1,1,0]
    v_pk_fma_f32 v[172:173], v[172:173], s[40:41], v[34:35] op_sel_hi:[1,1,0]
    v_pk_fma_f32 v[206:207], v[174:175], s[36:37], v[26:27] op_sel_hi:[1,1,0]
    v_pk_fma_f32 v[174:175], v[174:175], s[40:41], v[34:35] op_sel_hi:[1,1,0]
    v_pk_fma_f32 v[208:209], v[176:177], s[36:37], v[28:29] op_sel_hi:[1,1,0]
    v_pk_fma_f32 v[176:177], v[176:177], s[40:41], v[36:37] op_sel_hi:[1,1,0]
    v_pk_fma_f32 v[210:211], v[178:179], s[36:37], v[28:29] op_sel_hi:[1,1,0]
    v_pk_fma_f32 v[178:179], v[178:179], s[40:41], v[36:37] op_sel_hi:[1,1,0]
    v_pk_fma_f32 v[212:213], v[180:181], s[36:37], v[28:29] op_sel_hi:[1,1,0]
    v_pk_fma_f32 v[180:181], v[180:181], s[40:41], v[36:37] op_sel_hi:[1,1,0]
    v_pk_fma_f32 v[214:215], v[182:183], s[36:37], v[28:29] op_sel_hi:[1,1,0]
    v_pk_fma_f32 v[182:183], v[182:183], s[40:41], v[36:37] op_sel_hi:[1,1,0]
    v_pk_fma_f32 v[216:217], v[184:185], s[36:37], v[30:31] op_sel_hi:[1,1,0]
    v_pk_fma_f32 v[184:185], v[184:185], s[40:41], v[38:39] op_sel_hi:[1,1,0]
    v_pk_fma_f32 v[218:219], v[186:187], s[36:37], v[30:31] op_sel_hi:[1,1,0]
    v_pk_fma_f32 v[186:187], v[186:187], s[40:41], v[38:39] op_sel_hi:[1,1,0]
    v_pk_fma_f32 v[220:221], v[188:189], s[36:37], v[30:31] op_sel_hi:[1,1,0]
    v_pk_fma_f32 v[188:189], v[188:189], s[40:41], v[38:39] op_sel_hi:[1,1,0]
    v_pk_fma_f32 v[222:223], v[190:191], s[36:37], v[30:31] op_sel_hi:[1,1,0]
    v_pk_fma_f32 v[190:191], v[190:191], s[40:41], v[38:39] op_sel_hi:[1,1,0]
    v_exp_f32 v192, v192
    v_exp_f32 v160, v160
    v_exp_f32 v193, v193
    v_exp_f32 v161, v161
    v_exp_f32 v194, v194
    v_exp_f32 v162, v162
    v_exp_f32 v195, v195
    v_exp_f32 v163, v163
    v_exp_f32 v196, v196
    v_exp_f32 v164, v164
    v_exp_f32 v197, v197
    v_exp_f32 v165, v165
    v_exp_f32 v198, v198
    v_exp_f32 v166, v166
    v_exp_f32 v199, v199
    v_exp_f32 v167, v167
    v_exp_f32 v200, v200
    v_exp_f32 v168, v168
    v_exp_f32 v201, v201
    v_exp_f32 v169, v169
    v_exp_f32 v202, v202
    v_exp_f32 v170, v170
    v_exp_f32 v203, v203
    v_exp_f32 v171, v171
    v_exp_f32 v204, v204
    v_exp_f32 v172, v172
    v_exp_f32 v205, v205
    v_exp_f32 v173, v173
    v_exp_f32 v206, v206
    v_exp_f32 v174, v174
    v_exp_f32 v207, v207
    v_exp_f32 v175, v175
    v_exp_f32 v208, v208
    v_exp_f32 v176, v176
    v_exp_f32 v209, v209
    v_exp_f32 v177, v177
    v_exp_f32 v210, v210
    v_exp_f32 v178, v178
    v_exp_f32 v211, v211
    v_exp_f32 v179, v179
    v_exp_f32 v212, v212
    v_exp_f32 v180, v180
    v_exp_f32 v213, v213
    v_exp_f32 v181, v181
    v_exp_f32 v214, v214
    v_exp_f32 v182, v182
    v_exp_f32 v215, v215
    v_exp_f32 v183, v183
    v_exp_f32 v216, v216
    v_exp_f32 v184, v184
    v_exp_f32 v217, v217
    v_exp_f32 v185, v185
    v_exp_f32 v218, v218
    v_exp_f32 v186, v186
    v_exp_f32 v219, v219
    v_exp_f32 v187, v187
    v_exp_f32 v220, v220
    v_exp_f32 v188, v188
    v_exp_f32 v221, v221
    v_exp_f32 v189, v189
    v_exp_f32 v222, v222
    v_exp_f32 v190, v190
    v_exp_f32 v223, v223
    v_exp_f32 v191, v191
    s_nop 0
    v_cvt_pk_bf16_f32 v80, v192, v193
    v_cvt_pk_bf16_f32 v112, v160, v161
    v_cvt_pk_bf16_f32 v81, v194, v195
    v_cvt_pk_bf16_f32 v113, v162, v163
    v_cvt_pk_bf16_f32 v82, v196, v197
    v_cvt_pk_bf16_f32 v114, v164, v165
    v_cvt_pk_bf16_f32 v83, v198, v199
    v_cvt_pk_bf16_f32 v115, v166, v167
    v_cvt_pk_bf16_f32 v84, v200, v201
    v_cvt_pk_bf16_f32 v116, v168, v169
    v_cvt_pk_bf16_f32 v85, v202, v203
    v_cvt_pk_bf16_f32 v117, v170, v171
    v_cvt_pk_bf16_f32 v86, v204, v205
    v_cvt_pk_bf16_f32 v118, v172, v173
    v_cvt_pk_bf16_f32 v87, v206, v207
    v_cvt_pk_bf16_f32 v119, v174, v175
    v_cvt_pk_bf16_f32 v88, v208, v209
    v_cvt_pk_bf16_f32 v120, v176, v177
    v_cvt_pk_bf16_f32 v89, v210, v211
    v_cvt_pk_bf16_f32 v121, v178, v179
    v_cvt_pk_bf16_f32 v90, v212, v213
    v_cvt_pk_bf16_f32 v122, v180, v181
    v_cvt_pk_bf16_f32 v91, v214, v215
    v_cvt_pk_bf16_f32 v123, v182, v183
    v_cvt_pk_bf16_f32 v92, v216, v217
    v_cvt_pk_bf16_f32 v124, v184, v185
    v_cvt_pk_bf16_f32 v93, v218, v219
    v_cvt_pk_bf16_f32 v125, v186, v187
    v_cvt_pk_bf16_f32 v94, v220, v221
    v_cvt_pk_bf16_f32 v126, v188, v189
    v_cvt_pk_bf16_f32 v95, v222, v223
    v_cvt_pk_bf16_f32 v127, v190, v191
    s_nop 1
    v_mfma_f32_16x16x32_bf16 v[132:135], v[56:59], v[80:83], 0
    v_mfma_f32_16x16x32_bf16 v[224:227], v[56:59], v[112:115], 0
    v_mfma_f32_16x16x32_bf16 v[140:143], v[56:59], v[84:87], 0
    v_mfma_f32_16x16x32_bf16 v[228:231], v[56:59], v[116:119], 0
    v_mfma_f32_16x16x32_bf16 v[148:151], v[56:59], v[88:91], 0
    v_mfma_f32_16x16x32_bf16 v[232:235], v[56:59], v[120:123], 0
    v_mfma_f32_16x16x32_bf16 v[156:159], v[56:59], v[92:95], 0
    v_mfma_f32_16x16x32_bf16 v[236:239], v[56:59], v[124:127], 0
    s_nop 7
    v_rcp_f32 v132, v132
    v_rcp_f32 v224, v224
    v_rcp_f32 v140, v140
    v_rcp_f32 v228, v228
    v_rcp_f32 v148, v148
    v_rcp_f32 v232, v232
    v_rcp_f32 v156, v156
    v_rcp_f32 v236, v236
    s_nop 0
    v_pk_mul_f32 v[192:193], v[192:193], v[132:133] op_sel_hi:[1,0]
    v_pk_mul_f32 v[160:161], v[160:161], v[224:225] op_sel_hi:[1,0]
    v_pk_mul_f32 v[194:195], v[194:195], v[132:133] op_sel_hi:[1,0]
    v_pk_mul_f32 v[162:163], v[162:163], v[224:225] op_sel_hi:[1,0]
    v_pk_mul_f32 v[196:197], v[196:197], v[132:133] op_sel_hi:[1,0]
    v_pk_mul_f32 v[164:165], v[164:165], v[224:225] op_sel_hi:[1,0]
    v_pk_mul_f32 v[198:199], v[198:199], v[132:133] op_sel_hi:[1,0]
    v_pk_mul_f32 v[166:167], v[166:167], v[224:225] op_sel_hi:[1,0]
    v_pk_mul_f32 v[200:201], v[200:201], v[140:141] op_sel_hi:[1,0]
    v_pk_mul_f32 v[168:169], v[168:169], v[228:229] op_sel_hi:[1,0]
    v_pk_mul_f32 v[202:203], v[202:203], v[140:141] op_sel_hi:[1,0]
    v_pk_mul_f32 v[170:171], v[170:171], v[228:229] op_sel_hi:[1,0]
    v_pk_mul_f32 v[204:205], v[204:205], v[140:141] op_sel_hi:[1,0]
    v_pk_mul_f32 v[172:173], v[172:173], v[228:229] op_sel_hi:[1,0]
    v_pk_mul_f32 v[206:207], v[206:207], v[140:141] op_sel_hi:[1,0]
    v_pk_mul_f32 v[174:175], v[174:175], v[228:229] op_sel_hi:[1,0]
    v_pk_mul_f32 v[208:209], v[208:209], v[148:149] op_sel_hi:[1,0]
    v_pk_mul_f32 v[176:177], v[176:177], v[232:233] op_sel_hi:[1,0]
    v_pk_mul_f32 v[210:211], v[210:211], v[148:149] op_sel_hi:[1,0]
    v_pk_mul_f32 v[178:179], v[178:179], v[232:233] op_sel_hi:[1,0]
    v_pk_mul_f32 v[212:213], v[212:213], v[148:149] op_sel_hi:[1,0]
    v_pk_mul_f32 v[180:181], v[180:181], v[232:233] op_sel_hi:[1,0]
    v_pk_mul_f32 v[214:215], v[214:215], v[148:149] op_sel_hi:[1,0]
    v_pk_mul_f32 v[182:183], v[182:183], v[232:233] op_sel_hi:[1,0]
    v_pk_mul_f32 v[216:217], v[216:217], v[156:157] op_sel_hi:[1,0]
    v_pk_mul_f32 v[184:185], v[184:185], v[236:237] op_sel_hi:[1,0]
    v_pk_mul_f32 v[218:219], v[218:219], v[156:157] op_sel_hi:[1,0]
    v_pk_mul_f32 v[186:187], v[186:187], v[236:237] op_sel_hi:[1,0]
    v_pk_mul_f32 v[220:221], v[220:221], v[156:157] op_sel_hi:[1,0]
    v_pk_mul_f32 v[188:189], v[188:189], v[236:237] op_sel_hi:[1,0]
    v_pk_mul_f32 v[222:223], v[222:223], v[156:157] op_sel_hi:[1,0]
    v_pk_mul_f32 v[190:191], v[190:191], v[236:237] op_sel_hi:[1,0]
    v_cvt_pk_bf16_f32 v80, v192, v193
    v_cvt_pk_bf16_f32 v112, v160, v161
    v_cvt_pk_bf16_f32 v81, v194, v195
    v_cvt_pk_bf16_f32 v113, v162, v163
    v_cvt_pk_bf16_f32 v82, v196, v197
    v_cvt_pk_bf16_f32 v114, v164, v165
    v_cvt_pk_bf16_f32 v83, v198, v199
    v_cvt_pk_bf16_f32 v115, v166, v167
    ds_write_b64 v18, v[80:81] offset:0
    ds_write_b64 v18, v[112:113] offset:64
    ds_write_b64 v18, v[82:83] offset:32
    ds_write_b64 v18, v[114:115] offset:96
    v_cvt_pk_bf16_f32 v84, v200, v201
    v_cvt_pk_bf16_f32 v116, v168, v169
    v_cvt_pk_bf16_f32 v85, v202, v203
    v_cvt_pk_bf16_f32 v117, v170, v171
    v_cvt_pk_bf16_f32 v86, v204, v205
    v_cvt_pk_bf16_f32 v118, v172, v173
    v_cvt_pk_bf16_f32 v87, v206, v207
    v_cvt_pk_bf16_f32 v119, v174, v175
    ds_write_b64 v18, v[84:85] offset:2176
    ds_write_b64 v18, v[116:117] offset:2240
    ds_write_b64 v18, v[86:87] offset:2208
    ds_write_b64 v18, v[118:119] offset:2272
    v_cvt_pk_bf16_f32 v88, v208, v209
    v_cvt_pk_bf16_f32 v120, v176, v177
    v_cvt_pk_bf16_f32 v89, v210, v211
    v_cvt_pk_bf16_f32 v121, v178, v179
    v_cvt_pk_bf16_f32 v90, v212, v213
    v_cvt_pk_bf16_f32 v122, v180, v181
    v_cvt_pk_bf16_f32 v91, v214, v215
    v_cvt_pk_bf16_f32 v123, v182, v183
    ds_write_b64 v18, v[88:89] offset:4352
    ds_write_b64 v18, v[120:121] offset:4416
    ds_write_b64 v18, v[90:91] offset:4384
    ds_write_b64 v18, v[122:123] offset:4448
    v_cvt_pk_bf16_f32 v92, v216, v217
    v_cvt_pk_bf16_f32 v124, v184, v185
    v_cvt_pk_bf16_f32 v93, v218, v219
    v_cvt_pk_bf16_f32 v125, v186, v187
    v_cvt_pk_bf16_f32 v94, v220, v221
    v_cvt_pk_bf16_f32 v126, v188, v189
    v_cvt_pk_bf16_f32 v95, v222, v223
    v_cvt_pk_bf16_f32 v127, v190, v191
    ds_write_b64 v18, v[92:93] offset:6528
    ds_write_b64 v18, v[124:125] offset:6592
    ds_write_b64 v18, v[94:95] offset:6560
    ds_write_b64 v18, v[126:127] offset:6624
    s_waitcnt lgkmcnt(0)
    ds_read_b64_tr_b16 v[160:161], v23 offset:0
    ds_read_b64_tr_b16 v[162:163], v23 offset:2176
    ds_read_b64_tr_b16 v[164:165], v23 offset:4352
    ds_read_b64_tr_b16 v[166:167], v23 offset:6528
    ds_read_b64_tr_b16 v[168:169], v23 offset:32
    ds_read_b64_tr_b16 v[170:171], v23 offset:2208
    ds_read_b64_tr_b16 v[172:173], v23 offset:4384
    ds_read_b64_tr_b16 v[174:175], v23 offset:6560
    ds_read_b64_tr_b16 v[176:177], v23 offset:64
    ds_read_b64_tr_b16 v[178:179], v23 offset:2240
    ds_read_b64_tr_b16 v[180:181], v23 offset:4416
    ds_read_b64_tr_b16 v[182:183], v23 offset:6592
    ds_read_b64_tr_b16 v[184:185], v23 offset:96
    ds_read_b64_tr_b16 v[186:187], v23 offset:2272
    ds_read_b64_tr_b16 v[188:189], v23 offset:4448
    ds_read_b64_tr_b16 v[190:191], v23 offset:6624
    s_mul_i32 s3, s7, 12288
    s_add_u32 s3, s3, 40960
    v_add_u32 v20, s3, v15
    s_and_b32 s4, s7, 2
    s_mul_i32 s4, s4, 12288
    s_mul_i32 s5, s27, 6144
    s_add_u32 s4, s4, s5
    s_add_u32 s4, s4, 40960
    v_add_u32 v22, s4, v15
    s_waitcnt lgkmcnt(12)
    v_mfma_f32_16x16x32_bf16 v[192:195], v[160:163], v[128:131], 0
    v_mfma_f32_16x16x32_bf16 v[196:199], v[160:163], v[144:147], 0
    v_mfma_f32_16x16x32_bf16 v[200:203], v[160:163], v[56:59], 0
    v_mfma_f32_16x16x32_bf16 v[192:195], v[164:167], v[136:139], v[192:195]
    v_mfma_f32_16x16x32_bf16 v[196:199], v[164:167], v[152:155], v[196:199]
    v_mfma_f32_16x16x32_bf16 v[200:203], v[164:167], v[56:59], v[200:203]
    s_waitcnt lgkmcnt(8)
    v_mfma_f32_16x16x32_bf16 v[204:207], v[168:171], v[128:131], 0
    v_mfma_f32_16x16x32_bf16 v[208:211], v[168:171], v[144:147], 0
    v_mfma_f32_16x16x32_bf16 v[212:215], v[168:171], v[56:59], 0
    v_mfma_f32_16x16x32_bf16 v[204:207], v[172:175], v[136:139], v[204:207]
    v_mfma_f32_16x16x32_bf16 v[208:211], v[172:175], v[152:155], v[208:211]
    v_mfma_f32_16x16x32_bf16 v[212:215], v[172:175], v[56:59], v[212:215]
    s_waitcnt lgkmcnt(4)
    v_mfma_f32_16x16x32_bf16 v[216:219], v[176:179], v[128:131], 0
    v_mfma_f32_16x16x32_bf16 v[220:223], v[176:179], v[144:147], 0
    v_mfma_f32_16x16x32_bf16 v[224:227], v[176:179], v[56:59], 0
    v_mfma_f32_16x16x32_bf16 v[216:219], v[180:183], v[136:139], v[216:219]
    v_mfma_f32_16x16x32_bf16 v[220:223], v[180:183], v[152:155], v[220:223]
    v_mfma_f32_16x16x32_bf16 v[224:227], v[180:183], v[56:59], v[224:227]
    s_waitcnt lgkmcnt(0)
    v_mfma_f32_16x16x32_bf16 v[228:231], v[184:187], v[128:131], 0
    v_mfma_f32_16x16x32_bf16 v[232:235], v[184:187], v[144:147], 0
    v_mfma_f32_16x16x32_bf16 v[236:239], v[184:187], v[56:59], 0
    v_mfma_f32_16x16x32_bf16 v[228:231], v[188:191], v[136:139], v[228:231]
    v_mfma_f32_16x16x32_bf16 v[232:235], v[188:191], v[152:155], v[232:235]
    v_mfma_f32_16x16x32_bf16 v[236:239], v[188:191], v[56:59], v[236:239]
    s_lshl_b32 s3, s30, 4
    s_add_u32 s3, s3, s20
    s_lshl_b32 s3, s3, 14
    s_add_u32 s3, s3, 33554432
    s_lshl_b32 s4, s27, 12
    s_add_u32 s4, s4, s3
    s_lshl_b32 s6, s27, 7
    s_add_u32 s6, s6, s3
    s_add_u32 s6, s6, 8192
    v_lshlrev_b32 v21, 4, v21
    ds_write_b128 v20, v[192:195] offset:0
    ds_write_b128 v20, v[196:199] offset:1024
    ds_write_b128 v20, v[200:203] offset:2048
    ds_write_b128 v20, v[204:207] offset:3072
    ds_write_b128 v20, v[208:211] offset:4096
    ds_write_b128 v20, v[212:215] offset:5120
    ds_write_b128 v20, v[216:219] offset:6144
    ds_write_b128 v20, v[220:223] offset:7168
    ds_write_b128 v20, v[224:227] offset:8192
    ds_write_b128 v20, v[228:231] offset:9216
    ds_write_b128 v20, v[232:235] offset:10240
    ds_write_b128 v20, v[236:239] offset:11264
    s_mov_b32 s92, s43
    s_mov_b32 s93, s4
    s_mov_b32 s94, s6
    s_waitcnt lgkmcnt(0)
    s_barrier
    ds_read_b128 v[160:163], v22 offset:0
    ds_read_b128 v[164:167], v22 offset:1024
    ds_read_b128 v[168:171], v22 offset:2048
    ds_read_b128 v[172:175], v22 offset:3072
    ds_read_b128 v[176:179], v22 offset:4096
    ds_read_b128 v[180:183], v22 offset:5120
    ds_read_b128 v[184:187], v22 offset:12288
    ds_read_b128 v[188:191], v22 offset:13312
    ds_read_b128 v[192:195], v22 offset:14336
    ds_read_b128 v[196:199], v22 offset:15360
    ds_read_b128 v[200:203], v22 offset:16384
    ds_read_b128 v[204:207], v22 offset:17408
    s_waitcnt lgkmcnt(0)
    v_pk_add_f32 v[214:215], v[182:183], v[206:207]
    v_pk_add_f32 v[212:213], v[180:181], v[204:205]
    v_pk_add_f32 v[210:211], v[178:179], v[202:203]
    v_pk_add_f32 v[208:209], v[176:177], v[200:201]
    v_pk_add_f32 v[206:207], v[174:175], v[198:199]
    v_pk_add_f32 v[204:205], v[172:173], v[196:197]
    v_pk_add_f32 v[202:203], v[170:171], v[194:195]
    v_pk_add_f32 v[200:201], v[168:169], v[192:193]
    v_pk_add_f32 v[198:199], v[166:167], v[190:191]
    v_pk_add_f32 v[196:197], v[164:165], v[188:189]
    v_pk_add_f32 v[194:195], v[162:163], v[186:187]
    v_pk_add_f32 v[192:193], v[160:161], v[184:185]
    v_mov_b32 v224, v64
    v_mov_b32 v225, v65
    v_mov_b32 v226, v66
    v_mov_b32 v227, v67
    v_mov_b32 v228, v68
    v_mov_b32 v229, v69
    v_mov_b32 v230, v70
    v_mov_b32 v231, v71
    v_mov_b32 v232, v72
    v_mov_b32 v233, v73
    v_mov_b32 v234, v74
    v_mov_b32 v235, v75
    v_mov_b32 v236, v76
    v_mov_b32 v237, v77
    v_mov_b32 v238, v78
    v_mov_b32 v239, v79
    s_lshl_b32 s95, s21, 7
    s_lshl_b32 s3, s20, 2
    s_add_u32 s95, s95, s3
    s_load_dwordx2 s[4:5], s[0:1], 80
    s_load_dwordx2 s[34:35], s[0:1], 40
    s_load_dwordx2 s[66:67], s[0:1], 16
    s_load_dwordx2 s[68:69], s[0:1], 48
    s_load_dwordx2 s[72:73], s[0:1], 64
    s_and_b32 s3, s2, 7
    s_lshr_b32 s6, s2, 3
    s_lshl_b32 s20, s3, 2
    s_lshr_b32 s7, s6, 3
    s_add_u32 s20, s20, s7
    s_and_b32 s21, s6, 7
    v_lshrrev_b32 v2, 6, v0
    v_and_b32 v3, 63, v0
    v_lshlrev_b32 v1, 4, v3
    v_readfirstlane_b32 s22, v2
    s_waitcnt lgkmcnt(0)
    s_mov_b32 s8, s4
    s_and_b32 s9, s5, 0xffff
    s_mov_b32 s10, 268435456
    s_mov_b32 s11, 0x00020000
    s_mov_b32 s28, s34
    s_and_b32 s29, s35, 0xffff
    s_mov_b32 s30, 65536
    s_mov_b32 s31, 0x00020000
    s_lshl_b32 s3, s20, 17
    s_add_u32 s6, s3, 4194304
    s_add_u32 s12, s4, s6
    s_addc_u32 s13, s5, 0
    s_and_b32 s13, s13, 0xffff
    s_mov_b32 s14, 131072
    s_mov_b32 s15, 0x00020000
    s_add_u32 s6, s3, 8388608
    s_add_u32 s16, s4, s6
    s_addc_u32 s17, s5, 0
    s_and_b32 s17, s17, 0xffff
    s_mov_b32 s18, 131072
    s_mov_b32 s19, 0x00020000
    s_lshl_b32 s26, s22, 11
    s_and_b32 s27, s22, 3
    s_lshr_b32 s32, s22, 2
    s_lshl_b32 s6, s32, 13
    v_add_u32 v7, s6, v1
    s_lshl_b32 s6, s21, 3
    s_lshl_b32 s7, s27, 1
    s_add_u32 s6, s6, s7
    s_lshl_b32 s7, s6, 11
    s_lshl_b32 s3, s20, 17
    s_add_u32 s7, s7, s3
    s_add_u32 s7, s7, 0
    s_mov_b32 s25, 0
    s_mov_b32 s23, s26
gated_mix__softmax_full_mha__linear_kernel_hedgehog__prompt_kernel_p1_epidone:
    s_barrier
    s_add_u32 m0, s26, 0
    s_nop 0
    buffer_load_dwordx4 v1, s[12:15], s23 offen offset:0 sc1 lds
    buffer_load_dwordx4 v1, s[12:15], s23 offen offset:1024 sc1 lds
    buffer_load_dwordx4 v[8:11], v1, s[8:11], s7 offen offset:0 sc1
    buffer_load_dwordx4 v[12:15], v1, s[8:11], s7 offen offset:1024 sc1
    buffer_load_dwordx4 v[16:19], v1, s[8:11], s7 offen offset:2048 sc1
    buffer_load_dwordx4 v[20:23], v1, s[8:11], s7 offen offset:3072 sc1
    s_add_u32 m0, s26, 16384
    s_nop 0
    buffer_load_dwordx4 v1, s[16:19], s23 offen offset:0 sc1 lds
    buffer_load_dwordx4 v1, s[16:19], s23 offen offset:1024 sc1 lds
    s_add_u32 s23, s23, 16384
    s_add_u32 s6, s6, s32
    s_lshl_b32 s7, s6, 7
    s_add_u32 s7, s7, 23068672
    v_and_b32 v2, 31, v3
    v_lshlrev_b32 v2, 2, v2
    buffer_load_dword v6, v2, s[8:11], s7 offen sc1
    s_lshl_b32 s6, s20, 18
    s_add_u32 s6, s6, 33554432
    s_add_u32 s44, s4, s6
    s_addc_u32 s45, s5, 0
    s_and_b32 s45, s45, 0xffff
    s_mov_b32 s46, 262144
    s_mov_b32 s47, 0x00020000
    v_lshrrev_b32 v246, 4, v3
    v_lshlrev_b32 v246, 4, v246
    s_lshl_b32 s48, s22, 10
    s_and_b32 s49, s22, 3
    s_lshl_b32 s49, s49, 6
    s_add_u32 s49, s49, 8192
    v_mov_b32 v176, 0
    v_mov_b32 v177, 0
    v_mov_b32 v178, 0
    v_mov_b32 v179, 0
    v_mov_b32 v180, 0
    v_mov_b32 v181, 0
    v_mov_b32 v182, 0
    v_mov_b32 v183, 0
    v_lshrrev_b32 v2, 4, v3
    v_lshrrev_b32 v4, 2, v3
    v_xor_b32 v2, v2, v4
    v_and_b32 v2, 1, v2
    v_mov_b32 v4, 0x3f803f80
    v_cmp_eq_u32 vcc, 0, v2
    s_nop 1
    v_cndmask_b32 v168, 0, v4, vcc
    v_mov_b32 v169, v168
    v_mov_b32 v170, v168
    v_mov_b32 v171, v168
    s_and_b32 s3, s2, 7
    s_lshr_b32 s6, s2, 3
    s_lshr_b32 s7, s3, 1
    s_lshl_b32 s7, s7, 2
    s_and_b32 s60, s6, 3
    s_add_u32 s60, s60, s7
    s_and_b32 s7, s3, 1
    s_lshl_b32 s7, s7, 3
    s_lshr_b32 s61, s6, 2
    s_add_u32 s61, s61, s7
    s_mov_b32 s76, s66
    s_and_b32 s77, s67, 0xffff
    s_mov_b32 s78, 2097152
    s_mov_b32 s79, 0x00020000
    s_mov_b32 s80, s68
    s_and_b32 s81, s69, 0xffff
    s_mov_b32 s82, 2097152
    s_mov_b32 s83, 0x00020000
    s_mov_b32 s52, s72
    s_and_b32 s53, s73, 0xffff
    s_mov_b32 s54, 4194304
    s_mov_b32 s55, 0x00020000
    v_and_b32 v216, 63, v0
    v_lshrrev_b32 v217, 3, v216
    v_and_b32 v218, 7, v216
    v_bfe_u32 v216, v216, 4, 2
    v_lshlrev_b32 v216, 1, v216
    v_xor_b32 v218, v218, v216
    v_lshlrev_b32 v217, 11, v217
    v_lshl_add_u32 v217, v218, 4, v217
    s_lshl_b32 s3, s61, 7
    v_add_u32 v217, s3, v217
    s_lshl_b32 s3, s22, 15
    v_add_u32 v247, s3, v217
    s_add_u32 s3, s3, 15360
    v_add_u32 v248, s3, v217
    s_lshl_b32 s64, s22, 11
    s_lshl_b32 s3, s60, 3
    s_lshl_b32 s6, s27, 1
    s_add_u32 s3, s3, s6
    s_lshl_b32 s3, s3, 10
    s_lshl_b32 s6, s32, 17
    s_add_u32 s3, s3, s6
    s_add_u32 s65, s3, 25165824
    s_lshl_b32 s3, s21, 12
    s_lshl_b32 s6, s20, 2
    s_add_u32 s3, s3, s6
    s_add_u32 s70, s3, 24117248
    s_lshr_b32 s3, s60, 1
    s_lshl_b32 s3, s3, 12
    s_add_u32 s71, s3, 24117248
    s_and_b32 s3, s2, 1
    s_lshl_b32 s3, s3, 10
    s_lshr_b32 s6, s2, 3
    s_and_b32 s7, s6, 15
    s_lshl_b32 s7, s7, 6
    s_lshl_b32 s89, s22, 3
    s_add_u32 s7, s7, s89
    s_lshl_b32 s7, s7, 11
    s_add_u32 s88, s7, s3
    s_cmp_lt_u32 s6, 16
    s_cselect_b32 s84, s66, s68
    s_cselect_b32 s85, s67, s69
    s_and_b32 s85, s85, 0xffff
    s_mov_b32 s86, 2097152
    s_mov_b32 s87, 0x00020000
    v_bfe_u32 v2, v3, 4, 1
    v_lshlrev_b32 v2, 10, v2
    v_lshrrev_b32 v4, 5, v3
    v_lshl_add_u32 v2, v4, 8, v2
    v_and_b32 v4, 15, v3
    v_lshl_add_u32 v249, v4, 4, v2
    s_lshl_b32 s6, s21, 3
    s_lshl_b32 s7, s27, 1
    s_add_u32 s6, s6, s7
    s_add_u32 s6, s6, s32
    s_lshl_b32 s6, s6, 11
    s_lshl_b32 s7, s20, 17
    s_add_u32 s6, s6, s7
    s_add_u32 s40, s6, 25165824
    s_lshl_b32 s6, s21, 4
    s_lshl_b32 s3, s22, 1
    s_add_u32 s6, s6, s3
    s_lshl_b32 s6, s6, 10
    s_add_u32 s6, s6, s7
    s_add_u32 s41, s6, 29360128
    v_mov_b32 v128, 0
    v_mov_b32 v129, 0
    v_mov_b32 v130, 0
    v_mov_b32 v131, 0
    v_mov_b32 v132, 0
    v_mov_b32 v133, 0
    v_mov_b32 v134, 0
    v_mov_b32 v135, 0
    v_mov_b32 v136, 0
    v_mov_b32 v137, 0
    v_mov_b32 v138, 0
    v_mov_b32 v139, 0
    v_mov_b32 v140, 0
    v_mov_b32 v141, 0
    v_mov_b32 v142, 0
    v_mov_b32 v143, 0
    v_mov_b32 v144, 0
    v_mov_b32 v145, 0
    v_mov_b32 v146, 0
    v_mov_b32 v147, 0
    v_mov_b32 v148, 0
    v_mov_b32 v149, 0
    v_mov_b32 v150, 0
    v_mov_b32 v151, 0
    v_mov_b32 v152, 0
    v_mov_b32 v153, 0
    v_mov_b32 v154, 0
    v_mov_b32 v155, 0
    v_mov_b32 v156, 0
    v_mov_b32 v157, 0
    v_mov_b32 v158, 0
    v_mov_b32 v159, 0
    v_mov_b32 v160, 0
    v_mov_b32 v161, 0
    v_mov_b32 v162, 0
    v_mov_b32 v163, 0
    v_mov_b32 v164, 0
    v_mov_b32 v165, 0
    v_mov_b32 v166, 0
    v_mov_b32 v167, 0
    v_mov_b32 v88, 0
    v_mov_b32 v89, 0
    v_mov_b32 v90, 0
    v_mov_b32 v91, 0
    v_mov_b32 v92, 0
    v_mov_b32 v93, 0
    v_mov_b32 v94, 0
    v_mov_b32 v95, 0
    v_mov_b32 v124, 0
    v_mov_b32 v125, 0
    v_mov_b32 v126, 0
    v_mov_b32 v127, 0
    s_waitcnt vmcnt(1)
    s_branch gated_mix__softmax_full_mha__linear_kernel_hedgehog__prompt_kernel_first
gated_mix__softmax_full_mha__linear_kernel_hedgehog__prompt_kernel_restart:
    s_mov_b32 s23, s26
    s_add_u32 m0, s26, 0
    s_nop 0
    buffer_load_dwordx4 v1, s[12:15], s23 offen offset:0 sc1 lds
    buffer_load_dwordx4 v1, s[12:15], s23 offen offset:1024 sc1 lds
    s_add_u32 m0, s26, 16384
    s_nop 0
    buffer_load_dwordx4 v1, s[16:19], s23 offen offset:0 sc1 lds
    buffer_load_dwordx4 v1, s[16:19], s23 offen offset:1024 sc1 lds
    s_add_u32 s23, s23, 16384
    s_lshl_b32 s48, s22, 10
    s_and_b32 s49, s22, 3
    s_lshl_b32 s49, s49, 6
    s_add_u32 s49, s49, 8192
    v_mov_b32 v176, 0
    v_mov_b32 v177, 0
    v_mov_b32 v178, 0
    v_mov_b32 v179, 0
    v_mov_b32 v180, 0
    v_mov_b32 v181, 0
    v_mov_b32 v182, 0
    v_mov_b32 v183, 0
    v_mov_b32 v184, 0
    v_mov_b32 v185, 0
    v_mov_b32 v186, 0
    v_mov_b32 v187, 0
    v_mov_b32 v188, 0
    v_mov_b32 v189, 0
    v_mov_b32 v190, 0
    v_mov_b32 v191, 0
    v_mov_b32 v192, 0
    v_mov_b32 v193, 0
    v_mov_b32 v194, 0
    v_mov_b32 v195, 0
    v_mov_b32 v196, 0
    v_mov_b32 v197, 0
    v_mov_b32 v198, 0
    v_mov_b32 v199, 0
    v_mov_b32 v200, 0
    v_mov_b32 v201, 0
    v_mov_b32 v202, 0
    v_mov_b32 v203, 0
    v_mov_b32 v204, 0
    v_mov_b32 v205, 0
    v_mov_b32 v206, 0
    v_mov_b32 v207, 0
    v_mov_b32 v128, 0
    v_mov_b32 v129, 0
    v_mov_b32 v130, 0
    v_mov_b32 v131, 0
    v_mov_b32 v132, 0
    v_mov_b32 v133, 0
    v_mov_b32 v134, 0
    v_mov_b32 v135, 0
    v_mov_b32 v136, 0
    v_mov_b32 v137, 0
    v_mov_b32 v138, 0
    v_mov_b32 v139, 0
    v_mov_b32 v140, 0
    v_mov_b32 v141, 0
    v_mov_b32 v142, 0
    v_mov_b32 v143, 0
    v_mov_b32 v144, 0
    v_mov_b32 v145, 0
    v_mov_b32 v146, 0
    v_mov_b32 v147, 0
    v_mov_b32 v148, 0
    v_mov_b32 v149, 0
    v_mov_b32 v150, 0
    v_mov_b32 v151, 0
    v_mov_b32 v152, 0
    v_mov_b32 v153, 0
    v_mov_b32 v154, 0
    v_mov_b32 v155, 0
    v_mov_b32 v156, 0
    v_mov_b32 v157, 0
    v_mov_b32 v158, 0
    v_mov_b32 v159, 0
    v_mov_b32 v160, 0
    v_mov_b32 v161, 0
    v_mov_b32 v162, 0
    v_mov_b32 v163, 0
    v_mov_b32 v164, 0
    v_mov_b32 v165, 0
    v_mov_b32 v166, 0
    v_mov_b32 v167, 0
    v_mov_b32 v88, 0
    v_mov_b32 v89, 0
    v_mov_b32 v90, 0
    v_mov_b32 v91, 0
    v_mov_b32 v92, 0
    v_mov_b32 v93, 0
    v_mov_b32 v94, 0
    v_mov_b32 v95, 0
    v_mov_b32 v124, 0
    v_mov_b32 v125, 0
    v_mov_b32 v126, 0
    v_mov_b32 v127, 0
    s_waitcnt vmcnt(0)
gated_mix__softmax_full_mha__linear_kernel_hedgehog__prompt_kernel_first:
    s_barrier
    s_add_u32 m0, s26, 32768
    s_nop 0
    buffer_load_dwordx4 v1, s[12:15], s23 offen offset:0 sc1 lds
    buffer_load_dwordx4 v1, s[12:15], s23 offen offset:1024 sc1 lds
    s_lshr_b32 s50, s22, 2
    s_cmp_lg_u32 s25, 0
    s_cselect_b32 s50, 0, s50
    ds_read_b128 v[104:107], v1
    ds_read_b128 v[108:111], v1 offset:1024
    ds_read_b128 v[96:99], v7 offset:0
    ds_read_b128 v[100:103], v7 offset:1024
    ds_read_b128 v[112:115], v7 offset:16384
    ds_read_b128 v[116:119], v7 offset:17408
    s_cmp_lg_u32 s25, 0
    s_cbranch_scc1 gated_mix__softmax_full_mha__linear_kernel_hedgehog__prompt_kernel_havemax
    s_waitcnt lgkmcnt(4)
    v_mfma_f32_32x32x16_bf16 v[56:71], v[104:107], v[8:11], 0
    v_mfma_f32_32x32x16_bf16 v[56:71], v[108:111], v[12:15], v[56:71]
    v_mfma_f32_32x32x16_bf16 v[72:87], v[104:107], v[16:19], 0
    v_mfma_f32_32x32x16_bf16 v[72:87], v[108:111], v[20:23], v[72:87]
    s_nop 15
    v_max3_f32 v2, v56, v57, v58
    v_max3_f32 v2, v2, v59, v60
    v_max3_f32 v2, v2, v61, v62
    v_max3_f32 v2, v2, v63, v64
    v_max3_f32 v2, v2, v65, v66
    v_max3_f32 v2, v2, v67, v68
    v_max3_f32 v2, v2, v69, v70
    v_max_f32 v2, v2, v71
    v_max3_f32 v4, v72, v73, v74
    v_max3_f32 v4, v4, v75, v76
    v_max3_f32 v4, v4, v77, v78
    v_max3_f32 v4, v4, v79, v80
    v_max3_f32 v4, v4, v81, v82
    v_max3_f32 v4, v4, v83, v84
    v_max3_f32 v4, v4, v85, v86
    v_max_f32 v4, v4, v87
    v_mov_b32 v5, v2
    s_nop 1
    v_permlane32_swap_b32 v2, v5
    s_nop 1
    v_max_f32 v2, v2, v5
    v_add_f32 v2, 1119092736, v2
    v_sub_f32 v24, 0, v2
    v_mov_b32 v25, v24
    v_mov_b32 v26, v24
    v_mov_b32 v27, v24
    v_mov_b32 v28, v24
    v_mov_b32 v29, v24
    v_mov_b32 v30, v24
    v_mov_b32 v31, v24
    v_mov_b32 v32, v24
    v_mov_b32 v33, v24
    v_mov_b32 v34, v24
    v_mov_b32 v35, v24
    v_mov_b32 v36, v24
    v_mov_b32 v37, v24
    v_mov_b32 v38, v24
    v_mov_b32 v39, v24
    v_mov_b32 v5, v4
    s_nop 1
    v_permlane32_swap_b32 v4, v5
    s_nop 1
    v_max_f32 v4, v4, v5
    v_add_f32 v4, 1119092736, v4
    v_sub_f32 v40, 0, v4
    v_mov_b32 v41, v40
    v_mov_b32 v42, v40
    v_mov_b32 v43, v40
    v_mov_b32 v44, v40
    v_mov_b32 v45, v40
    v_mov_b32 v46, v40
    v_mov_b32 v47, v40
    v_mov_b32 v48, v40
    v_mov_b32 v49, v40
    v_mov_b32 v50, v40
    v_mov_b32 v51, v40
    v_mov_b32 v52, v40
    v_mov_b32 v53, v40
    v_mov_b32 v54, v40
    v_mov_b32 v55, v40
gated_mix__softmax_full_mha__linear_kernel_hedgehog__prompt_kernel_havemax:
    s_waitcnt lgkmcnt(0)
    v_mfma_f32_32x32x16_bf16 v[56:71], v[96:99], v[8:11], v[24:39]
    v_mfma_f32_32x32x16_bf16 v[56:71], v[100:103], v[12:15], v[56:71]
    s_nop 7
    s_mov_b32 s24, 4
    s_nop 3
    s_waitcnt lgkmcnt(0)
    s_setprio 2
    ds_read_b128 v[104:107], v7 offset:2048
    ds_read_b128 v[108:111], v7 offset:3072
    v_exp_f32 v56, v56
    v_exp_f32 v57, v57
    v_exp_f32 v58, v58
    v_exp_f32 v59, v59
    v_mfma_f32_32x32x16_bf16 v[72:87], v[96:99], v[16:19], v[40:55]
    v_cvt_pk_bf16_f32 v88, v56, v57
    v_cvt_pk_bf16_f32 v89, v58, v59
    v_exp_f32 v60, v60
    v_exp_f32 v61, v61
    v_mfma_f32_16x16x32_bf16 v[164:167], v[168:171], v[92:95], v[164:167]
    v_exp_f32 v62, v62
    v_exp_f32 v63, v63
    v_cvt_pk_bf16_f32 v90, v60, v61
    v_cvt_pk_bf16_f32 v91, v62, v63
    v_mfma_f32_32x32x16_bf16 v[72:87], v[100:103], v[20:23], v[72:87]
    s_add_u32 m0, s26, 49152
    s_nop 0
    buffer_load_dwordx4 v1, s[16:19], s23 offen offset:0 sc1 lds
    s_cmp_eq_u32 s50, 0
    s_cbranch_scc1 gated_mix__softmax_full_mha__linear_kernel_hedgehog__prompt_kernel_ds0
    buffer_store_dwordx4 v[224:227], v1, s[8:11], s92 offen offset:0 sc1
    buffer_store_dwordx4 v[228:231], v1, s[8:11], s92 offen offset:1024 sc1
gated_mix__softmax_full_mha__linear_kernel_hedgehog__prompt_kernel_ds0:
    v_exp_f32 v64, v64
    v_exp_f32 v65, v65
    v_exp_f32 v66, v66
    v_exp_f32 v67, v67
    v_mfma_f32_32x32x16_bf16 v[144:159], v[124:127], v[92:95], v[144:159]
    v_cvt_pk_bf16_f32 v92, v64, v65
    v_cvt_pk_bf16_f32 v93, v66, v67
    v_exp_f32 v68, v68
    v_exp_f32 v69, v69
    v_mfma_f32_32x32x16_bf16 v[128:143], v[112:115], v[88:91], v[128:143]
    v_exp_f32 v70, v70
    v_exp_f32 v71, v71
    v_cvt_pk_bf16_f32 v94, v68, v69
    v_cvt_pk_bf16_f32 v95, v70, v71
    v_mfma_f32_16x16x32_bf16 v[160:163], v[168:171], v[88:91], v[160:163]
    s_waitcnt lgkmcnt(0)
    ds_read_b128 v[120:123], v7 offset:18432
    ds_read_b128 v[124:127], v7 offset:19456
    v_exp_f32 v72, v72
    v_exp_f32 v73, v73
    v_exp_f32 v74, v74
    v_exp_f32 v75, v75
    v_mfma_f32_32x32x16_bf16 v[56:71], v[104:107], v[8:11], v[24:39]
    v_cvt_pk_bf16_f32 v88, v72, v73
    v_cvt_pk_bf16_f32 v89, v74, v75
    v_exp_f32 v76, v76
    v_exp_f32 v77, v77
    v_mfma_f32_16x16x32_bf16 v[160:163], v[168:171], v[92:95], v[160:163]
    v_exp_f32 v78, v78
    v_exp_f32 v79, v79
    v_cvt_pk_bf16_f32 v90, v76, v77
    v_cvt_pk_bf16_f32 v91, v78, v79
    v_mfma_f32_32x32x16_bf16 v[56:71], v[108:111], v[12:15], v[56:71]
    buffer_load_dwordx4 v1, s[16:19], s23 offen offset:1024 sc1 lds
    s_add_u32 s23, s23, 16384
    s_cmp_eq_u32 s50, 0
    s_cbranch_scc1 gated_mix__softmax_full_mha__linear_kernel_hedgehog__prompt_kernel_ds1
    buffer_store_dwordx4 v[232:235], v1, s[8:11], s92 offen offset:2048 sc1
    buffer_store_dwordx4 v[236:239], v1, s[8:11], s92 offen offset:3072 sc1
gated_mix__softmax_full_mha__linear_kernel_hedgehog__prompt_kernel_ds1:
    v_exp_f32 v80, v80
    v_exp_f32 v81, v81
    v_exp_f32 v82, v82
    v_exp_f32 v83, v83
    v_mfma_f32_32x32x16_bf16 v[128:143], v[116:119], v[92:95], v[128:143]
    v_cvt_pk_bf16_f32 v92, v80, v81
    v_cvt_pk_bf16_f32 v93, v82, v83
    v_exp_f32 v84, v84
    v_exp_f32 v85, v85
    v_mfma_f32_32x32x16_bf16 v[144:159], v[112:115], v[88:91], v[144:159]
    v_exp_f32 v86, v86
    v_exp_f32 v87, v87
    v_cvt_pk_bf16_f32 v94, v84, v85
    v_cvt_pk_bf16_f32 v95, v86, v87
    v_mfma_f32_16x16x32_bf16 v[164:167], v[168:171], v[88:91], v[164:167]
    s_waitcnt lgkmcnt(0)
    s_setprio 1
    ds_read_b128 v[96:99], v7 offset:4096
    ds_read_b128 v[100:103], v7 offset:5120
    v_exp_f32 v56, v56
    v_exp_f32 v57, v57
    v_exp_f32 v58, v58
    v_exp_f32 v59, v59
    v_mfma_f32_32x32x16_bf16 v[72:87], v[104:107], v[16:19], v[40:55]
    v_cvt_pk_bf16_f32 v88, v56, v57
    v_cvt_pk_bf16_f32 v89, v58, v59
    v_exp_f32 v60, v60
    v_exp_f32 v61, v61
    v_mfma_f32_16x16x32_bf16 v[164:167], v[168:171], v[92:95], v[164:167]
    v_exp_f32 v62, v62
    v_exp_f32 v63, v63
    v_cvt_pk_bf16_f32 v90, v60, v61
    v_cvt_pk_bf16_f32 v91, v62, v63
    v_mfma_f32_32x32x16_bf16 v[72:87], v[108:111], v[20:23], v[72:87]
    s_cmp_eq_u32 s50, 0
    s_cbranch_scc1 gated_mix__softmax_full_mha__linear_kernel_hedgehog__prompt_kernel_ds2
    buffer_store_dwordx4 v[192:195], v1, s[8:11], s93 offen offset:0 sc1
    buffer_store_dwordx4 v[196:199], v1, s[8:11], s93 offen offset:1024 sc1
gated_mix__softmax_full_mha__linear_kernel_hedgehog__prompt_kernel_ds2:
    v_exp_f32 v64, v64
    v_exp_f32 v65, v65
    v_exp_f32 v66, v66
    v_exp_f32 v67, v67
    v_mfma_f32_32x32x16_bf16 v[144:159], v[116:119], v[92:95], v[144:159]
    v_cvt_pk_bf16_f32 v92, v64, v65
    v_cvt_pk_bf16_f32 v93, v66, v67
    v_exp_f32 v68, v68
    v_exp_f32 v69, v69
    v_mfma_f32_32x32x16_bf16 v[128:143], v[120:123], v[88:91], v[128:143]
    v_exp_f32 v70, v70
    v_exp_f32 v71, v71
    v_cvt_pk_bf16_f32 v94, v68, v69
    v_cvt_pk_bf16_f32 v95, v70, v71
    v_mfma_f32_16x16x32_bf16 v[160:163], v[168:171], v[88:91], v[160:163]
    s_waitcnt lgkmcnt(0)
    ds_read_b128 v[112:115], v7 offset:20480
    ds_read_b128 v[116:119], v7 offset:21504
    v_exp_f32 v72, v72
    v_exp_f32 v73, v73
    v_exp_f32 v74, v74
    v_exp_f32 v75, v75
    v_mfma_f32_32x32x16_bf16 v[56:71], v[96:99], v[8:11], v[24:39]
    v_cvt_pk_bf16_f32 v88, v72, v73
    v_cvt_pk_bf16_f32 v89, v74, v75
    v_exp_f32 v76, v76
    v_exp_f32 v77, v77
    v_mfma_f32_16x16x32_bf16 v[160:163], v[168:171], v[92:95], v[160:163]
    v_exp_f32 v78, v78
    v_exp_f32 v79, v79
    v_cvt_pk_bf16_f32 v90, v76, v77
    v_cvt_pk_bf16_f32 v91, v78, v79
    v_mfma_f32_32x32x16_bf16 v[56:71], v[100:103], v[12:15], v[56:71]
    s_cmp_eq_u32 s50, 0
    s_cbranch_scc1 gated_mix__softmax_full_mha__linear_kernel_hedgehog__prompt_kernel_ds3
    buffer_store_dwordx4 v[200:203], v246, s[8:11], s94 offen offset:0 sc1
    buffer_store_dwordx4 v[204:207], v1, s[8:11], s93 offen offset:2048 sc1
gated_mix__softmax_full_mha__linear_kernel_hedgehog__prompt_kernel_ds3:
    v_exp_f32 v80, v80
    v_exp_f32 v81, v81
    v_exp_f32 v82, v82
    v_exp_f32 v83, v83
    v_mfma_f32_32x32x16_bf16 v[128:143], v[124:127], v[92:95], v[128:143]
    v_cvt_pk_bf16_f32 v92, v80, v81
    v_cvt_pk_bf16_f32 v93, v82, v83
    v_exp_f32 v84, v84
    v_exp_f32 v85, v85
    v_mfma_f32_32x32x16_bf16 v[144:159], v[120:123], v[88:91], v[144:159]
    v_exp_f32 v86, v86
    v_exp_f32 v87, v87
    v_cvt_pk_bf16_f32 v94, v84, v85
    v_cvt_pk_bf16_f32 v95, v86, v87
    v_mfma_f32_16x16x32_bf16 v[164:167], v[168:171], v[88:91], v[164:167]
    s_waitcnt lgkmcnt(0)
    s_setprio 0
    ds_read_b128 v[104:107], v7 offset:6144
    ds_read_b128 v[108:111], v7 offset:7168
    v_exp_f32 v56, v56
    v_exp_f32 v57, v57
    v_exp_f32 v58, v58
    v_exp_f32 v59, v59
    v_mfma_f32_32x32x16_bf16 v[72:87], v[96:99], v[16:19], v[40:55]
    v_cvt_pk_bf16_f32 v88, v56, v57
    v_cvt_pk_bf16_f32 v89, v58, v59
    v_exp_f32 v60, v60
    v_exp_f32 v61, v61
    v_mfma_f32_16x16x32_bf16 v[164:167], v[168:171], v[92:95], v[164:167]
    v_exp_f32 v62, v62
    v_exp_f32 v63, v63
    v_cvt_pk_bf16_f32 v90, v60, v61
    v_cvt_pk_bf16_f32 v91, v62, v63
    v_mfma_f32_32x32x16_bf16 v[72:87], v[100:103], v[20:23], v[72:87]
    s_cmp_eq_u32 s50, 0
    s_cbranch_scc1 gated_mix__softmax_full_mha__linear_kernel_hedgehog__prompt_kernel_ds4
    buffer_store_dwordx4 v[208:211], v1, s[8:11], s93 offen offset:3072 sc1
    buffer_store_dwordx4 v[212:215], v246, s[8:11], s94 offen offset:64 sc1
gated_mix__softmax_full_mha__linear_kernel_hedgehog__prompt_kernel_ds4:
    v_exp_f32 v64, v64
    v_exp_f32 v65, v65
    v_exp_f32 v66, v66
    v_exp_f32 v67, v67
    v_mfma_f32_32x32x16_bf16 v[144:159], v[124:127], v[92:95], v[144:159]
    v_cvt_pk_bf16_f32 v92, v64, v65
    v_cvt_pk_bf16_f32 v93, v66, v67
    v_exp_f32 v68, v68
    v_exp_f32 v69, v69
    v_mfma_f32_32x32x16_bf16 v[128:143], v[112:115], v[88:91], v[128:143]
    v_exp_f32 v70, v70
    v_exp_f32 v71, v71
    v_cvt_pk_bf16_f32 v94, v68, v69
    v_cvt_pk_bf16_f32 v95, v70, v71
    v_mfma_f32_16x16x32_bf16 v[160:163], v[168:171], v[88:91], v[160:163]
    s_waitcnt lgkmcnt(0)
    ds_read_b128 v[120:123], v7 offset:22528
    ds_read_b128 v[124:127], v7 offset:23552
    v_exp_f32 v72, v72
    v_exp_f32 v73, v73
    v_exp_f32 v74, v74
    v_exp_f32 v75, v75
    v_mfma_f32_32x32x16_bf16 v[56:71], v[104:107], v[8:11], v[24:39]
    v_cvt_pk_bf16_f32 v88, v72, v73
    v_cvt_pk_bf16_f32 v89, v74, v75
    v_exp_f32 v76, v76
    v_exp_f32 v77, v77
    v_mfma_f32_16x16x32_bf16 v[160:163], v[168:171], v[92:95], v[160:163]
    v_exp_f32 v78, v78
    v_exp_f32 v79, v79
    v_cvt_pk_bf16_f32 v90, v76, v77
    v_cvt_pk_bf16_f32 v91, v78, v79
    v_mfma_f32_32x32x16_bf16 v[56:71], v[108:111], v[12:15], v[56:71]
    v_exp_f32 v80, v80
    v_exp_f32 v81, v81
    v_exp_f32 v82, v82
    v_exp_f32 v83, v83
    v_mfma_f32_32x32x16_bf16 v[128:143], v[116:119], v[92:95], v[128:143]
    v_cvt_pk_bf16_f32 v92, v80, v81
    v_cvt_pk_bf16_f32 v93, v82, v83
    v_exp_f32 v84, v84
    v_exp_f32 v85, v85
    v_mfma_f32_32x32x16_bf16 v[144:159], v[112:115], v[88:91], v[144:159]
    v_exp_f32 v86, v86
    v_exp_f32 v87, v87
    v_cvt_pk_bf16_f32 v94, v84, v85
    v_cvt_pk_bf16_f32 v95, v86, v87
    v_mfma_f32_16x16x32_bf16 v[164:167], v[168:171], v[88:91], v[164:167]
    s_waitcnt lgkmcnt(0)
    s_cmp_eq_u32 s50, 0
    s_cbranch_scc1 gated_mix__softmax_full_mha__linear_kernel_hedgehog__prompt_kernel_sw1a
    s_waitcnt vmcnt(8)
    s_branch gated_mix__softmax_full_mha__linear_kernel_hedgehog__prompt_kernel_sw1b
gated_mix__softmax_full_mha__linear_kernel_hedgehog__prompt_kernel_sw1a:
    s_waitcnt vmcnt(0)
gated_mix__softmax_full_mha__linear_kernel_hedgehog__prompt_kernel_sw1b:
    s_barrier
    buffer_load_dwordx4 v[208:211], v1, s[84:87], s88 offen
    s_add_u32 s88, s88, 2048
    s_setprio 3
    ds_read_b128 v[96:99], v7 offset:32768
    ds_read_b128 v[100:103], v7 offset:33792
    v_exp_f32 v56, v56
    v_exp_f32 v57, v57
    v_exp_f32 v58, v58
    v_exp_f32 v59, v59
    v_mfma_f32_32x32x16_bf16 v[72:87], v[104:107], v[16:19], v[40:55]
    v_cvt_pk_bf16_f32 v88, v56, v57
    v_cvt_pk_bf16_f32 v89, v58, v59
    v_exp_f32 v60, v60
    v_exp_f32 v61, v61
    v_mfma_f32_16x16x32_bf16 v[164:167], v[168:171], v[92:95], v[164:167]
    v_exp_f32 v62, v62
    v_exp_f32 v63, v63
    v_cvt_pk_bf16_f32 v90, v60, v61
    v_cvt_pk_bf16_f32 v91, v62, v63
    v_mfma_f32_32x32x16_bf16 v[72:87], v[108:111], v[20:23], v[72:87]
    s_add_u32 m0, s26, 0
    s_nop 0
    buffer_load_dwordx4 v1, s[12:15], s23 offen offset:0 sc1 lds
    v_exp_f32 v64, v64
    v_exp_f32 v65, v65
    v_exp_f32 v66, v66
    v_exp_f32 v67, v67
    v_mfma_f32_32x32x16_bf16 v[144:159], v[116:119], v[92:95], v[144:159]
    v_cvt_pk_bf16_f32 v92, v64, v65
    v_cvt_pk_bf16_f32 v93, v66, v67
    v_exp_f32 v68, v68
    v_exp_f32 v69, v69
    v_mfma_f32_32x32x16_bf16 v[128:143], v[120:123], v[88:91], v[128:143]
    v_exp_f32 v70, v70
    v_exp_f32 v71, v71
    v_cvt_pk_bf16_f32 v94, v68, v69
    v_cvt_pk_bf16_f32 v95, v70, v71
    v_mfma_f32_16x16x32_bf16 v[160:163], v[168:171], v[88:91], v[160:163]
    s_waitcnt lgkmcnt(0)
    ds_read_b128 v[112:115], v7 offset:49152
    ds_read_b128 v[116:119], v7 offset:50176
    v_exp_f32 v72, v72
    v_exp_f32 v73, v73
    v_exp_f32 v74, v74
    v_exp_f32 v75, v75
    v_mfma_f32_32x32x16_bf16 v[56:71], v[96:99], v[8:11], v[24:39]
    v_cvt_pk_bf16_f32 v88, v72, v73
    v_cvt_pk_bf16_f32 v89, v74, v75
    v_exp_f32 v76, v76
    v_exp_f32 v77, v77
    v_mfma_f32_16x16x32_bf16 v[160:163], v[168:171], v[92:95], v[160:163]
    v_exp_f32 v78, v78
    v_exp_f32 v79, v79
    v_cvt_pk_bf16_f32 v90, v76, v77
    v_cvt_pk_bf16_f32 v91, v78, v79
    v_mfma_f32_32x32x16_bf16 v[56:71], v[100:103], v[12:15], v[56:71]
    buffer_load_dwordx4 v1, s[12:15], s23 offen offset:1024 sc1 lds
    v_exp_f32 v80, v80
    v_exp_f32 v81, v81
    v_exp_f32 v82, v82
    v_exp_f32 v83, v83
    v_mfma_f32_32x32x16_bf16 v[128:143], v[124:127], v[92:95], v[128:143]
    v_cvt_pk_bf16_f32 v92, v80, v81
    v_cvt_pk_bf16_f32 v93, v82, v83
    v_exp_f32 v84, v84
    v_exp_f32 v85, v85
    v_mfma_f32_32x32x16_bf16 v[144:159], v[120:123], v[88:91], v[144:159]
    v_exp_f32 v86, v86
    v_exp_f32 v87, v87
    v_cvt_pk_bf16_f32 v94, v84, v85
    v_cvt_pk_bf16_f32 v95, v86, v87
    v_mfma_f32_16x16x32_bf16 v[164:167], v[168:171], v[88:91], v[164:167]
    s_waitcnt lgkmcnt(0)
    s_setprio 2
    ds_read_b128 v[104:107], v7 offset:34816
    ds_read_b128 v[108:111], v7 offset:35840
    v_exp_f32 v56, v56
    v_exp_f32 v57, v57
    v_exp_f32 v58, v58
    v_exp_f32 v59, v59
    v_mfma_f32_32x32x16_bf16 v[72:87], v[96:99], v[16:19], v[40:55]
    v_cvt_pk_bf16_f32 v88, v56, v57
    v_cvt_pk_bf16_f32 v89, v58, v59
    v_exp_f32 v60, v60
    v_exp_f32 v61, v61
    v_mfma_f32_16x16x32_bf16 v[164:167], v[168:171], v[92:95], v[164:167]
    v_exp_f32 v62, v62
    v_exp_f32 v63, v63
    v_cvt_pk_bf16_f32 v90, v60, v61
    v_cvt_pk_bf16_f32 v91, v62, v63
    v_mfma_f32_32x32x16_bf16 v[72:87], v[100:103], v[20:23], v[72:87]
    s_add_u32 m0, s26, 16384
    s_nop 0
    buffer_load_dwordx4 v1, s[16:19], s23 offen offset:0 sc1 lds
    v_exp_f32 v64, v64
    v_exp_f32 v65, v65
    v_exp_f32 v66, v66
    v_exp_f32 v67, v67
    v_mfma_f32_32x32x16_bf16 v[144:159], v[124:127], v[92:95], v[144:159]
    v_cvt_pk_bf16_f32 v92, v64, v65
    v_cvt_pk_bf16_f32 v93, v66, v67
    v_exp_f32 v68, v68
    v_exp_f32 v69, v69
    v_mfma_f32_32x32x16_bf16 v[128:143], v[112:115], v[88:91], v[128:143]
    v_exp_f32 v70, v70
    v_exp_f32 v71, v71
    v_cvt_pk_bf16_f32 v94, v68, v69
    v_cvt_pk_bf16_f32 v95, v70, v71
    v_mfma_f32_16x16x32_bf16 v[160:163], v[168:171], v[88:91], v[160:163]
    s_waitcnt lgkmcnt(0)
    ds_read_b128 v[120:123], v7 offset:51200
    ds_read_b128 v[124:127], v7 offset:52224
    v_exp_f32 v72, v72
    v_exp_f32 v73, v73
    v_exp_f32 v74, v74
    v_exp_f32 v75, v75
    v_mfma_f32_32x32x16_bf16 v[56:71], v[104:107], v[8:11], v[24:39]
    v_cvt_pk_bf16_f32 v88, v72, v73
    v_cvt_pk_bf16_f32 v89, v74, v75
    v_exp_f32 v76, v76
    v_exp_f32 v77, v77
    v_mfma_f32_16x16x32_bf16 v[160:163], v[168:171], v[92:95], v[160:163]
    v_exp_f32 v78, v78
    v_exp_f32 v79, v79
    v_cvt_pk_bf16_f32 v90, v76, v77
    v_cvt_pk_bf16_f32 v91, v78, v79
    v_mfma_f32_32x32x16_bf16 v[56:71], v[108:111], v[12:15], v[56:71]
    buffer_load_dwordx4 v1, s[16:19], s23 offen offset:1024 sc1 lds
    s_add_u32 s23, s23, 16384
    v_exp_f32 v80, v80
    v_exp_f32 v81, v81
    v_exp_f32 v82, v82
    v_exp_f32 v83, v83
    v_mfma_f32_32x32x16_bf16 v[128:143], v[116:119], v[92:95], v[128:143]
    v_cvt_pk_bf16_f32 v92, v80, v81
    v_cvt_pk_bf16_f32 v93, v82, v83
    v_exp_f32 v84, v84
    v_exp_f32 v85, v85
    v_mfma_f32_32x32x16_bf16 v[144:159], v[112:115], v[88:91], v[144:159]
    v_exp_f32 v86, v86
    v_exp_f32 v87, v87
    v_cvt_pk_bf16_f32 v94, v84, v85
    v_cvt_pk_bf16_f32 v95, v86, v87
    v_mfma_f32_16x16x32_bf16 v[164:167], v[168:171], v[88:91], v[164:167]
    s_waitcnt lgkmcnt(0)
    s_setprio 1
    ds_read_b128 v[96:99], v7 offset:36864
    ds_read_b128 v[100:103], v7 offset:37888
    v_exp_f32 v56, v56
    v_exp_f32 v57, v57
    v_exp_f32 v58, v58
    v_exp_f32 v59, v59
    v_mfma_f32_32x32x16_bf16 v[72:87], v[104:107], v[16:19], v[40:55]
    v_cvt_pk_bf16_f32 v88, v56, v57
    v_cvt_pk_bf16_f32 v89, v58, v59
    v_exp_f32 v60, v60
    v_exp_f32 v61, v61
    v_mfma_f32_16x16x32_bf16 v[164:167], v[168:171], v[92:95], v[164:167]
    v_exp_f32 v62, v62
    v_exp_f32 v63, v63
    v_cvt_pk_bf16_f32 v90, v60, v61
    v_cvt_pk_bf16_f32 v91, v62, v63
    v_mfma_f32_32x32x16_bf16 v[72:87], v[108:111], v[20:23], v[72:87]
    v_exp_f32 v64, v64
    v_exp_f32 v65, v65
    v_exp_f32 v66, v66
    v_exp_f32 v67, v67
    v_mfma_f32_32x32x16_bf16 v[144:159], v[116:119], v[92:95], v[144:159]
    v_cvt_pk_bf16_f32 v92, v64, v65
    v_cvt_pk_bf16_f32 v93, v66, v67
    v_exp_f32 v68, v68
    v_exp_f32 v69, v69
    v_mfma_f32_32x32x16_bf16 v[128:143], v[120:123], v[88:91], v[128:143]
    v_exp_f32 v70, v70
    v_exp_f32 v71, v71
    v_cvt_pk_bf16_f32 v94, v68, v69
    v_cvt_pk_bf16_f32 v95, v70, v71
    v_mfma_f32_16x16x32_bf16 v[160:163], v[168:171], v[88:91], v[160:163]
    s_waitcnt lgkmcnt(0)
    ds_read_b128 v[112:115], v7 offset:53248
    ds_read_b128 v[116:119], v7 offset:54272
    v_exp_f32 v72, v72
    v_exp_f32 v73, v73
    v_exp_f32 v74, v74
    v_exp_f32 v75, v75
    v_mfma_f32_32x32x16_bf16 v[56:71], v[96:99], v[8:11], v[24:39]
    v_cvt_pk_bf16_f32 v88, v72, v73
    v_cvt_pk_bf16_f32 v89, v74, v75
    v_exp_f32 v76, v76
    v_exp_f32 v77, v77
    v_mfma_f32_16x16x32_bf16 v[160:163], v[168:171], v[92:95], v[160:163]
    v_exp_f32 v78, v78
    v_exp_f32 v79, v79
    v_cvt_pk_bf16_f32 v90, v76, v77
    v_cvt_pk_bf16_f32 v91, v78, v79
    v_mfma_f32_32x32x16_bf16 v[56:71], v[100:103], v[12:15], v[56:71]
    v_exp_f32 v80, v80
    v_exp_f32 v81, v81
    v_exp_f32 v82, v82
    v_exp_f32 v83, v83
    v_mfma_f32_32x32x16_bf16 v[128:143], v[124:127], v[92:95], v[128:143]
    v_cvt_pk_bf16_f32 v92, v80, v81
    v_cvt_pk_bf16_f32 v93, v82, v83
    v_exp_f32 v84, v84
    v_exp_f32 v85, v85
    v_mfma_f32_32x32x16_bf16 v[144:159], v[120:123], v[88:91], v[144:159]
    v_exp_f32 v86, v86
    v_exp_f32 v87, v87
    v_cvt_pk_bf16_f32 v94, v84, v85
    v_cvt_pk_bf16_f32 v95, v86, v87
    v_mfma_f32_16x16x32_bf16 v[164:167], v[168:171], v[88:91], v[164:167]
    s_waitcnt lgkmcnt(0)
    s_setprio 0
    ds_read_b128 v[104:107], v7 offset:38912
    ds_read_b128 v[108:111], v7 offset:39936
    v_exp_f32 v56, v56
    v_exp_f32 v57, v57
    v_exp_f32 v58, v58
    v_exp_f32 v59, v59
    v_mfma_f32_32x32x16_bf16 v[72:87], v[96:99], v[16:19], v[40:55]
    v_cvt_pk_bf16_f32 v88, v56, v57
    v_cvt_pk_bf16_f32 v89, v58, v59
    v_exp_f32 v60, v60
    v_exp_f32 v61, v61
    v_mfma_f32_16x16x32_bf16 v[164:167], v[168:171], v[92:95], v[164:167]
    v_exp_f32 v62, v62
    v_exp_f32 v63, v63
    v_cvt_pk_bf16_f32 v90, v60, v61
    v_cvt_pk_bf16_f32 v91, v62, v63
    v_mfma_f32_32x32x16_bf16 v[72:87], v[100:103], v[20:23], v[72:87]
    v_exp_f32 v64, v64
    v_exp_f32 v65, v65
    v_exp_f32 v66, v66
    v_exp_f32 v67, v67
    v_mfma_f32_32x32x16_bf16 v[144:159], v[124:127], v[92:95], v[144:159]
    v_cvt_pk_bf16_f32 v92, v64, v65
    v_cvt_pk_bf16_f32 v93, v66, v67
    v_exp_f32 v68, v68
    v_exp_f32 v69, v69
    v_mfma_f32_32x32x16_bf16 v[128:143], v[112:115], v[88:91], v[128:143]
    v_exp_f32 v70, v70
    v_exp_f32 v71, v71
    v_cvt_pk_bf16_f32 v94, v68, v69
    v_cvt_pk_bf16_f32 v95, v70, v71
    v_mfma_f32_16x16x32_bf16 v[160:163], v[168:171], v[88:91], v[160:163]
    s_waitcnt lgkmcnt(0)
    ds_read_b128 v[120:123], v7 offset:55296
    ds_read_b128 v[124:127], v7 offset:56320
    v_exp_f32 v72, v72
    v_exp_f32 v73, v73
    v_exp_f32 v74, v74
    v_exp_f32 v75, v75
    v_mfma_f32_32x32x16_bf16 v[56:71], v[104:107], v[8:11], v[24:39]
    v_cvt_pk_bf16_f32 v88, v72, v73
    v_cvt_pk_bf16_f32 v89, v74, v75
    v_exp_f32 v76, v76
    v_exp_f32 v77, v77
    v_mfma_f32_16x16x32_bf16 v[160:163], v[168:171], v[92:95], v[160:163]
    v_exp_f32 v78, v78
    v_exp_f32 v79, v79
    v_cvt_pk_bf16_f32 v90, v76, v77
    v_cvt_pk_bf16_f32 v91, v78, v79
    v_mfma_f32_32x32x16_bf16 v[56:71], v[108:111], v[12:15], v[56:71]
    v_exp_f32 v80, v80
    v_exp_f32 v81, v81
    v_exp_f32 v82, v82
    v_exp_f32 v83, v83
    v_mfma_f32_32x32x16_bf16 v[128:143], v[116:119], v[92:95], v[128:143]
    v_cvt_pk_bf16_f32 v92, v80, v81
    v_cvt_pk_bf16_f32 v93, v82, v83
    v_exp_f32 v84, v84
    v_exp_f32 v85, v85
    v_mfma_f32_32x32x16_bf16 v[144:159], v[112:115], v[88:91], v[144:159]
    v_exp_f32 v86, v86
    v_exp_f32 v87, v87
    v_cvt_pk_bf16_f32 v94, v84, v85
    v_cvt_pk_bf16_f32 v95, v86, v87
    v_mfma_f32_16x16x32_bf16 v[164:167], v[168:171], v[88:91], v[164:167]
    s_waitcnt lgkmcnt(0)
    s_waitcnt vmcnt(0)
    s_barrier
    s_cmp_lg_u32 s22, 0
    s_cbranch_scc1 gated_mix__softmax_full_mha__linear_kernel_hedgehog__prompt_kernel_r2
    s_add_u32 s36, s95, 24154112
    s_mov_b64 exec, 1
    v_mov_b32 v216, 0
    v_mov_b32 v217, 1
    buffer_store_dword v217, v216, s[8:11], s36 offen sc1
    s_mov_b64 exec, -1
gated_mix__softmax_full_mha__linear_kernel_hedgehog__prompt_kernel_r2:
    buffer_load_dwordx4 v[208:211], v1, s[84:87], s88 offen
    s_add_u32 s88, s88, 2048
    s_setprio 3
    ds_read_b128 v[96:99], v7 offset:0
    ds_read_b128 v[100:103], v7 offset:1024
    v_exp_f32 v56, v56
    v_exp_f32 v57, v57
    v_exp_f32 v58, v58
    v_exp_f32 v59, v59
    v_mfma_f32_32x32x16_bf16 v[72:87], v[104:107], v[16:19], v[40:55]
    v_cvt_pk_bf16_f32 v88, v56, v57
    v_cvt_pk_bf16_f32 v89, v58, v59
    v_exp_f32 v60, v60
    v_exp_f32 v61, v61
    v_mfma_f32_16x16x32_bf16 v[164:167], v[168:171], v[92:95], v[164:167]
    v_exp_f32 v62, v62
    v_exp_f32 v63, v63
    v_cvt_pk_bf16_f32 v90, v60, v61
    v_cvt_pk_bf16_f32 v91, v62, v63
    v_mfma_f32_32x32x16_bf16 v[72:87], v[108:111], v[20:23], v[72:87]
    s_add_u32 m0, s26, 32768
    s_nop 0
    buffer_load_dwordx4 v1, s[12:15], s23 offen offset:0 sc1 lds
    v_exp_f32 v64, v64
    v_exp_f32 v65, v65
    v_exp_f32 v66, v66
    v_exp_f32 v67, v67
    v_mfma_f32_32x32x16_bf16 v[144:159], v[116:119], v[92:95], v[144:159]
    v_cvt_pk_bf16_f32 v92, v64, v65
    v_cvt_pk_bf16_f32 v93, v66, v67
    v_exp_f32 v68, v68
    v_exp_f32 v69, v69
    v_mfma_f32_32x32x16_bf16 v[128:143], v[120:123], v[88:91], v[128:143]
    v_exp_f32 v70, v70
    v_exp_f32 v71, v71
    v_cvt_pk_bf16_f32 v94, v68, v69
    v_cvt_pk_bf16_f32 v95, v70, v71
    v_mfma_f32_16x16x32_bf16 v[160:163], v[168:171], v[88:91], v[160:163]
    s_waitcnt lgkmcnt(0)
    ds_read_b128 v[112:115], v7 offset:16384
    ds_read_b128 v[116:119], v7 offset:17408
    v_exp_f32 v72, v72
    v_exp_f32 v73, v73
    v_exp_f32 v74, v74
    v_exp_f32 v75, v75
    v_mfma_f32_32x32x16_bf16 v[56:71], v[96:99], v[8:11], v[24:39]
    v_cvt_pk_bf16_f32 v88, v72, v73
    v_cvt_pk_bf16_f32 v89, v74, v75
    v_exp_f32 v76, v76
    v_exp_f32 v77, v77
    v_mfma_f32_16x16x32_bf16 v[160:163], v[168:171], v[92:95], v[160:163]
    v_exp_f32 v78, v78
    v_exp_f32 v79, v79
    v_cvt_pk_bf16_f32 v90, v76, v77
    v_cvt_pk_bf16_f32 v91, v78, v79
    v_mfma_f32_32x32x16_bf16 v[56:71], v[100:103], v[12:15], v[56:71]
    buffer_load_dwordx4 v1, s[12:15], s23 offen offset:1024 sc1 lds
    v_exp_f32 v80, v80
    v_exp_f32 v81, v81
    v_exp_f32 v82, v82
    v_exp_f32 v83, v83
    v_mfma_f32_32x32x16_bf16 v[128:143], v[124:127], v[92:95], v[128:143]
    v_cvt_pk_bf16_f32 v92, v80, v81
    v_cvt_pk_bf16_f32 v93, v82, v83
    v_exp_f32 v84, v84
    v_exp_f32 v85, v85
    v_mfma_f32_32x32x16_bf16 v[144:159], v[120:123], v[88:91], v[144:159]
    v_exp_f32 v86, v86
    v_exp_f32 v87, v87
    v_cvt_pk_bf16_f32 v94, v84, v85
    v_cvt_pk_bf16_f32 v95, v86, v87
    v_mfma_f32_16x16x32_bf16 v[164:167], v[168:171], v[88:91], v[164:167]
    s_waitcnt lgkmcnt(0)
    s_setprio 2
    ds_read_b128 v[104:107], v7 offset:2048
    ds_read_b128 v[108:111], v7 offset:3072
    v_exp_f32 v56, v56
    v_exp_f32 v57, v57
    v_exp_f32 v58, v58
    v_exp_f32 v59, v59
    v_mfma_f32_32x32x16_bf16 v[72:87], v[96:99], v[16:19], v[40:55]
    v_cvt_pk_bf16_f32 v88, v56, v57
    v_cvt_pk_bf16_f32 v89, v58, v59
    v_exp_f32 v60, v60
    v_exp_f32 v61, v61
    v_mfma_f32_16x16x32_bf16 v[164:167], v[168:171], v[92:95], v[164:167]
    v_exp_f32 v62, v62
    v_exp_f32 v63, v63
    v_cvt_pk_bf16_f32 v90, v60, v61
    v_cvt_pk_bf16_f32 v91, v62, v63
    v_mfma_f32_32x32x16_bf16 v[72:87], v[100:103], v[20:23], v[72:87]
    s_add_u32 m0, s26, 49152
    s_nop 0
    buffer_load_dwordx4 v1, s[16:19], s23 offen offset:0 sc1 lds
    v_exp_f32 v64, v64
    v_exp_f32 v65, v65
    v_exp_f32 v66, v66
    v_exp_f32 v67, v67
    v_mfma_f32_32x32x16_bf16 v[144:159], v[124:127], v[92:95], v[144:159]
    v_cvt_pk_bf16_f32 v92, v64, v65
    v_cvt_pk_bf16_f32 v93, v66, v67
    v_exp_f32 v68, v68
    v_exp_f32 v69, v69
    v_mfma_f32_32x32x16_bf16 v[128:143], v[112:115], v[88:91], v[128:143]
    v_exp_f32 v70, v70
    v_exp_f32 v71, v71
    v_cvt_pk_bf16_f32 v94, v68, v69
    v_cvt_pk_bf16_f32 v95, v70, v71
    v_mfma_f32_16x16x32_bf16 v[160:163], v[168:171], v[88:91], v[160:163]
    s_waitcnt lgkmcnt(0)
    ds_read_b128 v[120:123], v7 offset:18432
    ds_read_b128 v[124:127], v7 offset:19456
    v_exp_f32 v72, v72
    v_exp_f32 v73, v73
    v_exp_f32 v74, v74
    v_exp_f32 v75, v75
    v_mfma_f32_32x32x16_bf16 v[56:71], v[104:107], v[8:11], v[24:39]
    v_cvt_pk_bf16_f32 v88, v72, v73
    v_cvt_pk_bf16_f32 v89, v74, v75
    v_exp_f32 v76, v76
    v_exp_f32 v77, v77
    v_mfma_f32_16x16x32_bf16 v[160:163], v[168:171], v[92:95], v[160:163]
    v_exp_f32 v78, v78
    v_exp_f32 v79, v79
    v_cvt_pk_bf16_f32 v90, v76, v77
    v_cvt_pk_bf16_f32 v91, v78, v79
    v_mfma_f32_32x32x16_bf16 v[56:71], v[108:111], v[12:15], v[56:71]
    buffer_load_dwordx4 v1, s[16:19], s23 offen offset:1024 sc1 lds
    s_add_u32 s23, s23, 16384
    v_exp_f32 v80, v80
    v_exp_f32 v81, v81
    v_exp_f32 v82, v82
    v_exp_f32 v83, v83
    v_mfma_f32_32x32x16_bf16 v[128:143], v[116:119], v[92:95], v[128:143]
    v_cvt_pk_bf16_f32 v92, v80, v81
    v_cvt_pk_bf16_f32 v93, v82, v83
    v_exp_f32 v84, v84
    v_exp_f32 v85, v85
    v_mfma_f32_32x32x16_bf16 v[144:159], v[112:115], v[88:91], v[144:159]
    v_exp_f32 v86, v86
    v_exp_f32 v87, v87
    v_cvt_pk_bf16_f32 v94, v84, v85
    v_cvt_pk_bf16_f32 v95, v86, v87
    v_mfma_f32_16x16x32_bf16 v[164:167], v[168:171], v[88:91], v[164:167]
    s_waitcnt lgkmcnt(0)
    s_cmp_lg_u32 s22, 0
    s_cbranch_scc1 gated_mix__softmax_full_mha__linear_kernel_hedgehog__prompt_kernel_i2
    s_lshr_b32 s37, s20, 1
    s_lshl_b32 s37, s37, 7
    s_add_u32 s37, s37, 24154112
    v_and_b32 v216, 15, v0
    v_lshlrev_b32 v216, 2, v216
    buffer_load_dword v217, v216, s[8:11], s37 offen sc1
gated_mix__softmax_full_mha__linear_kernel_hedgehog__prompt_kernel_i2:
    s_setprio 1
    ds_read_b128 v[96:99], v7 offset:4096
    ds_read_b128 v[100:103], v7 offset:5120
    v_exp_f32 v56, v56
    v_exp_f32 v57, v57
    v_exp_f32 v58, v58
    v_exp_f32 v59, v59
    v_mfma_f32_32x32x16_bf16 v[72:87], v[104:107], v[16:19], v[40:55]
    v_cvt_pk_bf16_f32 v88, v56, v57
    v_cvt_pk_bf16_f32 v89, v58, v59
    v_exp_f32 v60, v60
    v_exp_f32 v61, v61
    v_mfma_f32_16x16x32_bf16 v[164:167], v[168:171], v[92:95], v[164:167]
    v_exp_f32 v62, v62
    v_exp_f32 v63, v63
    v_cvt_pk_bf16_f32 v90, v60, v61
    v_cvt_pk_bf16_f32 v91, v62, v63
    v_mfma_f32_32x32x16_bf16 v[72:87], v[108:111], v[20:23], v[72:87]
    v_exp_f32 v64, v64
    v_exp_f32 v65, v65
    v_exp_f32 v66, v66
    v_exp_f32 v67, v67
    v_mfma_f32_32x32x16_bf16 v[144:159], v[116:119], v[92:95], v[144:159]
    v_cvt_pk_bf16_f32 v92, v64, v65
    v_cvt_pk_bf16_f32 v93, v66, v67
    v_exp_f32 v68, v68
    v_exp_f32 v69, v69
    v_mfma_f32_32x32x16_bf16 v[128:143], v[120:123], v[88:91], v[128:143]
    v_exp_f32 v70, v70
    v_exp_f32 v71, v71
    v_cvt_pk_bf16_f32 v94, v68, v69
    v_cvt_pk_bf16_f32 v95, v70, v71
    v_mfma_f32_16x16x32_bf16 v[160:163], v[168:171], v[88:91], v[160:163]
    s_waitcnt lgkmcnt(0)
    ds_read_b128 v[112:115], v7 offset:20480
    ds_read_b128 v[116:119], v7 offset:21504
    v_exp_f32 v72, v72
    v_exp_f32 v73, v73
    v_exp_f32 v74, v74
    v_exp_f32 v75, v75
    v_mfma_f32_32x32x16_bf16 v[56:71], v[96:99], v[8:11], v[24:39]
    v_cvt_pk_bf16_f32 v88, v72, v73
    v_cvt_pk_bf16_f32 v89, v74, v75
    v_exp_f32 v76, v76
    v_exp_f32 v77, v77
    v_mfma_f32_16x16x32_bf16 v[160:163], v[168:171], v[92:95], v[160:163]
    v_exp_f32 v78, v78
    v_exp_f32 v79, v79
    v_cvt_pk_bf16_f32 v90, v76, v77
    v_cvt_pk_bf16_f32 v91, v78, v79
    v_mfma_f32_32x32x16_bf16 v[56:71], v[100:103], v[12:15], v[56:71]
    v_exp_f32 v80, v80
    v_exp_f32 v81, v81
    v_exp_f32 v82, v82
    v_exp_f32 v83, v83
    v_mfma_f32_32x32x16_bf16 v[128:143], v[124:127], v[92:95], v[128:143]
    v_cvt_pk_bf16_f32 v92, v80, v81
    v_cvt_pk_bf16_f32 v93, v82, v83
    v_exp_f32 v84, v84
    v_exp_f32 v85, v85
    v_mfma_f32_32x32x16_bf16 v[144:159], v[120:123], v[88:91], v[144:159]
    v_exp_f32 v86, v86
    v_exp_f32 v87, v87
    v_cvt_pk_bf16_f32 v94, v84, v85
    v_cvt_pk_bf16_f32 v95, v86, v87
    v_mfma_f32_16x16x32_bf16 v[164:167], v[168:171], v[88:91], v[164:167]
    s_waitcnt lgkmcnt(0)
    s_setprio 0
    ds_read_b128 v[104:107], v7 offset:6144
    ds_read_b128 v[108:111], v7 offset:7168
    v_exp_f32 v56, v56
    v_exp_f32 v57, v57
    v_exp_f32 v58, v58
    v_exp_f32 v59, v59
    v_mfma_f32_32x32x16_bf16 v[72:87], v[96:99], v[16:19], v[40:55]
    v_cvt_pk_bf16_f32 v88, v56, v57
    v_cvt_pk_bf16_f32 v89, v58, v59
    v_exp_f32 v60, v60
    v_exp_f32 v61, v61
    v_mfma_f32_16x16x32_bf16 v[164:167], v[168:171], v[92:95], v[164:167]
    v_exp_f32 v62, v62
    v_exp_f32 v63, v63
    v_cvt_pk_bf16_f32 v90, v60, v61
    v_cvt_pk_bf16_f32 v91, v62, v63
    v_mfma_f32_32x32x16_bf16 v[72:87], v[100:103], v[20:23], v[72:87]
    v_exp_f32 v64, v64
    v_exp_f32 v65, v65
    v_exp_f32 v66, v66
    v_exp_f32 v67, v67
    v_mfma_f32_32x32x16_bf16 v[144:159], v[124:127], v[92:95], v[144:159]
    v_cvt_pk_bf16_f32 v92, v64, v65
    v_cvt_pk_bf16_f32 v93, v66, v67
    v_exp_f32 v68, v68
    v_exp_f32 v69, v69
    v_mfma_f32_32x32x16_bf16 v[128:143], v[112:115], v[88:91], v[128:143]
    v_exp_f32 v70, v70
    v_exp_f32 v71, v71
    v_cvt_pk_bf16_f32 v94, v68, v69
    v_cvt_pk_bf16_f32 v95, v70, v71
    v_mfma_f32_16x16x32_bf16 v[160:163], v[168:171], v[88:91], v[160:163]
    s_waitcnt lgkmcnt(0)
    ds_read_b128 v[120:123], v7 offset:22528
    ds_read_b128 v[124:127], v7 offset:23552
    v_exp_f32 v72, v72
    v_exp_f32 v73, v73
    v_exp_f32 v74, v74
    v_exp_f32 v75, v75
    v_mfma_f32_32x32x16_bf16 v[56:71], v[104:107], v[8:11], v[24:39]
    v_cvt_pk_bf16_f32 v88, v72, v73
    v_cvt_pk_bf16_f32 v89, v74, v75
    v_exp_f32 v76, v76
    v_exp_f32 v77, v77
    v_mfma_f32_16x16x32_bf16 v[160:163], v[168:171], v[92:95], v[160:163]
    v_exp_f32 v78, v78
    v_exp_f32 v79, v79
    v_cvt_pk_bf16_f32 v90, v76, v77
    v_cvt_pk_bf16_f32 v91, v78, v79
    v_mfma_f32_32x32x16_bf16 v[56:71], v[108:111], v[12:15], v[56:71]
    v_exp_f32 v80, v80
    v_exp_f32 v81, v81
    v_exp_f32 v82, v82
    v_exp_f32 v83, v83
    v_mfma_f32_32x32x16_bf16 v[128:143], v[116:119], v[92:95], v[128:143]
    v_cvt_pk_bf16_f32 v92, v80, v81
    v_cvt_pk_bf16_f32 v93, v82, v83
    v_exp_f32 v84, v84
    v_exp_f32 v85, v85
    v_mfma_f32_32x32x16_bf16 v[144:159], v[112:115], v[88:91], v[144:159]
    v_exp_f32 v86, v86
    v_exp_f32 v87, v87
    v_cvt_pk_bf16_f32 v94, v84, v85
    v_cvt_pk_bf16_f32 v95, v86, v87
    v_mfma_f32_16x16x32_bf16 v[164:167], v[168:171], v[88:91], v[164:167]
    s_waitcnt lgkmcnt(0)
    s_waitcnt vmcnt(0)
    s_cmp_lg_u32 s22, 0
    s_cbranch_scc1 gated_mix__softmax_full_mha__linear_kernel_hedgehog__prompt_kernel_c2
    s_mov_b32 s36, 131072
gated_mix__softmax_full_mha__linear_kernel_hedgehog__prompt_kernel_c2l:
    v_cmp_eq_u32 vcc, 1, v217
    s_sub_u32 s36, s36, 1
    s_cmp_eq_u32 s36, 0
    s_cbranch_scc1 gated_mix__softmax_full_mha__linear_kernel_hedgehog__prompt_kernel_c2
    s_cmp_eq_u64 vcc, exec
    s_cbranch_scc1 gated_mix__softmax_full_mha__linear_kernel_hedgehog__prompt_kernel_c2
    buffer_load_dword v217, v216, s[8:11], s37 offen sc1
    s_waitcnt vmcnt(0)
    s_branch gated_mix__softmax_full_mha__linear_kernel_hedgehog__prompt_kernel_c2l
gated_mix__softmax_full_mha__linear_kernel_hedgehog__prompt_kernel_c2:
    s_barrier
    s_lshl_b32 s6, s21, 4
    s_lshl_b32 s7, s22, 1
    s_add_u32 s6, s6, s7
    s_lshl_b32 s7, s6, 10
    s_lshl_b32 s3, s20, 17
    s_add_u32 s7, s7, s3
    s_add_u32 s7, s7, 12582912
    buffer_load_dwordx4 v[224:227], v1, s[8:11], s7 offen offset:0 sc1
    buffer_load_dwordx4 v[228:231], v1, s[8:11], s7 offen offset:1024 sc1
    s_lshl_b32 s7, s6, 6
    s_add_u32 s7, s7, 23068672
    v_and_b32 v2, 15, v3
    v_lshlrev_b32 v2, 2, v2
    buffer_load_dword v244, v2, s[8:11], s7 offen offset:0 sc1
    buffer_load_dword v245, v2, s[8:11], s7 offen offset:64 sc1
    s_lshl_b32 s6, s20, 11
    s_lshl_b32 s7, s22, 10
    s_add_u32 s6, s6, s7
    s_cmp_ge_u32 s22, 2
    s_cselect_b32 s6, 0x10000, s6
    s_cselect_b32 s7, 2304, s7
    s_add_u32 m0, s7, 71680
    s_nop 0
    buffer_load_dwordx4 v1, s[28:31], s6 offen lds
    buffer_load_dwordx4 v[184:187], v1, s[44:47], s48 offen sc1
    buffer_load_dwordx4 v[188:191], v246, s[44:47], s49 offen sc1
    s_add_u32 s48, s48, 16384
    s_add_u32 s49, s49, 16384
    buffer_load_dwordx4 v[192:195], v1, s[44:47], s48 offen sc1
    buffer_load_dwordx4 v[196:199], v246, s[44:47], s49 offen sc1
    s_add_u32 s48, s48, 16384
    s_add_u32 s49, s49, 16384
    buffer_load_dwordx4 v[200:203], v1, s[44:47], s48 offen sc1
    buffer_load_dwordx4 v[204:207], v246, s[44:47], s49 offen sc1
    s_add_u32 s48, s48, 16384
    s_add_u32 s49, s49, 16384
    buffer_load_dwordx4 v[208:211], v1, s[84:87], s88 offen
    s_add_u32 s88, s88, 2048
    s_setprio 3
    ds_read_b128 v[96:99], v7 offset:32768
    ds_read_b128 v[100:103], v7 offset:33792
    v_exp_f32 v56, v56
    v_exp_f32 v57, v57
    v_exp_f32 v58, v58
    v_exp_f32 v59, v59
    v_mfma_f32_32x32x16_bf16 v[72:87], v[104:107], v[16:19], v[40:55]
    v_cvt_pk_bf16_f32 v88, v56, v57
    v_cvt_pk_bf16_f32 v89, v58, v59
    v_exp_f32 v60, v60
    v_exp_f32 v61, v61
    v_mfma_f32_16x16x32_bf16 v[164:167], v[168:171], v[92:95], v[164:167]
    v_exp_f32 v62, v62
    v_exp_f32 v63, v63
    v_cvt_pk_bf16_f32 v90, v60, v61
    v_cvt_pk_bf16_f32 v91, v62, v63
    v_mfma_f32_32x32x16_bf16 v[72:87], v[108:111], v[20:23], v[72:87]
    s_add_u32 m0, s26, 0
    s_nop 0
    buffer_load_dwordx4 v1, s[12:15], s23 offen offset:0 sc1 lds
    v_exp_f32 v64, v64
    v_exp_f32 v65, v65
    v_exp_f32 v66, v66
    v_exp_f32 v67, v67
    v_mfma_f32_32x32x16_bf16 v[144:159], v[116:119], v[92:95], v[144:159]
    v_cvt_pk_bf16_f32 v92, v64, v65
    v_cvt_pk_bf16_f32 v93, v66, v67
    v_exp_f32 v68, v68
    v_exp_f32 v69, v69
    v_mfma_f32_32x32x16_bf16 v[128:143], v[120:123], v[88:91], v[128:143]
    v_exp_f32 v70, v70
    v_exp_f32 v71, v71
    v_cvt_pk_bf16_f32 v94, v68, v69
    v_cvt_pk_bf16_f32 v95, v70, v71
    v_mfma_f32_16x16x32_bf16 v[160:163], v[168:171], v[88:91], v[160:163]
    s_waitcnt lgkmcnt(0)
    ds_read_b128 v[112:115], v7 offset:49152
    ds_read_b128 v[116:119], v7 offset:50176
    v_exp_f32 v72, v72
    v_exp_f32 v73, v73
    v_exp_f32 v74, v74
    v_exp_f32 v75, v75
    v_mfma_f32_32x32x16_bf16 v[56:71], v[96:99], v[8:11], v[24:39]
    v_cvt_pk_bf16_f32 v88, v72, v73
    v_cvt_pk_bf16_f32 v89, v74, v75
    v_exp_f32 v76, v76
    v_exp_f32 v77, v77
    v_mfma_f32_16x16x32_bf16 v[160:163], v[168:171], v[92:95], v[160:163]
    v_exp_f32 v78, v78
    v_exp_f32 v79, v79
    v_cvt_pk_bf16_f32 v90, v76, v77
    v_cvt_pk_bf16_f32 v91, v78, v79
    v_mfma_f32_32x32x16_bf16 v[56:71], v[100:103], v[12:15], v[56:71]
    buffer_load_dwordx4 v1, s[12:15], s23 offen offset:1024 sc1 lds
    v_exp_f32 v80, v80
    v_exp_f32 v81, v81
    v_exp_f32 v82, v82
    v_exp_f32 v83, v83
    v_mfma_f32_32x32x16_bf16 v[128:143], v[124:127], v[92:95], v[128:143]
    v_cvt_pk_bf16_f32 v92, v80, v81
    v_cvt_pk_bf16_f32 v93, v82, v83
    v_exp_f32 v84, v84
    v_exp_f32 v85, v85
    v_mfma_f32_32x32x16_bf16 v[144:159], v[120:123], v[88:91], v[144:159]
    v_exp_f32 v86, v86
    v_exp_f32 v87, v87
    v_cvt_pk_bf16_f32 v94, v84, v85
    v_cvt_pk_bf16_f32 v95, v86, v87
    v_mfma_f32_16x16x32_bf16 v[164:167], v[168:171], v[88:91], v[164:167]
    s_waitcnt lgkmcnt(0)
    s_setprio 2
    ds_read_b128 v[104:107], v7 offset:34816
    ds_read_b128 v[108:111], v7 offset:35840
    v_exp_f32 v56, v56
    v_exp_f32 v57, v57
    v_exp_f32 v58, v58
    v_exp_f32 v59, v59
    v_mfma_f32_32x32x16_bf16 v[72:87], v[96:99], v[16:19], v[40:55]
    v_cvt_pk_bf16_f32 v88, v56, v57
    v_cvt_pk_bf16_f32 v89, v58, v59
    v_exp_f32 v60, v60
    v_exp_f32 v61, v61
    v_mfma_f32_16x16x32_bf16 v[164:167], v[168:171], v[92:95], v[164:167]
    v_exp_f32 v62, v62
    v_exp_f32 v63, v63
    v_cvt_pk_bf16_f32 v90, v60, v61
    v_cvt_pk_bf16_f32 v91, v62, v63
    v_mfma_f32_32x32x16_bf16 v[72:87], v[100:103], v[20:23], v[72:87]
    s_add_u32 m0, s26, 16384
    s_nop 0
    buffer_load_dwordx4 v1, s[16:19], s23 offen offset:0 sc1 lds
    v_exp_f32 v64, v64
    v_exp_f32 v65, v65
    v_exp_f32 v66, v66
    v_exp_f32 v67, v67
    v_mfma_f32_32x32x16_bf16 v[144:159], v[124:127], v[92:95], v[144:159]
    v_cvt_pk_bf16_f32 v92, v64, v65
    v_cvt_pk_bf16_f32 v93, v66, v67
    v_exp_f32 v68, v68
    v_exp_f32 v69, v69
    v_mfma_f32_32x32x16_bf16 v[128:143], v[112:115], v[88:91], v[128:143]
    v_exp_f32 v70, v70
    v_exp_f32 v71, v71
    v_cvt_pk_bf16_f32 v94, v68, v69
    v_cvt_pk_bf16_f32 v95, v70, v71
    v_mfma_f32_16x16x32_bf16 v[160:163], v[168:171], v[88:91], v[160:163]
    s_waitcnt lgkmcnt(0)
    ds_read_b128 v[120:123], v7 offset:51200
    ds_read_b128 v[124:127], v7 offset:52224
    v_exp_f32 v72, v72
    v_exp_f32 v73, v73
    v_exp_f32 v74, v74
    v_exp_f32 v75, v75
    v_mfma_f32_32x32x16_bf16 v[56:71], v[104:107], v[8:11], v[24:39]
    v_cvt_pk_bf16_f32 v88, v72, v73
    v_cvt_pk_bf16_f32 v89, v74, v75
    v_exp_f32 v76, v76
    v_exp_f32 v77, v77
    v_mfma_f32_16x16x32_bf16 v[160:163], v[168:171], v[92:95], v[160:163]
    v_exp_f32 v78, v78
    v_exp_f32 v79, v79
    v_cvt_pk_bf16_f32 v90, v76, v77
    v_cvt_pk_bf16_f32 v91, v78, v79
    v_mfma_f32_32x32x16_bf16 v[56:71], v[108:111], v[12:15], v[56:71]
    buffer_load_dwordx4 v1, s[16:19], s23 offen offset:1024 sc1 lds
    s_add_u32 s23, s23, 16384
    v_exp_f32 v80, v80
    v_exp_f32 v81, v81
    v_exp_f32 v82, v82
    v_exp_f32 v83, v83
    v_mfma_f32_32x32x16_bf16 v[128:143], v[116:119], v[92:95], v[128:143]
    v_cvt_pk_bf16_f32 v92, v80, v81
    v_cvt_pk_bf16_f32 v93, v82, v83
    v_exp_f32 v84, v84
    v_exp_f32 v85, v85
    v_mfma_f32_32x32x16_bf16 v[144:159], v[112:115], v[88:91], v[144:159]
    v_exp_f32 v86, v86
    v_exp_f32 v87, v87
    v_cvt_pk_bf16_f32 v94, v84, v85
    v_cvt_pk_bf16_f32 v95, v86, v87
    v_mfma_f32_16x16x32_bf16 v[164:167], v[168:171], v[88:91], v[164:167]
    s_waitcnt lgkmcnt(0)
    s_setprio 1
    ds_read_b128 v[96:99], v7 offset:36864
    ds_read_b128 v[100:103], v7 offset:37888
    v_exp_f32 v56, v56
    v_exp_f32 v57, v57
    v_exp_f32 v58, v58
    v_exp_f32 v59, v59
    v_mfma_f32_32x32x16_bf16 v[72:87], v[104:107], v[16:19], v[40:55]
    v_cvt_pk_bf16_f32 v88, v56, v57
    v_cvt_pk_bf16_f32 v89, v58, v59
    v_exp_f32 v60, v60
    v_exp_f32 v61, v61
    v_mfma_f32_16x16x32_bf16 v[164:167], v[168:171], v[92:95], v[164:167]
    v_exp_f32 v62, v62
    v_exp_f32 v63, v63
    v_cvt_pk_bf16_f32 v90, v60, v61
    v_cvt_pk_bf16_f32 v91, v62, v63
    v_mfma_f32_32x32x16_bf16 v[72:87], v[108:111], v[20:23], v[72:87]
    v_exp_f32 v64, v64
    v_exp_f32 v65, v65
    v_exp_f32 v66, v66
    v_exp_f32 v67, v67
    v_mfma_f32_32x32x16_bf16 v[144:159], v[116:119], v[92:95], v[144:159]
    v_cvt_pk_bf16_f32 v92, v64, v65
    v_cvt_pk_bf16_f32 v93, v66, v67
    v_exp_f32 v68, v68
    v_exp_f32 v69, v69
    v_mfma_f32_32x32x16_bf16 v[128:143], v[120:123], v[88:91], v[128:143]
    v_exp_f32 v70, v70
    v_exp_f32 v71, v71
    v_cvt_pk_bf16_f32 v94, v68, v69
    v_cvt_pk_bf16_f32 v95, v70, v71
    v_mfma_f32_16x16x32_bf16 v[160:163], v[168:171], v[88:91], v[160:163]
    s_waitcnt lgkmcnt(0)
    ds_read_b128 v[112:115], v7 offset:53248
    ds_read_b128 v[116:119], v7 offset:54272
    v_exp_f32 v72, v72
    v_exp_f32 v73, v73
    v_exp_f32 v74, v74
    v_exp_f32 v75, v75
    v_mfma_f32_32x32x16_bf16 v[56:71], v[96:99], v[8:11], v[24:39]
    v_cvt_pk_bf16_f32 v88, v72, v73
    v_cvt_pk_bf16_f32 v89, v74, v75
    v_exp_f32 v76, v76
    v_exp_f32 v77, v77
    v_mfma_f32_16x16x32_bf16 v[160:163], v[168:171], v[92:95], v[160:163]
    v_exp_f32 v78, v78
    v_exp_f32 v79, v79
    v_cvt_pk_bf16_f32 v90, v76, v77
    v_cvt_pk_bf16_f32 v91, v78, v79
    v_mfma_f32_32x32x16_bf16 v[56:71], v[100:103], v[12:15], v[56:71]
    v_exp_f32 v80, v80
    v_exp_f32 v81, v81
    v_exp_f32 v82, v82
    v_exp_f32 v83, v83
    v_mfma_f32_32x32x16_bf16 v[128:143], v[124:127], v[92:95], v[128:143]
    v_cvt_pk_bf16_f32 v92, v80, v81
    v_cvt_pk_bf16_f32 v93, v82, v83
    v_exp_f32 v84, v84
    v_exp_f32 v85, v85
    v_mfma_f32_32x32x16_bf16 v[144:159], v[120:123], v[88:91], v[144:159]
    v_exp_f32 v86, v86
    v_exp_f32 v87, v87
    v_cvt_pk_bf16_f32 v94, v84, v85
    v_cvt_pk_bf16_f32 v95, v86, v87
    v_mfma_f32_16x16x32_bf16 v[164:167], v[168:171], v[88:91], v[164:167]
    s_waitcnt lgkmcnt(0)
    s_setprio 0
    ds_read_b128 v[104:107], v7 offset:38912
    ds_read_b128 v[108:111], v7 offset:39936
    v_exp_f32 v56, v56
    v_exp_f32 v57, v57
    v_exp_f32 v58, v58
    v_exp_f32 v59, v59
    v_mfma_f32_32x32x16_bf16 v[72:87], v[96:99], v[16:19], v[40:55]
    v_cvt_pk_bf16_f32 v88, v56, v57
    v_cvt_pk_bf16_f32 v89, v58, v59
    v_exp_f32 v60, v60
    v_exp_f32 v61, v61
    v_mfma_f32_16x16x32_bf16 v[164:167], v[168:171], v[92:95], v[164:167]
    v_exp_f32 v62, v62
    v_exp_f32 v63, v63
    v_cvt_pk_bf16_f32 v90, v60, v61
    v_cvt_pk_bf16_f32 v91, v62, v63
    v_mfma_f32_32x32x16_bf16 v[72:87], v[100:103], v[20:23], v[72:87]
    v_exp_f32 v64, v64
    v_exp_f32 v65, v65
    v_exp_f32 v66, v66
    v_exp_f32 v67, v67
    v_mfma_f32_32x32x16_bf16 v[144:159], v[124:127], v[92:95], v[144:159]
    v_cvt_pk_bf16_f32 v92, v64, v65
    v_cvt_pk_bf16_f32 v93, v66, v67
    v_exp_f32 v68, v68
    v_exp_f32 v69, v69
    v_mfma_f32_32x32x16_bf16 v[128:143], v[112:115], v[88:91], v[128:143]
    v_exp_f32 v70, v70
    v_exp_f32 v71, v71
    v_cvt_pk_bf16_f32 v94, v68, v69
    v_cvt_pk_bf16_f32 v95, v70, v71
    v_mfma_f32_16x16x32_bf16 v[160:163], v[168:171], v[88:91], v[160:163]
    s_waitcnt lgkmcnt(0)
    ds_read_b128 v[120:123], v7 offset:55296
    ds_read_b128 v[124:127], v7 offset:56320
    v_exp_f32 v72, v72
    v_exp_f32 v73, v73
    v_exp_f32 v74, v74
    v_exp_f32 v75, v75
    v_mfma_f32_32x32x16_bf16 v[56:71], v[104:107], v[8:11], v[24:39]
    v_cvt_pk_bf16_f32 v88, v72, v73
    v_cvt_pk_bf16_f32 v89, v74, v75
    v_exp_f32 v76, v76
    v_exp_f32 v77, v77
    v_mfma_f32_16x16x32_bf16 v[160:163], v[168:171], v[92:95], v[160:163]
    v_exp_f32 v78, v78
    v_exp_f32 v79, v79
    v_cvt_pk_bf16_f32 v90, v76, v77
    v_cvt_pk_bf16_f32 v91, v78, v79
    v_mfma_f32_32x32x16_bf16 v[56:71], v[108:111], v[12:15], v[56:71]
    v_exp_f32 v80, v80
    v_exp_f32 v81, v81
    v_exp_f32 v82, v82
    v_exp_f32 v83, v83
    v_mfma_f32_32x32x16_bf16 v[128:143], v[116:119], v[92:95], v[128:143]
    v_cvt_pk_bf16_f32 v92, v80, v81
    v_cvt_pk_bf16_f32 v93, v82, v83
    v_exp_f32 v84, v84
    v_exp_f32 v85, v85
    v_mfma_f32_32x32x16_bf16 v[144:159], v[112:115], v[88:91], v[144:159]
    v_exp_f32 v86, v86
    v_exp_f32 v87, v87
    v_cvt_pk_bf16_f32 v94, v84, v85
    v_cvt_pk_bf16_f32 v95, v86, v87
    v_mfma_f32_16x16x32_bf16 v[164:167], v[168:171], v[88:91], v[164:167]
    s_waitcnt lgkmcnt(0)
    s_waitcnt vmcnt(0)
    s_barrier
    v_pk_add_f32 v[176:177], v[176:177], v[184:185]
    v_pk_add_f32 v[178:179], v[178:179], v[186:187]
    v_pk_add_f32 v[180:181], v[180:181], v[188:189]
    v_pk_add_f32 v[182:183], v[182:183], v[190:191]
    v_pk_add_f32 v[176:177], v[176:177], v[192:193]
    v_pk_add_f32 v[178:179], v[178:179], v[194:195]
    v_pk_add_f32 v[180:181], v[180:181], v[196:197]
    v_pk_add_f32 v[182:183], v[182:183], v[198:199]
    v_pk_add_f32 v[176:177], v[176:177], v[200:201]
    v_pk_add_f32 v[178:179], v[178:179], v[202:203]
    v_pk_add_f32 v[180:181], v[180:181], v[204:205]
    v_pk_add_f32 v[182:183], v[182:183], v[206:207]
    buffer_load_dwordx4 v[184:187], v1, s[44:47], s48 offen sc1
    buffer_load_dwordx4 v[188:191], v246, s[44:47], s49 offen sc1
    s_add_u32 s48, s48, 16384
    s_add_u32 s49, s49, 16384
    buffer_load_dwordx4 v[192:195], v1, s[44:47], s48 offen sc1
    buffer_load_dwordx4 v[196:199], v246, s[44:47], s49 offen sc1
    s_add_u32 s48, s48, 16384
    s_add_u32 s49, s49, 16384
    buffer_load_dwordx4 v[200:203], v1, s[44:47], s48 offen sc1
    buffer_load_dwordx4 v[204:207], v246, s[44:47], s49 offen sc1
    s_add_u32 s48, s48, 16384
    s_add_u32 s49, s49, 16384
    buffer_load_dwordx4 v[208:211], v1, s[84:87], s88 offen
    s_add_u32 s88, s88, 2048
    s_setprio 3
    ds_read_b128 v[96:99], v7 offset:0
    ds_read_b128 v[100:103], v7 offset:1024
    v_exp_f32 v56, v56
    v_exp_f32 v57, v57
    v_exp_f32 v58, v58
    v_exp_f32 v59, v59
    v_mfma_f32_32x32x16_bf16 v[72:87], v[104:107], v[16:19], v[40:55]
    v_cvt_pk_bf16_f32 v88, v56, v57
    v_cvt_pk_bf16_f32 v89, v58, v59
    v_exp_f32 v60, v60
    v_exp_f32 v61, v61
    v_mfma_f32_16x16x32_bf16 v[164:167], v[168:171], v[92:95], v[164:167]
    v_exp_f32 v62, v62
    v_exp_f32 v63, v63
    v_cvt_pk_bf16_f32 v90, v60, v61
    v_cvt_pk_bf16_f32 v91, v62, v63
    v_mfma_f32_32x32x16_bf16 v[72:87], v[108:111], v[20:23], v[72:87]
    s_add_u32 m0, s26, 32768
    s_nop 0
    buffer_load_dwordx4 v1, s[12:15], s23 offen offset:0 sc1 lds
    v_exp_f32 v64, v64
    v_exp_f32 v65, v65
    v_exp_f32 v66, v66
    v_exp_f32 v67, v67
    v_mfma_f32_32x32x16_bf16 v[144:159], v[116:119], v[92:95], v[144:159]
    v_cvt_pk_bf16_f32 v92, v64, v65
    v_cvt_pk_bf16_f32 v93, v66, v67
    v_exp_f32 v68, v68
    v_exp_f32 v69, v69
    v_mfma_f32_32x32x16_bf16 v[128:143], v[120:123], v[88:91], v[128:143]
    v_exp_f32 v70, v70
    v_exp_f32 v71, v71
    v_cvt_pk_bf16_f32 v94, v68, v69
    v_cvt_pk_bf16_f32 v95, v70, v71
    v_mfma_f32_16x16x32_bf16 v[160:163], v[168:171], v[88:91], v[160:163]
    s_waitcnt lgkmcnt(0)
    ds_read_b128 v[112:115], v7 offset:16384
    ds_read_b128 v[116:119], v7 offset:17408
    v_exp_f32 v72, v72
    v_exp_f32 v73, v73
    v_exp_f32 v74, v74
    v_exp_f32 v75, v75
    v_mfma_f32_32x32x16_bf16 v[56:71], v[96:99], v[8:11], v[24:39]
    v_cvt_pk_bf16_f32 v88, v72, v73
    v_cvt_pk_bf16_f32 v89, v74, v75
    v_exp_f32 v76, v76
    v_exp_f32 v77, v77
    v_mfma_f32_16x16x32_bf16 v[160:163], v[168:171], v[92:95], v[160:163]
    v_exp_f32 v78, v78
    v_exp_f32 v79, v79
    v_cvt_pk_bf16_f32 v90, v76, v77
    v_cvt_pk_bf16_f32 v91, v78, v79
    v_mfma_f32_32x32x16_bf16 v[56:71], v[100:103], v[12:15], v[56:71]
    buffer_load_dwordx4 v1, s[12:15], s23 offen offset:1024 sc1 lds
    v_exp_f32 v80, v80
    v_exp_f32 v81, v81
    v_exp_f32 v82, v82
    v_exp_f32 v83, v83
    v_mfma_f32_32x32x16_bf16 v[128:143], v[124:127], v[92:95], v[128:143]
    v_cvt_pk_bf16_f32 v92, v80, v81
    v_cvt_pk_bf16_f32 v93, v82, v83
    v_exp_f32 v84, v84
    v_exp_f32 v85, v85
    v_mfma_f32_32x32x16_bf16 v[144:159], v[120:123], v[88:91], v[144:159]
    v_exp_f32 v86, v86
    v_exp_f32 v87, v87
    v_cvt_pk_bf16_f32 v94, v84, v85
    v_cvt_pk_bf16_f32 v95, v86, v87
    v_mfma_f32_16x16x32_bf16 v[164:167], v[168:171], v[88:91], v[164:167]
    s_mov_b32 s24, 2
.p2align 6
gated_mix__softmax_full_mha__linear_kernel_hedgehog__prompt_kernel_loop:
    s_waitcnt lgkmcnt(0)
    s_setprio 2
    ds_read_b128 v[104:107], v7 offset:2048
    ds_read_b128 v[108:111], v7 offset:3072
    v_exp_f32 v56, v56
    v_exp_f32 v57, v57
    v_exp_f32 v58, v58
    v_exp_f32 v59, v59
    v_mfma_f32_32x32x16_bf16 v[72:87], v[96:99], v[16:19], v[40:55]
    v_cvt_pk_bf16_f32 v88, v56, v57
    v_cvt_pk_bf16_f32 v89, v58, v59
    v_exp_f32 v60, v60
    v_exp_f32 v61, v61
    v_mfma_f32_16x16x32_bf16 v[164:167], v[168:171], v[92:95], v[164:167]
    v_exp_f32 v62, v62
    v_exp_f32 v63, v63
    v_cvt_pk_bf16_f32 v90, v60, v61
    v_cvt_pk_bf16_f32 v91, v62, v63
    v_mfma_f32_32x32x16_bf16 v[72:87], v[100:103], v[20:23], v[72:87]
    s_add_u32 m0, s26, 49152
    s_nop 0
    buffer_load_dwordx4 v1, s[16:19], s23 offen offset:0 sc1 lds
    v_exp_f32 v64, v64
    v_exp_f32 v65, v65
    v_exp_f32 v66, v66
    v_exp_f32 v67, v67
    v_mfma_f32_32x32x16_bf16 v[144:159], v[124:127], v[92:95], v[144:159]
    v_cvt_pk_bf16_f32 v92, v64, v65
    v_cvt_pk_bf16_f32 v93, v66, v67
    v_exp_f32 v68, v68
    v_exp_f32 v69, v69
    v_mfma_f32_32x32x16_bf16 v[128:143], v[112:115], v[88:91], v[128:143]
    v_exp_f32 v70, v70
    v_exp_f32 v71, v71
    v_cvt_pk_bf16_f32 v94, v68, v69
    v_cvt_pk_bf16_f32 v95, v70, v71
    v_mfma_f32_16x16x32_bf16 v[160:163], v[168:171], v[88:91], v[160:163]
    s_waitcnt lgkmcnt(0)
    ds_read_b128 v[120:123], v7 offset:18432
    ds_read_b128 v[124:127], v7 offset:19456
    v_exp_f32 v72, v72
    v_exp_f32 v73, v73
    v_exp_f32 v74, v74
    v_exp_f32 v75, v75
    v_mfma_f32_32x32x16_bf16 v[56:71], v[104:107], v[8:11], v[24:39]
    v_cvt_pk_bf16_f32 v88, v72, v73
    v_cvt_pk_bf16_f32 v89, v74, v75
    v_exp_f32 v76, v76
    v_exp_f32 v77, v77
    v_mfma_f32_16x16x32_bf16 v[160:163], v[168:171], v[92:95], v[160:163]
    v_exp_f32 v78, v78
    v_exp_f32 v79, v79
    v_cvt_pk_bf16_f32 v90, v76, v77
    v_cvt_pk_bf16_f32 v91, v78, v79
    v_mfma_f32_32x32x16_bf16 v[56:71], v[108:111], v[12:15], v[56:71]
    buffer_load_dwordx4 v1, s[16:19], s23 offen offset:1024 sc1 lds
    s_add_u32 s23, s23, 16384
    v_exp_f32 v80, v80
    v_exp_f32 v81, v81
    v_exp_f32 v82, v82
    v_exp_f32 v83, v83
    v_mfma_f32_32x32x16_bf16 v[128:143], v[116:119], v[92:95], v[128:143]
    v_cvt_pk_bf16_f32 v92, v80, v81
    v_cvt_pk_bf16_f32 v93, v82, v83
    v_exp_f32 v84, v84
    v_exp_f32 v85, v85
    v_mfma_f32_32x32x16_bf16 v[144:159], v[112:115], v[88:91], v[144:159]
    v_exp_f32 v86, v86
    v_exp_f32 v87, v87
    v_cvt_pk_bf16_f32 v94, v84, v85
    v_cvt_pk_bf16_f32 v95, v86, v87
    v_mfma_f32_16x16x32_bf16 v[164:167], v[168:171], v[88:91], v[164:167]
    s_waitcnt lgkmcnt(0)
    s_setprio 1
    ds_read_b128 v[96:99], v7 offset:4096
    ds_read_b128 v[100:103], v7 offset:5120
    v_exp_f32 v56, v56
    v_exp_f32 v57, v57
    v_exp_f32 v58, v58
    v_exp_f32 v59, v59
    v_mfma_f32_32x32x16_bf16 v[72:87], v[104:107], v[16:19], v[40:55]
    v_cvt_pk_bf16_f32 v88, v56, v57
    v_cvt_pk_bf16_f32 v89, v58, v59
    v_exp_f32 v60, v60
    v_exp_f32 v61, v61
    v_mfma_f32_16x16x32_bf16 v[164:167], v[168:171], v[92:95], v[164:167]
    v_exp_f32 v62, v62
    v_exp_f32 v63, v63
    v_cvt_pk_bf16_f32 v90, v60, v61
    v_cvt_pk_bf16_f32 v91, v62, v63
    v_mfma_f32_32x32x16_bf16 v[72:87], v[108:111], v[20:23], v[72:87]
    v_exp_f32 v64, v64
    v_exp_f32 v65, v65
    v_exp_f32 v66, v66
    v_exp_f32 v67, v67
    v_mfma_f32_32x32x16_bf16 v[144:159], v[116:119], v[92:95], v[144:159]
    v_cvt_pk_bf16_f32 v92, v64, v65
    v_cvt_pk_bf16_f32 v93, v66, v67
    v_exp_f32 v68, v68
    v_exp_f32 v69, v69
    v_mfma_f32_32x32x16_bf16 v[128:143], v[120:123], v[88:91], v[128:143]
    v_exp_f32 v70, v70
    v_exp_f32 v71, v71
    v_cvt_pk_bf16_f32 v94, v68, v69
    v_cvt_pk_bf16_f32 v95, v70, v71
    v_mfma_f32_16x16x32_bf16 v[160:163], v[168:171], v[88:91], v[160:163]
    s_waitcnt lgkmcnt(0)
    ds_read_b128 v[112:115], v7 offset:20480
    ds_read_b128 v[116:119], v7 offset:21504
    v_exp_f32 v72, v72
    v_exp_f32 v73, v73
    v_exp_f32 v74, v74
    v_exp_f32 v75, v75
    v_mfma_f32_32x32x16_bf16 v[56:71], v[96:99], v[8:11], v[24:39]
    v_cvt_pk_bf16_f32 v88, v72, v73
    v_cvt_pk_bf16_f32 v89, v74, v75
    v_exp_f32 v76, v76
    v_exp_f32 v77, v77
    v_mfma_f32_16x16x32_bf16 v[160:163], v[168:171], v[92:95], v[160:163]
    v_exp_f32 v78, v78
    v_exp_f32 v79, v79
    v_cvt_pk_bf16_f32 v90, v76, v77
    v_cvt_pk_bf16_f32 v91, v78, v79
    v_mfma_f32_32x32x16_bf16 v[56:71], v[100:103], v[12:15], v[56:71]
    v_exp_f32 v80, v80
    v_exp_f32 v81, v81
    v_exp_f32 v82, v82
    v_exp_f32 v83, v83
    v_mfma_f32_32x32x16_bf16 v[128:143], v[124:127], v[92:95], v[128:143]
    v_cvt_pk_bf16_f32 v92, v80, v81
    v_cvt_pk_bf16_f32 v93, v82, v83
    v_exp_f32 v84, v84
    v_exp_f32 v85, v85
    v_mfma_f32_32x32x16_bf16 v[144:159], v[120:123], v[88:91], v[144:159]
    v_exp_f32 v86, v86
    v_exp_f32 v87, v87
    v_cvt_pk_bf16_f32 v94, v84, v85
    v_cvt_pk_bf16_f32 v95, v86, v87
    v_mfma_f32_16x16x32_bf16 v[164:167], v[168:171], v[88:91], v[164:167]
    s_waitcnt lgkmcnt(0)
    s_setprio 0
    ds_read_b128 v[104:107], v7 offset:6144
    ds_read_b128 v[108:111], v7 offset:7168
    v_exp_f32 v56, v56
    v_exp_f32 v57, v57
    v_exp_f32 v58, v58
    v_exp_f32 v59, v59
    v_mfma_f32_32x32x16_bf16 v[72:87], v[96:99], v[16:19], v[40:55]
    v_cvt_pk_bf16_f32 v88, v56, v57
    v_cvt_pk_bf16_f32 v89, v58, v59
    v_exp_f32 v60, v60
    v_exp_f32 v61, v61
    v_mfma_f32_16x16x32_bf16 v[164:167], v[168:171], v[92:95], v[164:167]
    v_exp_f32 v62, v62
    v_exp_f32 v63, v63
    v_cvt_pk_bf16_f32 v90, v60, v61
    v_cvt_pk_bf16_f32 v91, v62, v63
    v_mfma_f32_32x32x16_bf16 v[72:87], v[100:103], v[20:23], v[72:87]
    v_exp_f32 v64, v64
    v_exp_f32 v65, v65
    v_exp_f32 v66, v66
    v_exp_f32 v67, v67
    v_mfma_f32_32x32x16_bf16 v[144:159], v[124:127], v[92:95], v[144:159]
    v_cvt_pk_bf16_f32 v92, v64, v65
    v_cvt_pk_bf16_f32 v93, v66, v67
    v_exp_f32 v68, v68
    v_exp_f32 v69, v69
    v_mfma_f32_32x32x16_bf16 v[128:143], v[112:115], v[88:91], v[128:143]
    v_exp_f32 v70, v70
    v_exp_f32 v71, v71
    v_cvt_pk_bf16_f32 v94, v68, v69
    v_cvt_pk_bf16_f32 v95, v70, v71
    v_mfma_f32_16x16x32_bf16 v[160:163], v[168:171], v[88:91], v[160:163]
    s_waitcnt lgkmcnt(0)
    ds_read_b128 v[120:123], v7 offset:22528
    ds_read_b128 v[124:127], v7 offset:23552
    v_exp_f32 v72, v72
    v_exp_f32 v73, v73
    v_exp_f32 v74, v74
    v_exp_f32 v75, v75
    v_mfma_f32_32x32x16_bf16 v[56:71], v[104:107], v[8:11], v[24:39]
    v_cvt_pk_bf16_f32 v88, v72, v73
    v_cvt_pk_bf16_f32 v89, v74, v75
    v_exp_f32 v76, v76
    v_exp_f32 v77, v77
    v_mfma_f32_16x16x32_bf16 v[160:163], v[168:171], v[92:95], v[160:163]
    v_exp_f32 v78, v78
    v_exp_f32 v79, v79
    v_cvt_pk_bf16_f32 v90, v76, v77
    v_cvt_pk_bf16_f32 v91, v78, v79
    v_mfma_f32_32x32x16_bf16 v[56:71], v[108:111], v[12:15], v[56:71]
    v_exp_f32 v80, v80
    v_exp_f32 v81, v81
    v_exp_f32 v82, v82
    v_exp_f32 v83, v83
    v_mfma_f32_32x32x16_bf16 v[128:143], v[116:119], v[92:95], v[128:143]
    v_cvt_pk_bf16_f32 v92, v80, v81
    v_cvt_pk_bf16_f32 v93, v82, v83
    v_exp_f32 v84, v84
    v_exp_f32 v85, v85
    v_mfma_f32_32x32x16_bf16 v[144:159], v[112:115], v[88:91], v[144:159]
    v_exp_f32 v86, v86
    v_exp_f32 v87, v87
    v_cvt_pk_bf16_f32 v94, v84, v85
    v_cvt_pk_bf16_f32 v95, v86, v87
    v_mfma_f32_16x16x32_bf16 v[164:167], v[168:171], v[88:91], v[164:167]
    s_waitcnt lgkmcnt(0)
    s_waitcnt vmcnt(0)
    s_barrier
    v_pk_add_f32 v[176:177], v[176:177], v[184:185]
    v_pk_add_f32 v[178:179], v[178:179], v[186:187]
    v_pk_add_f32 v[180:181], v[180:181], v[188:189]
    v_pk_add_f32 v[182:183], v[182:183], v[190:191]
    v_pk_add_f32 v[176:177], v[176:177], v[192:193]
    v_pk_add_f32 v[178:179], v[178:179], v[194:195]
    v_pk_add_f32 v[180:181], v[180:181], v[196:197]
    v_pk_add_f32 v[182:183], v[182:183], v[198:199]
    v_pk_add_f32 v[176:177], v[176:177], v[200:201]
    v_pk_add_f32 v[178:179], v[178:179], v[202:203]
    v_pk_add_f32 v[180:181], v[180:181], v[204:205]
    v_pk_add_f32 v[182:183], v[182:183], v[206:207]
    buffer_load_dwordx4 v[184:187], v1, s[44:47], s48 offen sc1
    buffer_load_dwordx4 v[188:191], v246, s[44:47], s49 offen sc1
    s_add_u32 s48, s48, 16384
    s_add_u32 s49, s49, 16384
    buffer_load_dwordx4 v[192:195], v1, s[44:47], s48 offen sc1
    buffer_load_dwordx4 v[196:199], v246, s[44:47], s49 offen sc1
    s_add_u32 s48, s48, 16384
    s_add_u32 s49, s49, 16384
    buffer_load_dwordx4 v[200:203], v1, s[44:47], s48 offen sc1
    buffer_load_dwordx4 v[204:207], v246, s[44:47], s49 offen sc1
    s_add_u32 s48, s48, 16384
    s_add_u32 s49, s49, 16384
    buffer_load_dwordx4 v[208:211], v1, s[84:87], s88 offen
    s_add_u32 s88, s88, 2048
    s_setprio 3
    ds_read_b128 v[96:99], v7 offset:32768
    ds_read_b128 v[100:103], v7 offset:33792
    v_exp_f32 v56, v56
    v_exp_f32 v57, v57
    v_exp_f32 v58, v58
    v_exp_f32 v59, v59
    v_mfma_f32_32x32x16_bf16 v[72:87], v[104:107], v[16:19], v[40:55]
    v_cvt_pk_bf16_f32 v88, v56, v57
    v_cvt_pk_bf16_f32 v89, v58, v59
    v_exp_f32 v60, v60
    v_exp_f32 v61, v61
    v_mfma_f32_16x16x32_bf16 v[164:167], v[168:171], v[92:95], v[164:167]
    v_exp_f32 v62, v62
    v_exp_f32 v63, v63
    v_cvt_pk_bf16_f32 v90, v60, v61
    v_cvt_pk_bf16_f32 v91, v62, v63
    v_mfma_f32_32x32x16_bf16 v[72:87], v[108:111], v[20:23], v[72:87]
    s_add_u32 m0, s26, 0
    s_nop 0
    buffer_load_dwordx4 v1, s[12:15], s23 offen offset:0 sc1 lds
    v_exp_f32 v64, v64
    v_exp_f32 v65, v65
    v_exp_f32 v66, v66
    v_exp_f32 v67, v67
    v_mfma_f32_32x32x16_bf16 v[144:159], v[116:119], v[92:95], v[144:159]
    v_cvt_pk_bf16_f32 v92, v64, v65
    v_cvt_pk_bf16_f32 v93, v66, v67
    v_exp_f32 v68, v68
    v_exp_f32 v69, v69
    v_mfma_f32_32x32x16_bf16 v[128:143], v[120:123], v[88:91], v[128:143]
    v_exp_f32 v70, v70
    v_exp_f32 v71, v71
    v_cvt_pk_bf16_f32 v94, v68, v69
    v_cvt_pk_bf16_f32 v95, v70, v71
    v_mfma_f32_16x16x32_bf16 v[160:163], v[168:171], v[88:91], v[160:163]
    s_waitcnt lgkmcnt(0)
    ds_read_b128 v[112:115], v7 offset:49152
    ds_read_b128 v[116:119], v7 offset:50176
    v_exp_f32 v72, v72
    v_exp_f32 v73, v73
    v_exp_f32 v74, v74
    v_exp_f32 v75, v75
    v_mfma_f32_32x32x16_bf16 v[56:71], v[96:99], v[8:11], v[24:39]
    v_cvt_pk_bf16_f32 v88, v72, v73
    v_cvt_pk_bf16_f32 v89, v74, v75
    v_exp_f32 v76, v76
    v_exp_f32 v77, v77
    v_mfma_f32_16x16x32_bf16 v[160:163], v[168:171], v[92:95], v[160:163]
    v_exp_f32 v78, v78
    v_exp_f32 v79, v79
    v_cvt_pk_bf16_f32 v90, v76, v77
    v_cvt_pk_bf16_f32 v91, v78, v79
    v_mfma_f32_32x32x16_bf16 v[56:71], v[100:103], v[12:15], v[56:71]
    buffer_load_dwordx4 v1, s[12:15], s23 offen offset:1024 sc1 lds
    v_exp_f32 v80, v80
    v_exp_f32 v81, v81
    v_exp_f32 v82, v82
    v_exp_f32 v83, v83
    v_mfma_f32_32x32x16_bf16 v[128:143], v[124:127], v[92:95], v[128:143]
    v_cvt_pk_bf16_f32 v92, v80, v81
    v_cvt_pk_bf16_f32 v93, v82, v83
    v_exp_f32 v84, v84
    v_exp_f32 v85, v85
    v_mfma_f32_32x32x16_bf16 v[144:159], v[120:123], v[88:91], v[144:159]
    v_exp_f32 v86, v86
    v_exp_f32 v87, v87
    v_cvt_pk_bf16_f32 v94, v84, v85
    v_cvt_pk_bf16_f32 v95, v86, v87
    v_mfma_f32_16x16x32_bf16 v[164:167], v[168:171], v[88:91], v[164:167]
    s_waitcnt lgkmcnt(0)
    s_setprio 2
    ds_read_b128 v[104:107], v7 offset:34816
    ds_read_b128 v[108:111], v7 offset:35840
    v_exp_f32 v56, v56
    v_exp_f32 v57, v57
    v_exp_f32 v58, v58
    v_exp_f32 v59, v59
    v_mfma_f32_32x32x16_bf16 v[72:87], v[96:99], v[16:19], v[40:55]
    v_cvt_pk_bf16_f32 v88, v56, v57
    v_cvt_pk_bf16_f32 v89, v58, v59
    v_exp_f32 v60, v60
    v_exp_f32 v61, v61
    v_mfma_f32_16x16x32_bf16 v[164:167], v[168:171], v[92:95], v[164:167]
    v_exp_f32 v62, v62
    v_exp_f32 v63, v63
    v_cvt_pk_bf16_f32 v90, v60, v61
    v_cvt_pk_bf16_f32 v91, v62, v63
    v_mfma_f32_32x32x16_bf16 v[72:87], v[100:103], v[20:23], v[72:87]
    s_add_u32 m0, s26, 16384
    s_nop 0
    buffer_load_dwordx4 v1, s[16:19], s23 offen offset:0 sc1 lds
    v_exp_f32 v64, v64
    v_exp_f32 v65, v65
    v_exp_f32 v66, v66
    v_exp_f32 v67, v67
    v_mfma_f32_32x32x16_bf16 v[144:159], v[124:127], v[92:95], v[144:159]
    v_cvt_pk_bf16_f32 v92, v64, v65
    v_cvt_pk_bf16_f32 v93, v66, v67
    v_exp_f32 v68, v68
    v_exp_f32 v69, v69
    v_mfma_f32_32x32x16_bf16 v[128:143], v[112:115], v[88:91], v[128:143]
    v_exp_f32 v70, v70
    v_exp_f32 v71, v71
    v_cvt_pk_bf16_f32 v94, v68, v69
    v_cvt_pk_bf16_f32 v95, v70, v71
    v_mfma_f32_16x16x32_bf16 v[160:163], v[168:171], v[88:91], v[160:163]
    s_waitcnt lgkmcnt(0)
    ds_read_b128 v[120:123], v7 offset:51200
    ds_read_b128 v[124:127], v7 offset:52224
    v_exp_f32 v72, v72
    v_exp_f32 v73, v73
    v_exp_f32 v74, v74
    v_exp_f32 v75, v75
    v_mfma_f32_32x32x16_bf16 v[56:71], v[104:107], v[8:11], v[24:39]
    v_cvt_pk_bf16_f32 v88, v72, v73
    v_cvt_pk_bf16_f32 v89, v74, v75
    v_exp_f32 v76, v76
    v_exp_f32 v77, v77
    v_mfma_f32_16x16x32_bf16 v[160:163], v[168:171], v[92:95], v[160:163]
    v_exp_f32 v78, v78
    v_exp_f32 v79, v79
    v_cvt_pk_bf16_f32 v90, v76, v77
    v_cvt_pk_bf16_f32 v91, v78, v79
    v_mfma_f32_32x32x16_bf16 v[56:71], v[108:111], v[12:15], v[56:71]
    buffer_load_dwordx4 v1, s[16:19], s23 offen offset:1024 sc1 lds
    s_add_u32 s23, s23, 16384
    v_exp_f32 v80, v80
    v_exp_f32 v81, v81
    v_exp_f32 v82, v82
    v_exp_f32 v83, v83
    v_mfma_f32_32x32x16_bf16 v[128:143], v[116:119], v[92:95], v[128:143]
    v_cvt_pk_bf16_f32 v92, v80, v81
    v_cvt_pk_bf16_f32 v93, v82, v83
    v_exp_f32 v84, v84
    v_exp_f32 v85, v85
    v_mfma_f32_32x32x16_bf16 v[144:159], v[112:115], v[88:91], v[144:159]
    v_exp_f32 v86, v86
    v_exp_f32 v87, v87
    v_cvt_pk_bf16_f32 v94, v84, v85
    v_cvt_pk_bf16_f32 v95, v86, v87
    v_mfma_f32_16x16x32_bf16 v[164:167], v[168:171], v[88:91], v[164:167]
    s_waitcnt lgkmcnt(0)
    s_setprio 1
    ds_read_b128 v[96:99], v7 offset:36864
    ds_read_b128 v[100:103], v7 offset:37888
    v_exp_f32 v56, v56
    v_exp_f32 v57, v57
    v_exp_f32 v58, v58
    v_exp_f32 v59, v59
    v_mfma_f32_32x32x16_bf16 v[72:87], v[104:107], v[16:19], v[40:55]
    v_cvt_pk_bf16_f32 v88, v56, v57
    v_cvt_pk_bf16_f32 v89, v58, v59
    v_exp_f32 v60, v60
    v_exp_f32 v61, v61
    v_mfma_f32_16x16x32_bf16 v[164:167], v[168:171], v[92:95], v[164:167]
    v_exp_f32 v62, v62
    v_exp_f32 v63, v63
    v_cvt_pk_bf16_f32 v90, v60, v61
    v_cvt_pk_bf16_f32 v91, v62, v63
    v_mfma_f32_32x32x16_bf16 v[72:87], v[108:111], v[20:23], v[72:87]
    v_exp_f32 v64, v64
    v_exp_f32 v65, v65
    v_exp_f32 v66, v66
    v_exp_f32 v67, v67
    v_mfma_f32_32x32x16_bf16 v[144:159], v[116:119], v[92:95], v[144:159]
    v_cvt_pk_bf16_f32 v92, v64, v65
    v_cvt_pk_bf16_f32 v93, v66, v67
    v_exp_f32 v68, v68
    v_exp_f32 v69, v69
    v_mfma_f32_32x32x16_bf16 v[128:143], v[120:123], v[88:91], v[128:143]
    v_exp_f32 v70, v70
    v_exp_f32 v71, v71
    v_cvt_pk_bf16_f32 v94, v68, v69
    v_cvt_pk_bf16_f32 v95, v70, v71
    v_mfma_f32_16x16x32_bf16 v[160:163], v[168:171], v[88:91], v[160:163]
    s_waitcnt lgkmcnt(0)
    ds_read_b128 v[112:115], v7 offset:53248
    ds_read_b128 v[116:119], v7 offset:54272
    v_exp_f32 v72, v72
    v_exp_f32 v73, v73
    v_exp_f32 v74, v74
    v_exp_f32 v75, v75
    v_mfma_f32_32x32x16_bf16 v[56:71], v[96:99], v[8:11], v[24:39]
    v_cvt_pk_bf16_f32 v88, v72, v73
    v_cvt_pk_bf16_f32 v89, v74, v75
    v_exp_f32 v76, v76
    v_exp_f32 v77, v77
    v_mfma_f32_16x16x32_bf16 v[160:163], v[168:171], v[92:95], v[160:163]
    v_exp_f32 v78, v78
    v_exp_f32 v79, v79
    v_cvt_pk_bf16_f32 v90, v76, v77
    v_cvt_pk_bf16_f32 v91, v78, v79
    v_mfma_f32_32x32x16_bf16 v[56:71], v[100:103], v[12:15], v[56:71]
    v_exp_f32 v80, v80
    v_exp_f32 v81, v81
    v_exp_f32 v82, v82
    v_exp_f32 v83, v83
    v_mfma_f32_32x32x16_bf16 v[128:143], v[124:127], v[92:95], v[128:143]
    v_cvt_pk_bf16_f32 v92, v80, v81
    v_cvt_pk_bf16_f32 v93, v82, v83
    v_exp_f32 v84, v84
    v_exp_f32 v85, v85
    v_mfma_f32_32x32x16_bf16 v[144:159], v[120:123], v[88:91], v[144:159]
    v_exp_f32 v86, v86
    v_exp_f32 v87, v87
    v_cvt_pk_bf16_f32 v94, v84, v85
    v_cvt_pk_bf16_f32 v95, v86, v87
    v_mfma_f32_16x16x32_bf16 v[164:167], v[168:171], v[88:91], v[164:167]
    s_waitcnt lgkmcnt(0)
    s_setprio 0
    ds_read_b128 v[104:107], v7 offset:38912
    ds_read_b128 v[108:111], v7 offset:39936
    v_exp_f32 v56, v56
    v_exp_f32 v57, v57
    v_exp_f32 v58, v58
    v_exp_f32 v59, v59
    v_mfma_f32_32x32x16_bf16 v[72:87], v[96:99], v[16:19], v[40:55]
    v_cvt_pk_bf16_f32 v88, v56, v57
    v_cvt_pk_bf16_f32 v89, v58, v59
    v_exp_f32 v60, v60
    v_exp_f32 v61, v61
    v_mfma_f32_16x16x32_bf16 v[164:167], v[168:171], v[92:95], v[164:167]
    v_exp_f32 v62, v62
    v_exp_f32 v63, v63
    v_cvt_pk_bf16_f32 v90, v60, v61
    v_cvt_pk_bf16_f32 v91, v62, v63
    v_mfma_f32_32x32x16_bf16 v[72:87], v[100:103], v[20:23], v[72:87]
    v_exp_f32 v64, v64
    v_exp_f32 v65, v65
    v_exp_f32 v66, v66
    v_exp_f32 v67, v67
    v_mfma_f32_32x32x16_bf16 v[144:159], v[124:127], v[92:95], v[144:159]
    v_cvt_pk_bf16_f32 v92, v64, v65
    v_cvt_pk_bf16_f32 v93, v66, v67
    v_exp_f32 v68, v68
    v_exp_f32 v69, v69
    v_mfma_f32_32x32x16_bf16 v[128:143], v[112:115], v[88:91], v[128:143]
    v_exp_f32 v70, v70
    v_exp_f32 v71, v71
    v_cvt_pk_bf16_f32 v94, v68, v69
    v_cvt_pk_bf16_f32 v95, v70, v71
    v_mfma_f32_16x16x32_bf16 v[160:163], v[168:171], v[88:91], v[160:163]
    s_waitcnt lgkmcnt(0)
    ds_read_b128 v[120:123], v7 offset:55296
    ds_read_b128 v[124:127], v7 offset:56320
    v_exp_f32 v72, v72
    v_exp_f32 v73, v73
    v_exp_f32 v74, v74
    v_exp_f32 v75, v75
    v_mfma_f32_32x32x16_bf16 v[56:71], v[104:107], v[8:11], v[24:39]
    v_cvt_pk_bf16_f32 v88, v72, v73
    v_cvt_pk_bf16_f32 v89, v74, v75
    v_exp_f32 v76, v76
    v_exp_f32 v77, v77
    v_mfma_f32_16x16x32_bf16 v[160:163], v[168:171], v[92:95], v[160:163]
    v_exp_f32 v78, v78
    v_exp_f32 v79, v79
    v_cvt_pk_bf16_f32 v90, v76, v77
    v_cvt_pk_bf16_f32 v91, v78, v79
    v_mfma_f32_32x32x16_bf16 v[56:71], v[108:111], v[12:15], v[56:71]
    v_exp_f32 v80, v80
    v_exp_f32 v81, v81
    v_exp_f32 v82, v82
    v_exp_f32 v83, v83
    v_mfma_f32_32x32x16_bf16 v[128:143], v[116:119], v[92:95], v[128:143]
    v_cvt_pk_bf16_f32 v92, v80, v81
    v_cvt_pk_bf16_f32 v93, v82, v83
    v_exp_f32 v84, v84
    v_exp_f32 v85, v85
    v_mfma_f32_32x32x16_bf16 v[144:159], v[112:115], v[88:91], v[144:159]
    v_exp_f32 v86, v86
    v_exp_f32 v87, v87
    v_cvt_pk_bf16_f32 v94, v84, v85
    v_cvt_pk_bf16_f32 v95, v86, v87
    v_mfma_f32_16x16x32_bf16 v[164:167], v[168:171], v[88:91], v[164:167]
    s_waitcnt lgkmcnt(0)
    s_waitcnt vmcnt(0)
    s_barrier
    v_pk_add_f32 v[176:177], v[176:177], v[184:185]
    v_pk_add_f32 v[178:179], v[178:179], v[186:187]
    v_pk_add_f32 v[180:181], v[180:181], v[188:189]
    v_pk_add_f32 v[182:183], v[182:183], v[190:191]
    v_pk_add_f32 v[176:177], v[176:177], v[192:193]
    v_pk_add_f32 v[178:179], v[178:179], v[194:195]
    v_pk_add_f32 v[180:181], v[180:181], v[196:197]
    v_pk_add_f32 v[182:183], v[182:183], v[198:199]
    v_pk_add_f32 v[176:177], v[176:177], v[200:201]
    v_pk_add_f32 v[178:179], v[178:179], v[202:203]
    v_pk_add_f32 v[180:181], v[180:181], v[204:205]
    v_pk_add_f32 v[182:183], v[182:183], v[206:207]
    buffer_load_dwordx4 v[184:187], v1, s[44:47], s48 offen sc1
    buffer_load_dwordx4 v[188:191], v246, s[44:47], s49 offen sc1
    s_add_u32 s48, s48, 16384
    s_add_u32 s49, s49, 16384
    buffer_load_dwordx4 v[192:195], v1, s[44:47], s48 offen sc1
    buffer_load_dwordx4 v[196:199], v246, s[44:47], s49 offen sc1
    s_add_u32 s48, s48, 16384
    s_add_u32 s49, s49, 16384
    buffer_load_dwordx4 v[200:203], v1, s[44:47], s48 offen sc1
    buffer_load_dwordx4 v[204:207], v246, s[44:47], s49 offen sc1
    s_add_u32 s48, s48, 16384
    s_add_u32 s49, s49, 16384
    buffer_load_dwordx4 v[208:211], v1, s[84:87], s88 offen
    s_add_u32 s88, s88, 2048
    s_setprio 3
    ds_read_b128 v[96:99], v7 offset:0
    ds_read_b128 v[100:103], v7 offset:1024
    v_exp_f32 v56, v56
    v_exp_f32 v57, v57
    v_exp_f32 v58, v58
    v_exp_f32 v59, v59
    v_mfma_f32_32x32x16_bf16 v[72:87], v[104:107], v[16:19], v[40:55]
    v_cvt_pk_bf16_f32 v88, v56, v57
    v_cvt_pk_bf16_f32 v89, v58, v59
    v_exp_f32 v60, v60
    v_exp_f32 v61, v61
    v_mfma_f32_16x16x32_bf16 v[164:167], v[168:171], v[92:95], v[164:167]
    v_exp_f32 v62, v62
    v_exp_f32 v63, v63
    v_cvt_pk_bf16_f32 v90, v60, v61
    v_cvt_pk_bf16_f32 v91, v62, v63
    v_mfma_f32_32x32x16_bf16 v[72:87], v[108:111], v[20:23], v[72:87]
    s_add_u32 m0, s26, 32768
    s_nop 0
    buffer_load_dwordx4 v1, s[12:15], s23 offen offset:0 sc1 lds
    v_exp_f32 v64, v64
    v_exp_f32 v65, v65
    v_exp_f32 v66, v66
    v_exp_f32 v67, v67
    v_mfma_f32_32x32x16_bf16 v[144:159], v[116:119], v[92:95], v[144:159]
    v_cvt_pk_bf16_f32 v92, v64, v65
    v_cvt_pk_bf16_f32 v93, v66, v67
    v_exp_f32 v68, v68
    v_exp_f32 v69, v69
    v_mfma_f32_32x32x16_bf16 v[128:143], v[120:123], v[88:91], v[128:143]
    v_exp_f32 v70, v70
    v_exp_f32 v71, v71
    v_cvt_pk_bf16_f32 v94, v68, v69
    v_cvt_pk_bf16_f32 v95, v70, v71
    v_mfma_f32_16x16x32_bf16 v[160:163], v[168:171], v[88:91], v[160:163]
    s_waitcnt lgkmcnt(0)
    ds_read_b128 v[112:115], v7 offset:16384
    ds_read_b128 v[116:119], v7 offset:17408
    v_exp_f32 v72, v72
    v_exp_f32 v73, v73
    v_exp_f32 v74, v74
    v_exp_f32 v75, v75
    v_mfma_f32_32x32x16_bf16 v[56:71], v[96:99], v[8:11], v[24:39]
    v_cvt_pk_bf16_f32 v88, v72, v73
    v_cvt_pk_bf16_f32 v89, v74, v75
    v_exp_f32 v76, v76
    v_exp_f32 v77, v77
    v_mfma_f32_16x16x32_bf16 v[160:163], v[168:171], v[92:95], v[160:163]
    v_exp_f32 v78, v78
    v_exp_f32 v79, v79
    v_cvt_pk_bf16_f32 v90, v76, v77
    v_cvt_pk_bf16_f32 v91, v78, v79
    v_mfma_f32_32x32x16_bf16 v[56:71], v[100:103], v[12:15], v[56:71]
    buffer_load_dwordx4 v1, s[12:15], s23 offen offset:1024 sc1 lds
    v_exp_f32 v80, v80
    v_exp_f32 v81, v81
    v_exp_f32 v82, v82
    v_exp_f32 v83, v83
    v_mfma_f32_32x32x16_bf16 v[128:143], v[124:127], v[92:95], v[128:143]
    v_cvt_pk_bf16_f32 v92, v80, v81
    v_cvt_pk_bf16_f32 v93, v82, v83
    v_exp_f32 v84, v84
    v_exp_f32 v85, v85
    v_mfma_f32_32x32x16_bf16 v[144:159], v[120:123], v[88:91], v[144:159]
    v_exp_f32 v86, v86
    v_exp_f32 v87, v87
    v_cvt_pk_bf16_f32 v94, v84, v85
    v_cvt_pk_bf16_f32 v95, v86, v87
    v_mfma_f32_16x16x32_bf16 v[164:167], v[168:171], v[88:91], v[164:167]
    s_sub_u32 s24, s24, 1
    s_cmp_lg_u32 s24, 0
    s_cbranch_scc1 gated_mix__softmax_full_mha__linear_kernel_hedgehog__prompt_kernel_loop
    s_nop 1
    v_mfma_f32_32x32x16_bf16 v[144:159], v[124:127], v[92:95], v[144:159]
    v_mfma_f32_16x16x32_bf16 v[164:167], v[168:171], v[92:95], v[164:167]
    s_setprio 0
    s_waitcnt vmcnt(0) lgkmcnt(0)
    v_pk_add_f32 v[176:177], v[176:177], v[184:185]
    v_pk_add_f32 v[178:179], v[178:179], v[186:187]
    v_pk_add_f32 v[180:181], v[180:181], v[188:189]
    v_pk_add_f32 v[182:183], v[182:183], v[190:191]
    v_pk_add_f32 v[176:177], v[176:177], v[192:193]
    v_pk_add_f32 v[178:179], v[178:179], v[194:195]
    v_pk_add_f32 v[180:181], v[180:181], v[196:197]
    v_pk_add_f32 v[182:183], v[182:183], v[198:199]
    v_pk_add_f32 v[176:177], v[176:177], v[200:201]
    v_pk_add_f32 v[178:179], v[178:179], v[202:203]
    v_pk_add_f32 v[180:181], v[180:181], v[204:205]
    v_pk_add_f32 v[182:183], v[182:183], v[206:207]
    s_mov_b32 s3, 0
    v_mul_f32 v2, 1132462080, v160
    v_mul_f32 v4, 1132462080, v164
    v_mul_f32 v2, 0, v2
    v_fma_f32 v2, v4, 0, v2
    v_mov_b32 v216, 0
    v_mov_b32 v217, 0
    v_pk_fma_f32 v[216:217], v[128:129], 0, v[216:217] op_sel_hi:[1,0,1]
    v_pk_fma_f32 v[216:217], v[130:131], 0, v[216:217] op_sel_hi:[1,0,1]
    v_pk_fma_f32 v[216:217], v[132:133], 0, v[216:217] op_sel_hi:[1,0,1]
    v_pk_fma_f32 v[216:217], v[134:135], 0, v[216:217] op_sel_hi:[1,0,1]
    v_pk_fma_f32 v[216:217], v[136:137], 0, v[216:217] op_sel_hi:[1,0,1]
    v_pk_fma_f32 v[216:217], v[138:139], 0, v[216:217] op_sel_hi:[1,0,1]
    v_pk_fma_f32 v[216:217], v[140:141], 0, v[216:217] op_sel_hi:[1,0,1]
    v_pk_fma_f32 v[216:217], v[142:143], 0, v[216:217] op_sel_hi:[1,0,1]
    v_pk_fma_f32 v[216:217], v[144:145], 0, v[216:217] op_sel_hi:[1,0,1]
    v_pk_fma_f32 v[216:217], v[146:147], 0, v[216:217] op_sel_hi:[1,0,1]
    v_pk_fma_f32 v[216:217], v[148:149], 0, v[216:217] op_sel_hi:[1,0,1]
    v_pk_fma_f32 v[216:217], v[150:151], 0, v[216:217] op_sel_hi:[1,0,1]
    v_pk_fma_f32 v[216:217], v[152:153], 0, v[216:217] op_sel_hi:[1,0,1]
    v_pk_fma_f32 v[216:217], v[154:155], 0, v[216:217] op_sel_hi:[1,0,1]
    v_pk_fma_f32 v[216:217], v[156:157], 0, v[216:217] op_sel_hi:[1,0,1]
    v_pk_fma_f32 v[216:217], v[158:159], 0, v[216:217] op_sel_hi:[1,0,1]
    v_add_f32 v2, v2, v216
    v_add_f32 v2, v2, v217
    v_cmp_u_f32 vcc, v2, v2
    s_or_b32 s3, vcc_lo, vcc_hi
    s_cmp_lg_u32 s3, 0
    s_cselect_b32 s3, 1, 0
    v_mov_b32 v2, s3
    s_lshl_b32 s6, s22, 2
    s_add_u32 s6, s6, 73728
    v_mov_b32 v4, s6
    ds_write_b32 v4, v2
    s_mul_i32 s6, s22, 5120
    s_add_u32 s6, s6, 75008
    v_add_u32 v4, s6, v1
    s_cmp_eq_u32 s32, 0
    s_cbranch_scc1 gated_mix__softmax_full_mha__linear_kernel_hedgehog__prompt_kernel_give1
    ds_write_b128 v4, v[128:131] offset:0
    ds_write_b128 v4, v[132:135] offset:1024
    ds_write_b128 v4, v[136:139] offset:2048
    ds_write_b128 v4, v[140:143] offset:3072
    ds_write_b128 v4, v[160:163] offset:4096
    s_branch gated_mix__softmax_full_mha__linear_kernel_hedgehog__prompt_kernel_gave
gated_mix__softmax_full_mha__linear_kernel_hedgehog__prompt_kernel_give1:
    ds_write_b128 v4, v[144:147] offset:0
    ds_write_b128 v4, v[148:151] offset:1024
    ds_write_b128 v4, v[152:155] offset:2048
    ds_write_b128 v4, v[156:159] offset:3072
    ds_write_b128 v4, v[164:167] offset:4096
gated_mix__softmax_full_mha__linear_kernel_hedgehog__prompt_kernel_gave:
    v_cvt_pk_bf16_f32 v184, v176, v177
    v_cvt_pk_bf16_f32 v185, v178, v179
    v_cvt_pk_bf16_f32 v186, v180, v181
    v_cvt_pk_bf16_f32 v187, v182, v183
    v_and_b32 v3, 63, v0
    v_lshlrev_b32 v2, 3, v3
    v_add_u32 v2, 65536, v2
    s_lshl_b32 s6, s22, 9
    v_add_u32 v5, s6, v2
    ds_write_b64 v5, v[184:185] offset:0
    s_and_b32 s6, s22, 3
    s_lshl_b32 s6, s6, 9
    v_add_u32 v5, s6, v2
    ds_write_b64 v5, v[186:187] offset:4096
    s_waitcnt lgkmcnt(0)
    s_barrier
    v_mov_b32 v2, 73728
    ds_read_b128 v[216:219], v2
    ds_read_b128 v[220:223], v2 offset:16
    s_xor_b32 s6, s22, 4
    s_mul_i32 s6, s6, 5120
    s_add_u32 s6, s6, 75008
    v_add_u32 v4, s6, v1
    ds_read_b128 v[56:59], v4 offset:0
    ds_read_b128 v[60:63], v4 offset:1024
    ds_read_b128 v[64:67], v4 offset:2048
    ds_read_b128 v[68:71], v4 offset:3072
    ds_read_b128 v[72:75], v4 offset:4096
    s_waitcnt lgkmcnt(5)
    v_or3_b32 v216, v216, v217, v218
    v_or3_b32 v216, v216, v219, v220
    v_or3_b32 v216, v216, v221, v222
    v_or_b32 v216, v216, v223
    s_nop 0
    v_readfirstlane_b32 s3, v216
    s_sub_u32 s6, 1, s25
    s_and_b32 s3, s3, s6
    s_cmp_eq_u32 s3, 0
    s_cbranch_scc1 gated_mix__softmax_full_mha__linear_kernel_hedgehog__prompt_kernel_fin
    s_waitcnt lgkmcnt(0)
    s_barrier
    s_mov_b32 s23, s26
    s_mov_b32 s24, 8
    v_mov_b32 v2, 0xff800000
    v_mov_b32 v4, 0xff800000
gated_mix__softmax_full_mha__linear_kernel_hedgehog__prompt_kernel_maxloop:
    s_add_u32 m0, s26, 0
    s_nop 0
    buffer_load_dwordx4 v1, s[12:15], s23 offen offset:0 sc1 lds
    buffer_load_dwordx4 v1, s[12:15], s23 offen offset:1024 sc1 lds
    s_add_u32 m0, s26, 16384
    s_nop 0
    buffer_load_dwordx4 v1, s[16:19], s23 offen offset:0 sc1 lds
    buffer_load_dwordx4 v1, s[16:19], s23 offen offset:1024 sc1 lds
    s_add_u32 s23, s23, 16384
    s_waitcnt vmcnt(0)
    s_barrier
    ds_read_b128 v[96:99], v1 offset:0
    ds_read_b128 v[100:103], v1 offset:1024
    s_waitcnt lgkmcnt(0)
    v_mfma_f32_32x32x16_bf16 v[56:71], v[96:99], v[8:11], 0
    v_mfma_f32_32x32x16_bf16 v[56:71], v[100:103], v[12:15], v[56:71]
    v_mfma_f32_32x32x16_bf16 v[72:87], v[96:99], v[16:19], 0
    v_mfma_f32_32x32x16_bf16 v[72:87], v[100:103], v[20:23], v[72:87]
    s_nop 15
    v_max3_f32 v2, v2, v56, v57
    v_max3_f32 v2, v2, v58, v59
    v_max3_f32 v2, v2, v60, v61
    v_max3_f32 v2, v2, v62, v63
    v_max3_f32 v2, v2, v64, v65
    v_max3_f32 v2, v2, v66, v67
    v_max3_f32 v2, v2, v68, v69
    v_max3_f32 v2, v2, v70, v71
    v_max3_f32 v4, v4, v72, v73
    v_max3_f32 v4, v4, v74, v75
    v_max3_f32 v4, v4, v76, v77
    v_max3_f32 v4, v4, v78, v79
    v_max3_f32 v4, v4, v80, v81
    v_max3_f32 v4, v4, v82, v83
    v_max3_f32 v4, v4, v84, v85
    v_max3_f32 v4, v4, v86, v87
    ds_read_b128 v[96:99], v1 offset:2048
    ds_read_b128 v[100:103], v1 offset:3072
    s_waitcnt lgkmcnt(0)
    v_mfma_f32_32x32x16_bf16 v[56:71], v[96:99], v[8:11], 0
    v_mfma_f32_32x32x16_bf16 v[56:71], v[100:103], v[12:15], v[56:71]
    v_mfma_f32_32x32x16_bf16 v[72:87], v[96:99], v[16:19], 0
    v_mfma_f32_32x32x16_bf16 v[72:87], v[100:103], v[20:23], v[72:87]
    s_nop 15
    v_max3_f32 v2, v2, v56, v57
    v_max3_f32 v2, v2, v58, v59
    v_max3_f32 v2, v2, v60, v61
    v_max3_f32 v2, v2, v62, v63
    v_max3_f32 v2, v2, v64, v65
    v_max3_f32 v2, v2, v66, v67
    v_max3_f32 v2, v2, v68, v69
    v_max3_f32 v2, v2, v70, v71
    v_max3_f32 v4, v4, v72, v73
    v_max3_f32 v4, v4, v74, v75
    v_max3_f32 v4, v4, v76, v77
    v_max3_f32 v4, v4, v78, v79
    v_max3_f32 v4, v4, v80, v81
    v_max3_f32 v4, v4, v82, v83
    v_max3_f32 v4, v4, v84, v85
    v_max3_f32 v4, v4, v86, v87
    ds_read_b128 v[96:99], v1 offset:4096
    ds_read_b128 v[100:103], v1 offset:5120
    s_waitcnt lgkmcnt(0)
    v_mfma_f32_32x32x16_bf16 v[56:71], v[96:99], v[8:11], 0
    v_mfma_f32_32x32x16_bf16 v[56:71], v[100:103], v[12:15], v[56:71]
    v_mfma_f32_32x32x16_bf16 v[72:87], v[96:99], v[16:19], 0
    v_mfma_f32_32x32x16_bf16 v[72:87], v[100:103], v[20:23], v[72:87]
    s_nop 15
    v_max3_f32 v2, v2, v56, v57
    v_max3_f32 v2, v2, v58, v59
    v_max3_f32 v2, v2, v60, v61
    v_max3_f32 v2, v2, v62, v63
    v_max3_f32 v2, v2, v64, v65
    v_max3_f32 v2, v2, v66, v67
    v_max3_f32 v2, v2, v68, v69
    v_max3_f32 v2, v2, v70, v71
    v_max3_f32 v4, v4, v72, v73
    v_max3_f32 v4, v4, v74, v75
    v_max3_f32 v4, v4, v76, v77
    v_max3_f32 v4, v4, v78, v79
    v_max3_f32 v4, v4, v80, v81
    v_max3_f32 v4, v4, v82, v83
    v_max3_f32 v4, v4, v84, v85
    v_max3_f32 v4, v4, v86, v87
    ds_read_b128 v[96:99], v1 offset:6144
    ds_read_b128 v[100:103], v1 offset:7168
    s_waitcnt lgkmcnt(0)
    v_mfma_f32_32x32x16_bf16 v[56:71], v[96:99], v[8:11], 0
    v_mfma_f32_32x32x16_bf16 v[56:71], v[100:103], v[12:15], v[56:71]
    v_mfma_f32_32x32x16_bf16 v[72:87], v[96:99], v[16:19], 0
    v_mfma_f32_32x32x16_bf16 v[72:87], v[100:103], v[20:23], v[72:87]
    s_nop 15
    v_max3_f32 v2, v2, v56, v57
    v_max3_f32 v2, v2, v58, v59
    v_max3_f32 v2, v2, v60, v61
    v_max3_f32 v2, v2, v62, v63
    v_max3_f32 v2, v2, v64, v65
    v_max3_f32 v2, v2, v66, v67
    v_max3_f32 v2, v2, v68, v69
    v_max3_f32 v2, v2, v70, v71
    v_max3_f32 v4, v4, v72, v73
    v_max3_f32 v4, v4, v74, v75
    v_max3_f32 v4, v4, v76, v77
    v_max3_f32 v4, v4, v78, v79
    v_max3_f32 v4, v4, v80, v81
    v_max3_f32 v4, v4, v82, v83
    v_max3_f32 v4, v4, v84, v85
    v_max3_f32 v4, v4, v86, v87
    ds_read_b128 v[96:99], v1 offset:8192
    ds_read_b128 v[100:103], v1 offset:9216
    s_waitcnt lgkmcnt(0)
    v_mfma_f32_32x32x16_bf16 v[56:71], v[96:99], v[8:11], 0
    v_mfma_f32_32x32x16_bf16 v[56:71], v[100:103], v[12:15], v[56:71]
    v_mfma_f32_32x32x16_bf16 v[72:87], v[96:99], v[16:19], 0
    v_mfma_f32_32x32x16_bf16 v[72:87], v[100:103], v[20:23], v[72:87]
    s_nop 15
    v_max3_f32 v2, v2, v56, v57
    v_max3_f32 v2, v2, v58, v59
    v_max3_f32 v2, v2, v60, v61
    v_max3_f32 v2, v2, v62, v63
    v_max3_f32 v2, v2, v64, v65
    v_max3_f32 v2, v2, v66, v67
    v_max3_f32 v2, v2, v68, v69
    v_max3_f32 v2, v2, v70, v71
    v_max3_f32 v4, v4, v72, v73
    v_max3_f32 v4, v4, v74, v75
    v_max3_f32 v4, v4, v76, v77
    v_max3_f32 v4, v4, v78, v79
    v_max3_f32 v4, v4, v80, v81
    v_max3_f32 v4, v4, v82, v83
    v_max3_f32 v4, v4, v84, v85
    v_max3_f32 v4, v4, v86, v87
    ds_read_b128 v[96:99], v1 offset:10240
    ds_read_b128 v[100:103], v1 offset:11264
    s_waitcnt lgkmcnt(0)
    v_mfma_f32_32x32x16_bf16 v[56:71], v[96:99], v[8:11], 0
    v_mfma_f32_32x32x16_bf16 v[56:71], v[100:103], v[12:15], v[56:71]
    v_mfma_f32_32x32x16_bf16 v[72:87], v[96:99], v[16:19], 0
    v_mfma_f32_32x32x16_bf16 v[72:87], v[100:103], v[20:23], v[72:87]
    s_nop 15
    v_max3_f32 v2, v2, v56, v57
    v_max3_f32 v2, v2, v58, v59
    v_max3_f32 v2, v2, v60, v61
    v_max3_f32 v2, v2, v62, v63
    v_max3_f32 v2, v2, v64, v65
    v_max3_f32 v2, v2, v66, v67
    v_max3_f32 v2, v2, v68, v69
    v_max3_f32 v2, v2, v70, v71
    v_max3_f32 v4, v4, v72, v73
    v_max3_f32 v4, v4, v74, v75
    v_max3_f32 v4, v4, v76, v77
    v_max3_f32 v4, v4, v78, v79
    v_max3_f32 v4, v4, v80, v81
    v_max3_f32 v4, v4, v82, v83
    v_max3_f32 v4, v4, v84, v85
    v_max3_f32 v4, v4, v86, v87
    ds_read_b128 v[96:99], v1 offset:12288
    ds_read_b128 v[100:103], v1 offset:13312
    s_waitcnt lgkmcnt(0)
    v_mfma_f32_32x32x16_bf16 v[56:71], v[96:99], v[8:11], 0
    v_mfma_f32_32x32x16_bf16 v[56:71], v[100:103], v[12:15], v[56:71]
    v_mfma_f32_32x32x16_bf16 v[72:87], v[96:99], v[16:19], 0
    v_mfma_f32_32x32x16_bf16 v[72:87], v[100:103], v[20:23], v[72:87]
    s_nop 15
    v_max3_f32 v2, v2, v56, v57
    v_max3_f32 v2, v2, v58, v59
    v_max3_f32 v2, v2, v60, v61
    v_max3_f32 v2, v2, v62, v63
    v_max3_f32 v2, v2, v64, v65
    v_max3_f32 v2, v2, v66, v67
    v_max3_f32 v2, v2, v68, v69
    v_max3_f32 v2, v2, v70, v71
    v_max3_f32 v4, v4, v72, v73
    v_max3_f32 v4, v4, v74, v75
    v_max3_f32 v4, v4, v76, v77
    v_max3_f32 v4, v4, v78, v79
    v_max3_f32 v4, v4, v80, v81
    v_max3_f32 v4, v4, v82, v83
    v_max3_f32 v4, v4, v84, v85
    v_max3_f32 v4, v4, v86, v87
    ds_read_b128 v[96:99], v1 offset:14336
    ds_read_b128 v[100:103], v1 offset:15360
    s_waitcnt lgkmcnt(0)
    v_mfma_f32_32x32x16_bf16 v[56:71], v[96:99], v[8:11], 0
    v_mfma_f32_32x32x16_bf16 v[56:71], v[100:103], v[12:15], v[56:71]
    v_mfma_f32_32x32x16_bf16 v[72:87], v[96:99], v[16:19], 0
    v_mfma_f32_32x32x16_bf16 v[72:87], v[100:103], v[20:23], v[72:87]
    s_nop 15
    v_max3_f32 v2, v2, v56, v57
    v_max3_f32 v2, v2, v58, v59
    v_max3_f32 v2, v2, v60, v61
    v_max3_f32 v2, v2, v62, v63
    v_max3_f32 v2, v2, v64, v65
    v_max3_f32 v2, v2, v66, v67
    v_max3_f32 v2, v2, v68, v69
    v_max3_f32 v2, v2, v70, v71
    v_max3_f32 v4, v4, v72, v73
    v_max3_f32 v4, v4, v74, v75
    v_max3_f32 v4, v4, v76, v77
    v_max3_f32 v4, v4, v78, v79
    v_max3_f32 v4, v4, v80, v81
    v_max3_f32 v4, v4, v82, v83
    v_max3_f32 v4, v4, v84, v85
    v_max3_f32 v4, v4, v86, v87
    s_barrier
    s_sub_u32 s24, s24, 1
    s_cmp_lg_u32 s24, 0
    s_cbranch_scc1 gated_mix__softmax_full_mha__linear_kernel_hedgehog__prompt_kernel_maxloop
    v_mov_b32 v5, v2
    s_nop 1
    v_permlane32_swap_b32 v2, v5
    s_nop 1
    v_max_f32 v2, v2, v5
    v_sub_f32 v24, 0, v2
    v_mov_b32 v25, v24
    v_mov_b32 v26, v24
    v_mov_b32 v27, v24
    v_mov_b32 v28, v24
    v_mov_b32 v29, v24
    v_mov_b32 v30, v24
    v_mov_b32 v31, v24
    v_mov_b32 v32, v24
    v_mov_b32 v33, v24
    v_mov_b32 v34, v24
    v_mov_b32 v35, v24
    v_mov_b32 v36, v24
    v_mov_b32 v37, v24
    v_mov_b32 v38, v24
    v_mov_b32 v39, v24
    v_mov_b32 v5, v4
    s_nop 1
    v_permlane32_swap_b32 v4, v5
    s_nop 1
    v_max_f32 v4, v4, v5
    v_sub_f32 v40, 0, v4
    v_mov_b32 v41, v40
    v_mov_b32 v42, v40
    v_mov_b32 v43, v40
    v_mov_b32 v44, v40
    v_mov_b32 v45, v40
    v_mov_b32 v46, v40
    v_mov_b32 v47, v40
    v_mov_b32 v48, v40
    v_mov_b32 v49, v40
    v_mov_b32 v50, v40
    v_mov_b32 v51, v40
    v_mov_b32 v52, v40
    v_mov_b32 v53, v40
    v_mov_b32 v54, v40
    v_mov_b32 v55, v40
    s_mov_b32 s25, 1
    s_branch gated_mix__softmax_full_mha__linear_kernel_hedgehog__prompt_kernel_restart
gated_mix__softmax_full_mha__linear_kernel_hedgehog__prompt_kernel_fin:
    s_add_u32 m0, s64, 0
    s_mov_b32 s63, 0
    buffer_load_dwordx4 v247, s[76:79], s63 offen lds
    buffer_load_dwordx4 v248, s[76:79], s63 offen offset:1024 lds
    s_add_u32 m0, s64, 16384
    s_mov_b32 s63, 262144
    buffer_load_dwordx4 v247, s[76:79], s63 offen lds
    buffer_load_dwordx4 v248, s[76:79], s63 offen offset:1024 lds
    s_add_u32 m0, s64, 32768
    s_mov_b32 s63, 524288
    buffer_load_dwordx4 v247, s[76:79], s63 offen lds
    buffer_load_dwordx4 v248, s[76:79], s63 offen offset:1024 lds
    s_add_u32 m0, s64, 49152
    s_mov_b32 s63, 786432
    buffer_load_dwordx4 v247, s[76:79], s63 offen lds
    buffer_load_dwordx4 v248, s[76:79], s63 offen offset:1024 lds
    s_cmp_eq_u32 s32, 0
    s_cbranch_scc1 gated_mix__softmax_full_mha__linear_kernel_hedgehog__prompt_kernel_keep0
    v_mov_b32 v128, v144
    v_mov_b32 v129, v145
    v_mov_b32 v130, v146
    v_mov_b32 v131, v147
    v_mov_b32 v132, v148
    v_mov_b32 v133, v149
    v_mov_b32 v134, v150
    v_mov_b32 v135, v151
    v_mov_b32 v136, v152
    v_mov_b32 v137, v153
    v_mov_b32 v138, v154
    v_mov_b32 v139, v155
    v_mov_b32 v140, v156
    v_mov_b32 v141, v157
    v_mov_b32 v142, v158
    v_mov_b32 v143, v159
    v_mov_b32 v160, v164
gated_mix__softmax_full_mha__linear_kernel_hedgehog__prompt_kernel_keep0:
    s_waitcnt lgkmcnt(0)
    v_add_f32 v160, v160, v72
    v_rcp_f32 v4, v160
    v_pk_add_f32 v[128:129], v[128:129], v[56:57]
    v_pk_add_f32 v[130:131], v[130:131], v[58:59]
    v_pk_add_f32 v[132:133], v[132:133], v[60:61]
    v_pk_add_f32 v[134:135], v[134:135], v[62:63]
    v_pk_add_f32 v[136:137], v[136:137], v[64:65]
    v_pk_add_f32 v[138:139], v[138:139], v[66:67]
    v_pk_add_f32 v[140:141], v[140:141], v[68:69]
    v_pk_add_f32 v[142:143], v[142:143], v[70:71]
    v_mul_f32 v4, v4, v6
    v_pk_mul_f32 v[128:129], v[128:129], v[4:5] op_sel_hi:[1,0]
    v_pk_mul_f32 v[130:131], v[130:131], v[4:5] op_sel_hi:[1,0]
    v_pk_mul_f32 v[132:133], v[132:133], v[4:5] op_sel_hi:[1,0]
    v_pk_mul_f32 v[134:135], v[134:135], v[4:5] op_sel_hi:[1,0]
    v_pk_mul_f32 v[136:137], v[136:137], v[4:5] op_sel_hi:[1,0]
    v_pk_mul_f32 v[138:139], v[138:139], v[4:5] op_sel_hi:[1,0]
    v_pk_mul_f32 v[140:141], v[140:141], v[4:5] op_sel_hi:[1,0]
    v_pk_mul_f32 v[142:143], v[142:143], v[4:5] op_sel_hi:[1,0]
    v_cvt_pk_bf16_f32 v56, v128, v129
    v_cvt_pk_bf16_f32 v57, v130, v131
    v_cvt_pk_bf16_f32 v58, v132, v133
    v_cvt_pk_bf16_f32 v59, v134, v135
    v_cvt_pk_bf16_f32 v60, v136, v137
    v_cvt_pk_bf16_f32 v61, v138, v139
    v_cvt_pk_bf16_f32 v62, v140, v141
    v_cvt_pk_bf16_f32 v63, v142, v143
    buffer_store_dwordx4 v[56:59], v249, s[8:11], s40 offen sc1
    buffer_store_dwordx4 v[60:63], v249, s[8:11], s40 offen offset:512 sc1
    v_and_b32 v3, 63, v0
    v_lshlrev_b32 v2, 3, v3
    v_add_u32 v2, 65536, v2
    ds_read_b64 v[24:25], v2 offset:0
    ds_read_b64 v[26:27], v2 offset:1024
    ds_read_b64 v[28:29], v2 offset:512
    ds_read_b64 v[30:31], v2 offset:1536
    ds_read_b64 v[40:41], v2 offset:4096
    ds_read_b64 v[42:43], v2 offset:4608
    ds_read_b64 v[32:33], v2 offset:2048
    ds_read_b64 v[34:35], v2 offset:3072
    ds_read_b64 v[36:37], v2 offset:2560
    ds_read_b64 v[38:39], v2 offset:3584
    ds_read_b64 v[44:45], v2 offset:5120
    ds_read_b64 v[46:47], v2 offset:5632
    v_lshrrev_b32 v4, 4, v3
    v_bfe_u32 v5, v3, 2, 2
    v_lshl_add_u32 v4, v4, 2, v5
    v_lshlrev_b32 v4, 6, v4
    v_and_b32 v5, 3, v3
    v_lshl_add_u32 v4, v5, 3, v4
    v_add_u32 v4, 65536, v4
    ds_read_b64_tr_b16 v[48:49], v4 offset:6144
    ds_read_b64_tr_b16 v[50:51], v4 offset:7168
    ds_read_b64_tr_b16 v[52:53], v4 offset:6176
    ds_read_b64_tr_b16 v[54:55], v4 offset:7200
    v_mov_b32 v56, 0x3f803f80
    v_mov_b32 v57, v56
    v_mov_b32 v58, v56
    v_mov_b32 v59, v56
    s_waitcnt lgkmcnt(0)
    v_mfma_f32_16x16x32_bf16 v[64:67], v[48:51], v[224:227], 0
    v_mfma_f32_16x16x32_bf16 v[68:71], v[52:55], v[224:227], 0
    v_mfma_f32_16x16x32_bf16 v[72:75], v[48:51], v[228:231], 0
    v_mfma_f32_16x16x32_bf16 v[76:79], v[52:55], v[228:231], 0
    s_nop 7
    v_max3_f32 v96, v64, v65, v66
    v_min3_f32 v100, v64, v65, v66
    v_max3_f32 v98, v72, v73, v74
    v_min3_f32 v102, v72, v73, v74
    v_max3_f32 v96, v96, v67, v68
    v_min3_f32 v100, v100, v67, v68
    v_max3_f32 v98, v98, v75, v76
    v_min3_f32 v102, v102, v75, v76
    v_max3_f32 v96, v96, v69, v70
    v_min3_f32 v100, v100, v69, v70
    v_max3_f32 v98, v98, v77, v78
    v_min3_f32 v102, v102, v77, v78
    v_max_f32 v96, v96, v71
    v_min_f32 v100, v100, v71
    v_max_f32 v98, v98, v79
    v_min_f32 v102, v102, v79
    v_sub_f32 v100, 0, v100
    v_sub_f32 v102, 0, v102
    s_nop 1
    v_permlane32_swap_b32 v96, v100
    v_permlane32_swap_b32 v98, v102
    s_nop 1
    v_max_f32 v96, v96, v100
    v_max_f32 v98, v98, v102
    v_mov_b32 v104, v96
    v_mov_b32 v106, v98
    s_nop 1
    v_permlane16_swap_b32 v96, v104
    v_permlane16_swap_b32 v98, v106
    s_nop 1
    v_max_f32 v96, v96, v104
    v_max_f32 v98, v98, v106
    v_mov_b32 v100, v96
    v_mov_b32 v102, v98
    s_nop 1
    v_permlane32_swap_b32 v96, v100
    v_permlane32_swap_b32 v98, v102
    s_nop 1
    s_mov_b32 s36, 1069066811
    s_mov_b32 s37, 1069066811
    s_mov_b32 s38, 3216550459
    s_mov_b32 s39, 3216550459
    v_mul_f32 v96, s38, v96
    v_mul_f32 v100, s38, v100
    v_mul_f32 v98, s38, v98
    v_mul_f32 v102, s38, v102
    v_pk_fma_f32 v[176:177], v[64:65], s[36:37], v[96:97] op_sel_hi:[1,1,0]
    v_pk_fma_f32 v[64:65], v[64:65], s[38:39], v[100:101] op_sel_hi:[1,1,0]
    v_pk_fma_f32 v[178:179], v[66:67], s[36:37], v[96:97] op_sel_hi:[1,1,0]
    v_pk_fma_f32 v[66:67], v[66:67], s[38:39], v[100:101] op_sel_hi:[1,1,0]
    v_pk_fma_f32 v[180:181], v[68:69], s[36:37], v[96:97] op_sel_hi:[1,1,0]
    v_pk_fma_f32 v[68:69], v[68:69], s[38:39], v[100:101] op_sel_hi:[1,1,0]
    v_pk_fma_f32 v[182:183], v[70:71], s[36:37], v[96:97] op_sel_hi:[1,1,0]
    v_pk_fma_f32 v[70:71], v[70:71], s[38:39], v[100:101] op_sel_hi:[1,1,0]
    v_pk_fma_f32 v[184:185], v[72:73], s[36:37], v[98:99] op_sel_hi:[1,1,0]
    v_pk_fma_f32 v[72:73], v[72:73], s[38:39], v[102:103] op_sel_hi:[1,1,0]
    v_pk_fma_f32 v[186:187], v[74:75], s[36:37], v[98:99] op_sel_hi:[1,1,0]
    v_pk_fma_f32 v[74:75], v[74:75], s[38:39], v[102:103] op_sel_hi:[1,1,0]
    v_pk_fma_f32 v[188:189], v[76:77], s[36:37], v[98:99] op_sel_hi:[1,1,0]
    v_pk_fma_f32 v[76:77], v[76:77], s[38:39], v[102:103] op_sel_hi:[1,1,0]
    v_pk_fma_f32 v[190:191], v[78:79], s[36:37], v[98:99] op_sel_hi:[1,1,0]
    v_pk_fma_f32 v[78:79], v[78:79], s[38:39], v[102:103] op_sel_hi:[1,1,0]
    v_exp_f32 v176, v176
    v_exp_f32 v64, v64
    v_exp_f32 v177, v177
    v_exp_f32 v65, v65
    v_exp_f32 v178, v178
    v_exp_f32 v66, v66
    v_exp_f32 v179, v179
    v_exp_f32 v67, v67
    v_exp_f32 v180, v180
    v_exp_f32 v68, v68
    v_exp_f32 v181, v181
    v_exp_f32 v69, v69
    v_exp_f32 v182, v182
    v_exp_f32 v70, v70
    v_exp_f32 v183, v183
    v_exp_f32 v71, v71
    v_exp_f32 v184, v184
    v_exp_f32 v72, v72
    v_exp_f32 v185, v185
    v_exp_f32 v73, v73
    v_exp_f32 v186, v186
    v_exp_f32 v74, v74
    v_exp_f32 v187, v187
    v_exp_f32 v75, v75
    v_exp_f32 v188, v188
    v_exp_f32 v76, v76
    v_exp_f32 v189, v189
    v_exp_f32 v77, v77
    v_exp_f32 v190, v190
    v_exp_f32 v78, v78
    v_exp_f32 v191, v191
    v_exp_f32 v79, v79
    s_waitcnt vmcnt(0)
    s_barrier
    s_cmp_lg_u32 s22, 0
    s_cbranch_scc1 gated_mix__softmax_full_mha__linear_kernel_hedgehog__prompt_kernel_sigA
    s_mov_b64 exec, 1
    v_mov_b32 v200, 0
    v_mov_b32 v201, 1
    buffer_store_dword v201, v200, s[8:11], s70 offen sc1
    s_mov_b64 exec, -1
gated_mix__softmax_full_mha__linear_kernel_hedgehog__prompt_kernel_sigA:
    s_nop 0
    v_cvt_pk_bf16_f32 v96, v176, v177
    v_cvt_pk_bf16_f32 v112, v64, v65
    v_cvt_pk_bf16_f32 v97, v178, v179
    v_cvt_pk_bf16_f32 v113, v66, v67
    v_cvt_pk_bf16_f32 v98, v180, v181
    v_cvt_pk_bf16_f32 v114, v68, v69
    v_cvt_pk_bf16_f32 v99, v182, v183
    v_cvt_pk_bf16_f32 v115, v70, v71
    v_cvt_pk_bf16_f32 v100, v184, v185
    v_cvt_pk_bf16_f32 v116, v72, v73
    v_cvt_pk_bf16_f32 v101, v186, v187
    v_cvt_pk_bf16_f32 v117, v74, v75
    v_cvt_pk_bf16_f32 v102, v188, v189
    v_cvt_pk_bf16_f32 v118, v76, v77
    v_cvt_pk_bf16_f32 v103, v190, v191
    v_cvt_pk_bf16_f32 v119, v78, v79
    s_nop 1
    v_mfma_f32_16x16x32_bf16 v[176:179], v[24:27], v[96:99], 0
    v_mfma_f32_16x16x32_bf16 v[184:187], v[32:35], v[112:115], 0
    v_mfma_f32_16x16x32_bf16 v[180:183], v[28:31], v[96:99], 0
    v_mfma_f32_16x16x32_bf16 v[188:191], v[36:39], v[112:115], 0
    v_mfma_f32_16x16x32_bf16 v[192:195], v[40:43], v[96:99], 0
    v_mfma_f32_16x16x32_bf16 v[196:199], v[44:47], v[112:115], 0
    v_mfma_f32_16x16x32_bf16 v[200:203], v[56:59], v[96:99], 0
    v_mfma_f32_16x16x32_bf16 v[204:207], v[56:59], v[112:115], 0
    v_mfma_f32_16x16x32_bf16 v[208:211], v[24:27], v[100:103], 0
    v_mfma_f32_16x16x32_bf16 v[216:219], v[32:35], v[116:119], 0
    v_mfma_f32_16x16x32_bf16 v[212:215], v[28:31], v[100:103], 0
    v_mfma_f32_16x16x32_bf16 v[220:223], v[36:39], v[116:119], 0
    v_mfma_f32_16x16x32_bf16 v[224:227], v[40:43], v[100:103], 0
    v_mfma_f32_16x16x32_bf16 v[228:231], v[44:47], v[116:119], 0
    v_mfma_f32_16x16x32_bf16 v[232:235], v[56:59], v[100:103], 0
    v_mfma_f32_16x16x32_bf16 v[236:239], v[56:59], v[116:119], 0
    s_nop 7
    v_rcp_f32 v200, v200
    v_rcp_f32 v204, v204
    v_rcp_f32 v232, v232
    v_rcp_f32 v236, v236
    s_nop 0
    v_mul_f32 v192, v192, v200
    v_sub_f32 v193, 1.0, v244
    v_fma_f32 v192, v196, v204, v192
    v_add_f32 v192, 897988541, v192
    v_mul_f32 v224, v224, v232
    v_sub_f32 v225, 1.0, v245
    v_fma_f32 v224, v228, v236, v224
    v_add_f32 v224, 897988541, v224
    v_rcp_f32 v192, v192
    v_rcp_f32 v224, v224
    s_nop 0
    v_mul_f32 v192, v192, v193
    v_mul_f32 v200, v200, v192
    v_mul_f32 v204, v204, v192
    v_mul_f32 v224, v224, v225
    v_mul_f32 v232, v232, v224
    v_mul_f32 v236, v236, v224
    v_pk_mul_f32 v[176:177], v[176:177], v[200:201] op_sel_hi:[1,0]
    v_pk_mul_f32 v[178:179], v[178:179], v[200:201] op_sel_hi:[1,0]
    v_pk_mul_f32 v[180:181], v[180:181], v[200:201] op_sel_hi:[1,0]
    v_pk_mul_f32 v[182:183], v[182:183], v[200:201] op_sel_hi:[1,0]
    v_pk_fma_f32 v[176:177], v[184:185], v[204:205], v[176:177] op_sel_hi:[1,0,1]
    v_pk_fma_f32 v[178:179], v[186:187], v[204:205], v[178:179] op_sel_hi:[1,0,1]
    v_pk_fma_f32 v[180:181], v[188:189], v[204:205], v[180:181] op_sel_hi:[1,0,1]
    v_pk_fma_f32 v[182:183], v[190:191], v[204:205], v[182:183] op_sel_hi:[1,0,1]
    v_pk_mul_f32 v[208:209], v[208:209], v[232:233] op_sel_hi:[1,0]
    v_pk_mul_f32 v[210:211], v[210:211], v[232:233] op_sel_hi:[1,0]
    v_pk_mul_f32 v[212:213], v[212:213], v[232:233] op_sel_hi:[1,0]
    v_pk_mul_f32 v[214:215], v[214:215], v[232:233] op_sel_hi:[1,0]
    v_pk_fma_f32 v[208:209], v[216:217], v[236:237], v[208:209] op_sel_hi:[1,0,1]
    v_pk_fma_f32 v[210:211], v[218:219], v[236:237], v[210:211] op_sel_hi:[1,0,1]
    v_pk_fma_f32 v[212:213], v[220:221], v[236:237], v[212:213] op_sel_hi:[1,0,1]
    v_pk_fma_f32 v[214:215], v[222:223], v[236:237], v[214:215] op_sel_hi:[1,0,1]
    v_cvt_pk_bf16_f32 v196, v176, v177
    v_cvt_pk_bf16_f32 v197, v178, v179
    v_cvt_pk_bf16_f32 v198, v180, v181
    v_cvt_pk_bf16_f32 v199, v182, v183
    buffer_store_dwordx4 v[196:199], v1, s[8:11], s41 offen offset:0 sc1
    v_cvt_pk_bf16_f32 v228, v208, v209
    v_cvt_pk_bf16_f32 v229, v210, v211
    v_cvt_pk_bf16_f32 v230, v212, v213
    v_cvt_pk_bf16_f32 v231, v214, v215
    buffer_store_dwordx4 v[228:231], v1, s[8:11], s41 offen offset:1024 sc1
    v_and_b32 v202, 63, v0
    v_lshrrev_b32 v13, 4, v202
    v_bfe_u32 v14, v202, 2, 2
    v_and_b32 v15, 1, v13
    v_lshrrev_b32 v16, 1, v14
    v_lshl_add_u32 v16, v15, 1, v16
    v_lshlrev_b32 v16, 1, v16
    v_bfe_u32 v17, v202, 1, 1
    v_and_b32 v18, 1, v202
    v_lshlrev_b32 v18, 3, v18
    s_lshl_b32 s3, s32, 12
    v_add_u32 v18, s3, v18
    v_lshrrev_b32 v19, 1, v13
    v_lshlrev_b32 v19, 4, v19
    v_lshl_add_u32 v19, v15, 2, v19
    v_add_u32 v19, v19, v14
    v_lshl_add_u32 v20, v13, 2, v14
    v_add_u32 v21, 0, v17
    v_xor_b32 v21, v21, v16
    v_lshl_add_u32 v21, v21, 4, v18
    v_lshl_add_u32 v4, v19, 7, v21
    v_lshl_add_u32 v8, v20, 7, v21
    v_add_u32 v21, 2, v17
    v_xor_b32 v21, v21, v16
    v_lshl_add_u32 v21, v21, 4, v18
    v_lshl_add_u32 v5, v19, 7, v21
    v_lshl_add_u32 v9, v20, 7, v21
    v_add_u32 v21, 4, v17
    v_xor_b32 v21, v21, v16
    v_lshl_add_u32 v21, v21, 4, v18
    v_lshl_add_u32 v6, v19, 7, v21
    v_lshl_add_u32 v10, v20, 7, v21
    v_add_u32 v21, 6, v17
    v_xor_b32 v21, v21, v16
    v_lshl_add_u32 v21, v21, 4, v18
    v_lshl_add_u32 v7, v19, 7, v21
    v_lshl_add_u32 v11, v20, 7, v21
    v_mov_b32 v48, 0
    v_mov_b32 v49, 0
    v_mov_b32 v50, 0
    v_mov_b32 v51, 0
    v_mov_b32 v52, 0
    v_mov_b32 v53, 0
    v_mov_b32 v54, 0
    v_mov_b32 v55, 0
    v_mov_b32 v56, 0
    v_mov_b32 v57, 0
    v_mov_b32 v58, 0
    v_mov_b32 v59, 0
    v_mov_b32 v60, 0
    v_mov_b32 v61, 0
    v_mov_b32 v62, 0
    v_mov_b32 v63, 0
    v_mov_b32 v64, 0
    v_mov_b32 v65, 0
    v_mov_b32 v66, 0
    v_mov_b32 v67, 0
    v_mov_b32 v68, 0
    v_mov_b32 v69, 0
    v_mov_b32 v70, 0
    v_mov_b32 v71, 0
    v_mov_b32 v72, 0
    v_mov_b32 v73, 0
    v_mov_b32 v74, 0
    v_mov_b32 v75, 0
    v_mov_b32 v76, 0
    v_mov_b32 v77, 0
    v_mov_b32 v78, 0
    v_mov_b32 v79, 0
    s_cmp_lg_u32 s22, 0
    s_cbranch_scc1 gated_mix__softmax_full_mha__linear_kernel_hedgehog__prompt_kernel_pollA_skip
    v_and_b32 v200, 31, v0
    v_lshlrev_b32 v200, 2, v200
    s_mov_b32 s6, 131072
gated_mix__softmax_full_mha__linear_kernel_hedgehog__prompt_kernel_pollA:
    buffer_load_dword v201, v200, s[8:11], s71 offen offset:0 sc1
    s_waitcnt vmcnt(0)
    v_cmp_eq_u32 vcc, 1, v201
    s_sub_u32 s6, s6, 1
    s_cmp_eq_u32 s6, 0
    s_cbranch_scc1 gated_mix__softmax_full_mha__linear_kernel_hedgehog__prompt_kernel_pollA_skip
    s_cmp_eq_u32 vcc_lo, -1
    s_cbranch_scc1 gated_mix__softmax_full_mha__linear_kernel_hedgehog__prompt_kernel_pollA_skip
    s_sleep 2
    s_branch gated_mix__softmax_full_mha__linear_kernel_hedgehog__prompt_kernel_pollA
gated_mix__softmax_full_mha__linear_kernel_hedgehog__prompt_kernel_pollA_skip:
    s_waitcnt vmcnt(0)
    s_barrier
    s_cmp_lg_u32 s22, 0
    s_cbranch_scc1 gated_mix__softmax_full_mha__linear_kernel_hedgehog__prompt_kernel_sigB
    s_mov_b64 exec, 1
    v_mov_b32 v200, 128
    v_mov_b32 v201, 1
    buffer_store_dword v201, v200, s[8:11], s70 offen sc1
    s_mov_b64 exec, -1
gated_mix__softmax_full_mha__linear_kernel_hedgehog__prompt_kernel_sigB:
    s_add_u32 s62, s65, 0
    buffer_load_dwordx4 v[80:83], v1, s[8:11], s62 offen sc1
    buffer_load_dwordx4 v[84:87], v1, s[8:11], s62 offen offset:1024 sc1
    s_add_u32 s62, s65, 262144
    buffer_load_dwordx4 v[88:91], v1, s[8:11], s62 offen sc1
    buffer_load_dwordx4 v[92:95], v1, s[8:11], s62 offen offset:1024 sc1
    s_add_u32 s62, s65, 524288
    buffer_load_dwordx4 v[96:99], v1, s[8:11], s62 offen sc1
    buffer_load_dwordx4 v[100:103], v1, s[8:11], s62 offen offset:1024 sc1
    s_add_u32 s62, s65, 786432
    buffer_load_dwordx4 v[104:107], v1, s[8:11], s62 offen sc1
    buffer_load_dwordx4 v[108:111], v1, s[8:11], s62 offen offset:1024 sc1
    s_add_u32 s62, s65, 1048576
    buffer_load_dwordx4 v[112:115], v1, s[8:11], s62 offen sc1
    buffer_load_dwordx4 v[116:119], v1, s[8:11], s62 offen offset:1024 sc1
    s_add_u32 s62, s65, 1310720
    buffer_load_dwordx4 v[120:123], v1, s[8:11], s62 offen sc1
    buffer_load_dwordx4 v[124:127], v1, s[8:11], s62 offen offset:1024 sc1
    ds_read_b64_tr_b16 v[16:17], v4 offset:0
    ds_read_b64_tr_b16 v[18:19], v4 offset:1024
    ds_read_b64_tr_b16 v[20:21], v5 offset:0
    ds_read_b64_tr_b16 v[22:23], v5 offset:1024
    ds_read_b64_tr_b16 v[24:25], v6 offset:0
    ds_read_b64_tr_b16 v[26:27], v6 offset:1024
    ds_read_b64_tr_b16 v[28:29], v7 offset:0
    ds_read_b64_tr_b16 v[30:31], v7 offset:1024
    s_waitcnt vmcnt(8) lgkmcnt(0)
    v_mfma_f32_16x16x32_bf16 v[48:51], v[16:19], v[80:83], v[48:51]
    ds_read_b64_tr_b16 v[32:33], v4 offset:8192
    v_mfma_f32_16x16x32_bf16 v[64:67], v[16:19], v[84:87], v[64:67]
    ds_read_b64_tr_b16 v[34:35], v4 offset:9216
    v_mfma_f32_16x16x32_bf16 v[52:55], v[20:23], v[80:83], v[52:55]
    ds_read_b64_tr_b16 v[36:37], v5 offset:8192
    v_mfma_f32_16x16x32_bf16 v[68:71], v[20:23], v[84:87], v[68:71]
    ds_read_b64_tr_b16 v[38:39], v5 offset:9216
    v_mfma_f32_16x16x32_bf16 v[56:59], v[24:27], v[80:83], v[56:59]
    ds_read_b64_tr_b16 v[40:41], v6 offset:8192
    v_mfma_f32_16x16x32_bf16 v[72:75], v[24:27], v[84:87], v[72:75]
    ds_read_b64_tr_b16 v[42:43], v6 offset:9216
    v_mfma_f32_16x16x32_bf16 v[60:63], v[28:31], v[80:83], v[60:63]
    ds_read_b64_tr_b16 v[44:45], v7 offset:8192
    v_mfma_f32_16x16x32_bf16 v[76:79], v[28:31], v[84:87], v[76:79]
    ds_read_b64_tr_b16 v[46:47], v7 offset:9216
    s_waitcnt lgkmcnt(0)
    v_mfma_f32_16x16x32_bf16 v[48:51], v[32:35], v[88:91], v[48:51]
    s_waitcnt vmcnt(12)
    s_barrier
    v_mfma_f32_16x16x32_bf16 v[64:67], v[32:35], v[92:95], v[64:67]
    ds_read_b64_tr_b16 v[16:17], v4 offset:16384
    ds_read_b64_tr_b16 v[18:19], v4 offset:17408
    v_mfma_f32_16x16x32_bf16 v[52:55], v[36:39], v[88:91], v[52:55]
    ds_read_b64_tr_b16 v[20:21], v5 offset:16384
    v_mfma_f32_16x16x32_bf16 v[68:71], v[36:39], v[92:95], v[68:71]
    ds_read_b64_tr_b16 v[22:23], v5 offset:17408
    v_mfma_f32_16x16x32_bf16 v[56:59], v[40:43], v[88:91], v[56:59]
    ds_read_b64_tr_b16 v[24:25], v6 offset:16384
    ds_read_b64_tr_b16 v[26:27], v6 offset:17408
    v_mfma_f32_16x16x32_bf16 v[72:75], v[40:43], v[92:95], v[72:75]
    ds_read_b64_tr_b16 v[28:29], v7 offset:16384
    v_mfma_f32_16x16x32_bf16 v[60:63], v[44:47], v[88:91], v[60:63]
    ds_read_b64_tr_b16 v[30:31], v7 offset:17408
    v_mfma_f32_16x16x32_bf16 v[76:79], v[44:47], v[92:95], v[76:79]
    s_add_u32 m0, s64, 65536
    s_mov_b32 s63, 1048576
    buffer_load_dwordx4 v247, s[76:79], s63 offen lds
    buffer_load_dwordx4 v248, s[76:79], s63 offen offset:1024 lds
    s_add_u32 s62, s65, 1572864
    buffer_load_dwordx4 v[80:83], v1, s[8:11], s62 offen sc1
    buffer_load_dwordx4 v[84:87], v1, s[8:11], s62 offen offset:1024 sc1
    s_add_u32 s62, s65, 1835008
    buffer_load_dwordx4 v[88:91], v1, s[8:11], s62 offen sc1
    buffer_load_dwordx4 v[92:95], v1, s[8:11], s62 offen offset:1024 sc1
    s_waitcnt vmcnt(10) lgkmcnt(0)
    v_mfma_f32_16x16x32_bf16 v[48:51], v[16:19], v[96:99], v[48:51]
    ds_read_b64_tr_b16 v[32:33], v4 offset:24576
    v_mfma_f32_16x16x32_bf16 v[64:67], v[16:19], v[100:103], v[64:67]
    ds_read_b64_tr_b16 v[34:35], v4 offset:25600
    v_mfma_f32_16x16x32_bf16 v[52:55], v[20:23], v[96:99], v[52:55]
    ds_read_b64_tr_b16 v[36:37], v5 offset:24576
    v_mfma_f32_16x16x32_bf16 v[68:71], v[20:23], v[100:103], v[68:71]
    ds_read_b64_tr_b16 v[38:39], v5 offset:25600
    v_mfma_f32_16x16x32_bf16 v[56:59], v[24:27], v[96:99], v[56:59]
    ds_read_b64_tr_b16 v[40:41], v6 offset:24576
    v_mfma_f32_16x16x32_bf16 v[72:75], v[24:27], v[100:103], v[72:75]
    ds_read_b64_tr_b16 v[42:43], v6 offset:25600
    v_mfma_f32_16x16x32_bf16 v[60:63], v[28:31], v[96:99], v[60:63]
    ds_read_b64_tr_b16 v[44:45], v7 offset:24576
    v_mfma_f32_16x16x32_bf16 v[76:79], v[28:31], v[100:103], v[76:79]
    ds_read_b64_tr_b16 v[46:47], v7 offset:25600
    s_waitcnt lgkmcnt(0)
    v_mfma_f32_16x16x32_bf16 v[48:51], v[32:35], v[104:107], v[48:51]
    s_waitcnt vmcnt(18)
    s_barrier
    v_mfma_f32_16x16x32_bf16 v[64:67], v[32:35], v[108:111], v[64:67]
    ds_read_b64_tr_b16 v[16:17], v4 offset:32768
    ds_read_b64_tr_b16 v[18:19], v4 offset:33792
    v_mfma_f32_16x16x32_bf16 v[52:55], v[36:39], v[104:107], v[52:55]
    ds_read_b64_tr_b16 v[20:21], v5 offset:32768
    v_mfma_f32_16x16x32_bf16 v[68:71], v[36:39], v[108:111], v[68:71]
    ds_read_b64_tr_b16 v[22:23], v5 offset:33792
    v_mfma_f32_16x16x32_bf16 v[56:59], v[40:43], v[104:107], v[56:59]
    ds_read_b64_tr_b16 v[24:25], v6 offset:32768
    ds_read_b64_tr_b16 v[26:27], v6 offset:33792
    v_mfma_f32_16x16x32_bf16 v[72:75], v[40:43], v[108:111], v[72:75]
    ds_read_b64_tr_b16 v[28:29], v7 offset:32768
    v_mfma_f32_16x16x32_bf16 v[60:63], v[44:47], v[104:107], v[60:63]
    ds_read_b64_tr_b16 v[30:31], v7 offset:33792
    v_mfma_f32_16x16x32_bf16 v[76:79], v[44:47], v[108:111], v[76:79]
    s_add_u32 m0, s64, 81920
    s_mov_b32 s63, 1310720
    buffer_load_dwordx4 v247, s[76:79], s63 offen lds
    buffer_load_dwordx4 v248, s[76:79], s63 offen offset:1024 lds
    s_add_u32 s62, s65, 2097152
    buffer_load_dwordx4 v[96:99], v1, s[8:11], s62 offen sc1
    buffer_load_dwordx4 v[100:103], v1, s[8:11], s62 offen offset:1024 sc1
    s_add_u32 s62, s65, 2359296
    buffer_load_dwordx4 v[104:107], v1, s[8:11], s62 offen sc1
    buffer_load_dwordx4 v[108:111], v1, s[8:11], s62 offen offset:1024 sc1
    s_waitcnt vmcnt(12) lgkmcnt(0)
    v_mfma_f32_16x16x32_bf16 v[48:51], v[16:19], v[112:115], v[48:51]
    ds_read_b64_tr_b16 v[32:33], v4 offset:40960
    v_mfma_f32_16x16x32_bf16 v[64:67], v[16:19], v[116:119], v[64:67]
    ds_read_b64_tr_b16 v[34:35], v4 offset:41984
    v_mfma_f32_16x16x32_bf16 v[52:55], v[20:23], v[112:115], v[52:55]
    ds_read_b64_tr_b16 v[36:37], v5 offset:40960
    v_mfma_f32_16x16x32_bf16 v[68:71], v[20:23], v[116:119], v[68:71]
    ds_read_b64_tr_b16 v[38:39], v5 offset:41984
    v_mfma_f32_16x16x32_bf16 v[56:59], v[24:27], v[112:115], v[56:59]
    ds_read_b64_tr_b16 v[40:41], v6 offset:40960
    v_mfma_f32_16x16x32_bf16 v[72:75], v[24:27], v[116:119], v[72:75]
    ds_read_b64_tr_b16 v[42:43], v6 offset:41984
    v_mfma_f32_16x16x32_bf16 v[60:63], v[28:31], v[112:115], v[60:63]
    ds_read_b64_tr_b16 v[44:45], v7 offset:40960
    v_mfma_f32_16x16x32_bf16 v[76:79], v[28:31], v[116:119], v[76:79]
    ds_read_b64_tr_b16 v[46:47], v7 offset:41984
    s_waitcnt lgkmcnt(0)
    v_mfma_f32_16x16x32_bf16 v[48:51], v[32:35], v[120:123], v[48:51]
    s_waitcnt vmcnt(24)
    s_barrier
    v_mfma_f32_16x16x32_bf16 v[64:67], v[32:35], v[124:127], v[64:67]
    ds_read_b64_tr_b16 v[16:17], v4 offset:49152
    ds_read_b64_tr_b16 v[18:19], v4 offset:50176
    v_mfma_f32_16x16x32_bf16 v[52:55], v[36:39], v[120:123], v[52:55]
    ds_read_b64_tr_b16 v[20:21], v5 offset:49152
    v_mfma_f32_16x16x32_bf16 v[68:71], v[36:39], v[124:127], v[68:71]
    ds_read_b64_tr_b16 v[22:23], v5 offset:50176
    v_mfma_f32_16x16x32_bf16 v[56:59], v[40:43], v[120:123], v[56:59]
    ds_read_b64_tr_b16 v[24:25], v6 offset:49152
    ds_read_b64_tr_b16 v[26:27], v6 offset:50176
    v_mfma_f32_16x16x32_bf16 v[72:75], v[40:43], v[124:127], v[72:75]
    ds_read_b64_tr_b16 v[28:29], v7 offset:49152
    v_mfma_f32_16x16x32_bf16 v[60:63], v[44:47], v[120:123], v[60:63]
    ds_read_b64_tr_b16 v[30:31], v7 offset:50176
    v_mfma_f32_16x16x32_bf16 v[76:79], v[44:47], v[124:127], v[76:79]
    s_add_u32 m0, s64, 98304
    s_mov_b32 s63, 1572864
    buffer_load_dwordx4 v247, s[76:79], s63 offen lds
    buffer_load_dwordx4 v248, s[76:79], s63 offen offset:1024 lds
    s_add_u32 s62, s65, 2621440
    buffer_load_dwordx4 v[112:115], v1, s[8:11], s62 offen sc1
    buffer_load_dwordx4 v[116:119], v1, s[8:11], s62 offen offset:1024 sc1
    s_add_u32 s62, s65, 2883584
    buffer_load_dwordx4 v[120:123], v1, s[8:11], s62 offen sc1
    buffer_load_dwordx4 v[124:127], v1, s[8:11], s62 offen offset:1024 sc1
    s_waitcnt vmcnt(12) lgkmcnt(0)
    v_mfma_f32_16x16x32_bf16 v[48:51], v[16:19], v[80:83], v[48:51]
    ds_read_b64_tr_b16 v[32:33], v4 offset:57344
    v_mfma_f32_16x16x32_bf16 v[64:67], v[16:19], v[84:87], v[64:67]
    ds_read_b64_tr_b16 v[34:35], v4 offset:58368
    v_mfma_f32_16x16x32_bf16 v[52:55], v[20:23], v[80:83], v[52:55]
    ds_read_b64_tr_b16 v[36:37], v5 offset:57344
    v_mfma_f32_16x16x32_bf16 v[68:71], v[20:23], v[84:87], v[68:71]
    ds_read_b64_tr_b16 v[38:39], v5 offset:58368
    v_mfma_f32_16x16x32_bf16 v[56:59], v[24:27], v[80:83], v[56:59]
    ds_read_b64_tr_b16 v[40:41], v6 offset:57344
    v_mfma_f32_16x16x32_bf16 v[72:75], v[24:27], v[84:87], v[72:75]
    ds_read_b64_tr_b16 v[42:43], v6 offset:58368
    v_mfma_f32_16x16x32_bf16 v[60:63], v[28:31], v[80:83], v[60:63]
    ds_read_b64_tr_b16 v[44:45], v7 offset:57344
    v_mfma_f32_16x16x32_bf16 v[76:79], v[28:31], v[84:87], v[76:79]
    ds_read_b64_tr_b16 v[46:47], v7 offset:58368
    s_waitcnt lgkmcnt(0)
    v_mfma_f32_16x16x32_bf16 v[48:51], v[32:35], v[88:91], v[48:51]
    v_add_u32 v12, 65536, v4
    v_add_u32 v13, 65536, v5
    v_add_u32 v14, 65536, v6
    v_add_u32 v15, 65536, v7
    s_waitcnt vmcnt(16)
    s_barrier
    v_mfma_f32_16x16x32_bf16 v[64:67], v[32:35], v[92:95], v[64:67]
    ds_read_b64_tr_b16 v[16:17], v12 offset:0
    ds_read_b64_tr_b16 v[18:19], v12 offset:1024
    v_mfma_f32_16x16x32_bf16 v[52:55], v[36:39], v[88:91], v[52:55]
    ds_read_b64_tr_b16 v[20:21], v13 offset:0
    v_mfma_f32_16x16x32_bf16 v[68:71], v[36:39], v[92:95], v[68:71]
    ds_read_b64_tr_b16 v[22:23], v13 offset:1024
    v_mfma_f32_16x16x32_bf16 v[56:59], v[40:43], v[88:91], v[56:59]
    ds_read_b64_tr_b16 v[24:25], v14 offset:0
    ds_read_b64_tr_b16 v[26:27], v14 offset:1024
    v_mfma_f32_16x16x32_bf16 v[72:75], v[40:43], v[92:95], v[72:75]
    ds_read_b64_tr_b16 v[28:29], v15 offset:0
    v_mfma_f32_16x16x32_bf16 v[60:63], v[44:47], v[88:91], v[60:63]
    ds_read_b64_tr_b16 v[30:31], v15 offset:1024
    v_mfma_f32_16x16x32_bf16 v[76:79], v[44:47], v[92:95], v[76:79]
    s_add_u32 m0, s64, 114688
    s_mov_b32 s63, 1835008
    buffer_load_dwordx4 v247, s[76:79], s63 offen lds
    buffer_load_dwordx4 v248, s[76:79], s63 offen offset:1024 lds
    s_add_u32 s62, s65, 3145728
    buffer_load_dwordx4 v[80:83], v1, s[8:11], s62 offen sc1
    buffer_load_dwordx4 v[84:87], v1, s[8:11], s62 offen offset:1024 sc1
    s_add_u32 s62, s65, 3407872
    buffer_load_dwordx4 v[88:91], v1, s[8:11], s62 offen sc1
    buffer_load_dwordx4 v[92:95], v1, s[8:11], s62 offen offset:1024 sc1
    s_waitcnt vmcnt(12) lgkmcnt(0)
    v_mfma_f32_16x16x32_bf16 v[48:51], v[16:19], v[96:99], v[48:51]
    ds_read_b64_tr_b16 v[32:33], v12 offset:8192
    v_mfma_f32_16x16x32_bf16 v[64:67], v[16:19], v[100:103], v[64:67]
    ds_read_b64_tr_b16 v[34:35], v12 offset:9216
    v_mfma_f32_16x16x32_bf16 v[52:55], v[20:23], v[96:99], v[52:55]
    ds_read_b64_tr_b16 v[36:37], v13 offset:8192
    v_mfma_f32_16x16x32_bf16 v[68:71], v[20:23], v[100:103], v[68:71]
    ds_read_b64_tr_b16 v[38:39], v13 offset:9216
    v_mfma_f32_16x16x32_bf16 v[56:59], v[24:27], v[96:99], v[56:59]
    ds_read_b64_tr_b16 v[40:41], v14 offset:8192
    v_mfma_f32_16x16x32_bf16 v[72:75], v[24:27], v[100:103], v[72:75]
    ds_read_b64_tr_b16 v[42:43], v14 offset:9216
    v_mfma_f32_16x16x32_bf16 v[60:63], v[28:31], v[96:99], v[60:63]
    ds_read_b64_tr_b16 v[44:45], v15 offset:8192
    v_mfma_f32_16x16x32_bf16 v[76:79], v[28:31], v[100:103], v[76:79]
    ds_read_b64_tr_b16 v[46:47], v15 offset:9216
    s_waitcnt lgkmcnt(0)
    v_mfma_f32_16x16x32_bf16 v[48:51], v[32:35], v[104:107], v[48:51]
    s_cmp_lg_u32 s22, 0
    s_cbranch_scc1 gated_mix__softmax_full_mha__linear_kernel_hedgehog__prompt_kernel_pollB_skip
    v_and_b32 v200, 31, v0
    v_lshlrev_b32 v200, 2, v200
    s_mov_b32 s6, 131072
gated_mix__softmax_full_mha__linear_kernel_hedgehog__prompt_kernel_pollB:
    buffer_load_dword v201, v200, s[8:11], s71 offen offset:128 sc1
    s_waitcnt vmcnt(0)
    v_cmp_eq_u32 vcc, 1, v201
    s_sub_u32 s6, s6, 1
    s_cmp_eq_u32 s6, 0
    s_cbranch_scc1 gated_mix__softmax_full_mha__linear_kernel_hedgehog__prompt_kernel_pollB_skip
    s_cmp_eq_u32 vcc_lo, -1
    s_cbranch_scc1 gated_mix__softmax_full_mha__linear_kernel_hedgehog__prompt_kernel_pollB_skip
    s_sleep 2
    s_branch gated_mix__softmax_full_mha__linear_kernel_hedgehog__prompt_kernel_pollB
gated_mix__softmax_full_mha__linear_kernel_hedgehog__prompt_kernel_pollB_skip:
    s_waitcnt vmcnt(16)
    s_barrier
    v_mfma_f32_16x16x32_bf16 v[64:67], v[32:35], v[108:111], v[64:67]
    ds_read_b64_tr_b16 v[16:17], v12 offset:16384
    ds_read_b64_tr_b16 v[18:19], v12 offset:17408
    v_mfma_f32_16x16x32_bf16 v[52:55], v[36:39], v[104:107], v[52:55]
    ds_read_b64_tr_b16 v[20:21], v13 offset:16384
    v_mfma_f32_16x16x32_bf16 v[68:71], v[36:39], v[108:111], v[68:71]
    ds_read_b64_tr_b16 v[22:23], v13 offset:17408
    v_mfma_f32_16x16x32_bf16 v[56:59], v[40:43], v[104:107], v[56:59]
    ds_read_b64_tr_b16 v[24:25], v14 offset:16384
    ds_read_b64_tr_b16 v[26:27], v14 offset:17408
    v_mfma_f32_16x16x32_bf16 v[72:75], v[40:43], v[108:111], v[72:75]
    ds_read_b64_tr_b16 v[28:29], v15 offset:16384
    v_mfma_f32_16x16x32_bf16 v[60:63], v[44:47], v[104:107], v[60:63]
    ds_read_b64_tr_b16 v[30:31], v15 offset:17408
    v_mfma_f32_16x16x32_bf16 v[76:79], v[44:47], v[108:111], v[76:79]
    s_add_u32 m0, s64, 0
    s_mov_b32 s63, 0
    buffer_load_dwordx4 v247, s[80:83], s63 offen lds
    buffer_load_dwordx4 v248, s[80:83], s63 offen offset:1024 lds
    s_add_u32 s62, s65, 3670016
    buffer_load_dwordx4 v[96:99], v1, s[8:11], s62 offen sc1
    buffer_load_dwordx4 v[100:103], v1, s[8:11], s62 offen offset:1024 sc1
    s_add_u32 s62, s65, 3932160
    buffer_load_dwordx4 v[104:107], v1, s[8:11], s62 offen sc1
    buffer_load_dwordx4 v[108:111], v1, s[8:11], s62 offen offset:1024 sc1
    s_waitcnt vmcnt(12) lgkmcnt(0)
    v_mfma_f32_16x16x32_bf16 v[48:51], v[16:19], v[112:115], v[48:51]
    ds_read_b64_tr_b16 v[32:33], v12 offset:24576
    v_mfma_f32_16x16x32_bf16 v[64:67], v[16:19], v[116:119], v[64:67]
    ds_read_b64_tr_b16 v[34:35], v12 offset:25600
    v_mfma_f32_16x16x32_bf16 v[52:55], v[20:23], v[112:115], v[52:55]
    ds_read_b64_tr_b16 v[36:37], v13 offset:24576
    v_mfma_f32_16x16x32_bf16 v[68:71], v[20:23], v[116:119], v[68:71]
    ds_read_b64_tr_b16 v[38:39], v13 offset:25600
    v_mfma_f32_16x16x32_bf16 v[56:59], v[24:27], v[112:115], v[56:59]
    ds_read_b64_tr_b16 v[40:41], v14 offset:24576
    v_mfma_f32_16x16x32_bf16 v[72:75], v[24:27], v[116:119], v[72:75]
    ds_read_b64_tr_b16 v[42:43], v14 offset:25600
    v_mfma_f32_16x16x32_bf16 v[60:63], v[28:31], v[112:115], v[60:63]
    ds_read_b64_tr_b16 v[44:45], v15 offset:24576
    v_mfma_f32_16x16x32_bf16 v[76:79], v[28:31], v[116:119], v[76:79]
    ds_read_b64_tr_b16 v[46:47], v15 offset:25600
    s_waitcnt lgkmcnt(0)
    v_mfma_f32_16x16x32_bf16 v[48:51], v[32:35], v[120:123], v[48:51]
    s_waitcnt vmcnt(16)
    s_barrier
    v_mfma_f32_16x16x32_bf16 v[64:67], v[32:35], v[124:127], v[64:67]
    ds_read_b64_tr_b16 v[16:17], v12 offset:32768
    ds_read_b64_tr_b16 v[18:19], v12 offset:33792
    v_mfma_f32_16x16x32_bf16 v[52:55], v[36:39], v[120:123], v[52:55]
    ds_read_b64_tr_b16 v[20:21], v13 offset:32768
    v_mfma_f32_16x16x32_bf16 v[68:71], v[36:39], v[124:127], v[68:71]
    ds_read_b64_tr_b16 v[22:23], v13 offset:33792
    v_mfma_f32_16x16x32_bf16 v[56:59], v[40:43], v[120:123], v[56:59]
    ds_read_b64_tr_b16 v[24:25], v14 offset:32768
    ds_read_b64_tr_b16 v[26:27], v14 offset:33792
    v_mfma_f32_16x16x32_bf16 v[72:75], v[40:43], v[124:127], v[72:75]
    ds_read_b64_tr_b16 v[28:29], v15 offset:32768
    v_mfma_f32_16x16x32_bf16 v[60:63], v[44:47], v[120:123], v[60:63]
    ds_read_b64_tr_b16 v[30:31], v15 offset:33792
    v_mfma_f32_16x16x32_bf16 v[76:79], v[44:47], v[124:127], v[76:79]
    s_add_u32 m0, s64, 16384
    s_mov_b32 s63, 262144
    buffer_load_dwordx4 v247, s[80:83], s63 offen lds
    buffer_load_dwordx4 v248, s[80:83], s63 offen offset:1024 lds
    s_add_u32 s62, s65, 4194304
    buffer_load_dwordx4 v[112:115], v1, s[8:11], s62 offen sc1
    buffer_load_dwordx4 v[116:119], v1, s[8:11], s62 offen offset:1024 sc1
    s_add_u32 s62, s65, 4456448
    buffer_load_dwordx4 v[120:123], v1, s[8:11], s62 offen sc1
    buffer_load_dwordx4 v[124:127], v1, s[8:11], s62 offen offset:1024 sc1
    s_waitcnt vmcnt(12) lgkmcnt(0)
    v_mfma_f32_16x16x32_bf16 v[48:51], v[16:19], v[80:83], v[48:51]
    ds_read_b64_tr_b16 v[32:33], v12 offset:40960
    v_mfma_f32_16x16x32_bf16 v[64:67], v[16:19], v[84:87], v[64:67]
    ds_read_b64_tr_b16 v[34:35], v12 offset:41984
    v_mfma_f32_16x16x32_bf16 v[52:55], v[20:23], v[80:83], v[52:55]
    ds_read_b64_tr_b16 v[36:37], v13 offset:40960
    v_mfma_f32_16x16x32_bf16 v[68:71], v[20:23], v[84:87], v[68:71]
    ds_read_b64_tr_b16 v[38:39], v13 offset:41984
    v_mfma_f32_16x16x32_bf16 v[56:59], v[24:27], v[80:83], v[56:59]
    ds_read_b64_tr_b16 v[40:41], v14 offset:40960
    v_mfma_f32_16x16x32_bf16 v[72:75], v[24:27], v[84:87], v[72:75]
    ds_read_b64_tr_b16 v[42:43], v14 offset:41984
    v_mfma_f32_16x16x32_bf16 v[60:63], v[28:31], v[80:83], v[60:63]
    ds_read_b64_tr_b16 v[44:45], v15 offset:40960
    v_mfma_f32_16x16x32_bf16 v[76:79], v[28:31], v[84:87], v[76:79]
    ds_read_b64_tr_b16 v[46:47], v15 offset:41984
    s_waitcnt lgkmcnt(0)
    v_mfma_f32_16x16x32_bf16 v[48:51], v[32:35], v[88:91], v[48:51]
    s_waitcnt vmcnt(16)
    s_barrier
    v_mfma_f32_16x16x32_bf16 v[64:67], v[32:35], v[92:95], v[64:67]
    ds_read_b64_tr_b16 v[16:17], v12 offset:49152
    ds_read_b64_tr_b16 v[18:19], v12 offset:50176
    v_mfma_f32_16x16x32_bf16 v[52:55], v[36:39], v[88:91], v[52:55]
    ds_read_b64_tr_b16 v[20:21], v13 offset:49152
    v_mfma_f32_16x16x32_bf16 v[68:71], v[36:39], v[92:95], v[68:71]
    ds_read_b64_tr_b16 v[22:23], v13 offset:50176
    v_mfma_f32_16x16x32_bf16 v[56:59], v[40:43], v[88:91], v[56:59]
    ds_read_b64_tr_b16 v[24:25], v14 offset:49152
    ds_read_b64_tr_b16 v[26:27], v14 offset:50176
    v_mfma_f32_16x16x32_bf16 v[72:75], v[40:43], v[92:95], v[72:75]
    ds_read_b64_tr_b16 v[28:29], v15 offset:49152
    v_mfma_f32_16x16x32_bf16 v[60:63], v[44:47], v[88:91], v[60:63]
    ds_read_b64_tr_b16 v[30:31], v15 offset:50176
    v_mfma_f32_16x16x32_bf16 v[76:79], v[44:47], v[92:95], v[76:79]
    s_add_u32 m0, s64, 32768
    s_mov_b32 s63, 524288
    buffer_load_dwordx4 v247, s[80:83], s63 offen lds
    buffer_load_dwordx4 v248, s[80:83], s63 offen offset:1024 lds
    s_add_u32 s62, s65, 4718592
    buffer_load_dwordx4 v[80:83], v1, s[8:11], s62 offen sc1
    buffer_load_dwordx4 v[84:87], v1, s[8:11], s62 offen offset:1024 sc1
    s_add_u32 s62, s65, 4980736
    buffer_load_dwordx4 v[88:91], v1, s[8:11], s62 offen sc1
    buffer_load_dwordx4 v[92:95], v1, s[8:11], s62 offen offset:1024 sc1
    s_waitcnt vmcnt(12) lgkmcnt(0)
    v_mfma_f32_16x16x32_bf16 v[48:51], v[16:19], v[96:99], v[48:51]
    ds_read_b64_tr_b16 v[32:33], v12 offset:57344
    v_mfma_f32_16x16x32_bf16 v[64:67], v[16:19], v[100:103], v[64:67]
    ds_read_b64_tr_b16 v[34:35], v12 offset:58368
    v_mfma_f32_16x16x32_bf16 v[52:55], v[20:23], v[96:99], v[52:55]
    ds_read_b64_tr_b16 v[36:37], v13 offset:57344
    v_mfma_f32_16x16x32_bf16 v[68:71], v[20:23], v[100:103], v[68:71]
    ds_read_b64_tr_b16 v[38:39], v13 offset:58368
    v_mfma_f32_16x16x32_bf16 v[56:59], v[24:27], v[96:99], v[56:59]
    ds_read_b64_tr_b16 v[40:41], v14 offset:57344
    v_mfma_f32_16x16x32_bf16 v[72:75], v[24:27], v[100:103], v[72:75]
    ds_read_b64_tr_b16 v[42:43], v14 offset:58368
    v_mfma_f32_16x16x32_bf16 v[60:63], v[28:31], v[96:99], v[60:63]
    ds_read_b64_tr_b16 v[44:45], v15 offset:57344
    v_mfma_f32_16x16x32_bf16 v[76:79], v[28:31], v[100:103], v[76:79]
    ds_read_b64_tr_b16 v[46:47], v15 offset:58368
    s_waitcnt lgkmcnt(0)
    v_mfma_f32_16x16x32_bf16 v[48:51], v[32:35], v[104:107], v[48:51]
    s_waitcnt vmcnt(16)
    s_barrier
    v_mfma_f32_16x16x32_bf16 v[64:67], v[32:35], v[108:111], v[64:67]
    ds_read_b64_tr_b16 v[16:17], v8 offset:0
    ds_read_b64_tr_b16 v[18:19], v8 offset:2048
    v_mfma_f32_16x16x32_bf16 v[52:55], v[36:39], v[104:107], v[52:55]
    ds_read_b64_tr_b16 v[20:21], v9 offset:0
    v_mfma_f32_16x16x32_bf16 v[68:71], v[36:39], v[108:111], v[68:71]
    ds_read_b64_tr_b16 v[22:23], v9 offset:2048
    v_mfma_f32_16x16x32_bf16 v[56:59], v[40:43], v[104:107], v[56:59]
    ds_read_b64_tr_b16 v[24:25], v10 offset:0
    ds_read_b64_tr_b16 v[26:27], v10 offset:2048
    v_mfma_f32_16x16x32_bf16 v[72:75], v[40:43], v[108:111], v[72:75]
    ds_read_b64_tr_b16 v[28:29], v11 offset:0
    v_mfma_f32_16x16x32_bf16 v[60:63], v[44:47], v[104:107], v[60:63]
    ds_read_b64_tr_b16 v[30:31], v11 offset:2048
    v_mfma_f32_16x16x32_bf16 v[76:79], v[44:47], v[108:111], v[76:79]
    s_add_u32 m0, s64, 49152
    s_mov_b32 s63, 786432
    buffer_load_dwordx4 v247, s[80:83], s63 offen lds
    buffer_load_dwordx4 v248, s[80:83], s63 offen offset:1024 lds
    s_add_u32 s62, s65, 5242880
    buffer_load_dwordx4 v[96:99], v1, s[8:11], s62 offen sc1
    buffer_load_dwordx4 v[100:103], v1, s[8:11], s62 offen offset:1024 sc1
    s_add_u32 s62, s65, 5505024
    buffer_load_dwordx4 v[104:107], v1, s[8:11], s62 offen sc1
    buffer_load_dwordx4 v[108:111], v1, s[8:11], s62 offen offset:1024 sc1
    s_waitcnt vmcnt(12) lgkmcnt(0)
    v_mfma_f32_16x16x32_bf16 v[48:51], v[16:19], v[112:115], v[48:51]
    ds_read_b64_tr_b16 v[32:33], v8 offset:8192
    v_mfma_f32_16x16x32_bf16 v[64:67], v[16:19], v[116:119], v[64:67]
    ds_read_b64_tr_b16 v[34:35], v8 offset:10240
    v_mfma_f32_16x16x32_bf16 v[52:55], v[20:23], v[112:115], v[52:55]
    ds_read_b64_tr_b16 v[36:37], v9 offset:8192
    v_mfma_f32_16x16x32_bf16 v[68:71], v[20:23], v[116:119], v[68:71]
    ds_read_b64_tr_b16 v[38:39], v9 offset:10240
    v_mfma_f32_16x16x32_bf16 v[56:59], v[24:27], v[112:115], v[56:59]
    ds_read_b64_tr_b16 v[40:41], v10 offset:8192
    v_mfma_f32_16x16x32_bf16 v[72:75], v[24:27], v[116:119], v[72:75]
    ds_read_b64_tr_b16 v[42:43], v10 offset:10240
    v_mfma_f32_16x16x32_bf16 v[60:63], v[28:31], v[112:115], v[60:63]
    ds_read_b64_tr_b16 v[44:45], v11 offset:8192
    v_mfma_f32_16x16x32_bf16 v[76:79], v[28:31], v[116:119], v[76:79]
    ds_read_b64_tr_b16 v[46:47], v11 offset:10240
    s_waitcnt lgkmcnt(0)
    v_mfma_f32_16x16x32_bf16 v[48:51], v[32:35], v[120:123], v[48:51]
    s_waitcnt vmcnt(16)
    s_barrier
    v_mfma_f32_16x16x32_bf16 v[64:67], v[32:35], v[124:127], v[64:67]
    ds_read_b64_tr_b16 v[16:17], v8 offset:16384
    ds_read_b64_tr_b16 v[18:19], v8 offset:18432
    v_mfma_f32_16x16x32_bf16 v[52:55], v[36:39], v[120:123], v[52:55]
    ds_read_b64_tr_b16 v[20:21], v9 offset:16384
    v_mfma_f32_16x16x32_bf16 v[68:71], v[36:39], v[124:127], v[68:71]
    ds_read_b64_tr_b16 v[22:23], v9 offset:18432
    v_mfma_f32_16x16x32_bf16 v[56:59], v[40:43], v[120:123], v[56:59]
    ds_read_b64_tr_b16 v[24:25], v10 offset:16384
    ds_read_b64_tr_b16 v[26:27], v10 offset:18432
    v_mfma_f32_16x16x32_bf16 v[72:75], v[40:43], v[124:127], v[72:75]
    ds_read_b64_tr_b16 v[28:29], v11 offset:16384
    v_mfma_f32_16x16x32_bf16 v[60:63], v[44:47], v[120:123], v[60:63]
    ds_read_b64_tr_b16 v[30:31], v11 offset:18432
    v_mfma_f32_16x16x32_bf16 v[76:79], v[44:47], v[124:127], v[76:79]
    s_add_u32 m0, s64, 65536
    s_mov_b32 s63, 1048576
    buffer_load_dwordx4 v247, s[80:83], s63 offen lds
    buffer_load_dwordx4 v248, s[80:83], s63 offen offset:1024 lds
    s_add_u32 s62, s65, 5767168
    buffer_load_dwordx4 v[112:115], v1, s[8:11], s62 offen sc1
    buffer_load_dwordx4 v[116:119], v1, s[8:11], s62 offen offset:1024 sc1
    s_add_u32 s62, s65, 6029312
    buffer_load_dwordx4 v[120:123], v1, s[8:11], s62 offen sc1
    buffer_load_dwordx4 v[124:127], v1, s[8:11], s62 offen offset:1024 sc1
    s_waitcnt vmcnt(12) lgkmcnt(0)
    v_mfma_f32_16x16x32_bf16 v[48:51], v[16:19], v[80:83], v[48:51]
    ds_read_b64_tr_b16 v[32:33], v8 offset:24576
    v_mfma_f32_16x16x32_bf16 v[64:67], v[16:19], v[84:87], v[64:67]
    ds_read_b64_tr_b16 v[34:35], v8 offset:26624
    v_mfma_f32_16x16x32_bf16 v[52:55], v[20:23], v[80:83], v[52:55]
    ds_read_b64_tr_b16 v[36:37], v9 offset:24576
    v_mfma_f32_16x16x32_bf16 v[68:71], v[20:23], v[84:87], v[68:71]
    ds_read_b64_tr_b16 v[38:39], v9 offset:26624
    v_mfma_f32_16x16x32_bf16 v[56:59], v[24:27], v[80:83], v[56:59]
    ds_read_b64_tr_b16 v[40:41], v10 offset:24576
    v_mfma_f32_16x16x32_bf16 v[72:75], v[24:27], v[84:87], v[72:75]
    ds_read_b64_tr_b16 v[42:43], v10 offset:26624
    v_mfma_f32_16x16x32_bf16 v[60:63], v[28:31], v[80:83], v[60:63]
    ds_read_b64_tr_b16 v[44:45], v11 offset:24576
    v_mfma_f32_16x16x32_bf16 v[76:79], v[28:31], v[84:87], v[76:79]
    ds_read_b64_tr_b16 v[46:47], v11 offset:26624
    s_waitcnt lgkmcnt(0)
    v_mfma_f32_16x16x32_bf16 v[48:51], v[32:35], v[88:91], v[48:51]
    s_waitcnt vmcnt(16)
    s_barrier
    v_mfma_f32_16x16x32_bf16 v[64:67], v[32:35], v[92:95], v[64:67]
    ds_read_b64_tr_b16 v[16:17], v8 offset:32768
    ds_read_b64_tr_b16 v[18:19], v8 offset:34816
    v_mfma_f32_16x16x32_bf16 v[52:55], v[36:39], v[88:91], v[52:55]
    ds_read_b64_tr_b16 v[20:21], v9 offset:32768
    v_mfma_f32_16x16x32_bf16 v[68:71], v[36:39], v[92:95], v[68:71]
    ds_read_b64_tr_b16 v[22:23], v9 offset:34816
    v_mfma_f32_16x16x32_bf16 v[56:59], v[40:43], v[88:91], v[56:59]
    ds_read_b64_tr_b16 v[24:25], v10 offset:32768
    ds_read_b64_tr_b16 v[26:27], v10 offset:34816
    v_mfma_f32_16x16x32_bf16 v[72:75], v[40:43], v[92:95], v[72:75]
    ds_read_b64_tr_b16 v[28:29], v11 offset:32768
    v_mfma_f32_16x16x32_bf16 v[60:63], v[44:47], v[88:91], v[60:63]
    ds_read_b64_tr_b16 v[30:31], v11 offset:34816
    v_mfma_f32_16x16x32_bf16 v[76:79], v[44:47], v[92:95], v[76:79]
    s_add_u32 m0, s64, 81920
    s_mov_b32 s63, 1310720
    buffer_load_dwordx4 v247, s[80:83], s63 offen lds
    buffer_load_dwordx4 v248, s[80:83], s63 offen offset:1024 lds
    s_add_u32 s62, s65, 6291456
    buffer_load_dwordx4 v[80:83], v1, s[8:11], s62 offen sc1
    buffer_load_dwordx4 v[84:87], v1, s[8:11], s62 offen offset:1024 sc1
    s_add_u32 s62, s65, 6553600
    buffer_load_dwordx4 v[88:91], v1, s[8:11], s62 offen sc1
    buffer_load_dwordx4 v[92:95], v1, s[8:11], s62 offen offset:1024 sc1
    s_waitcnt vmcnt(12) lgkmcnt(0)
    v_mfma_f32_16x16x32_bf16 v[48:51], v[16:19], v[96:99], v[48:51]
    ds_read_b64_tr_b16 v[32:33], v8 offset:40960
    v_mfma_f32_16x16x32_bf16 v[64:67], v[16:19], v[100:103], v[64:67]
    ds_read_b64_tr_b16 v[34:35], v8 offset:43008
    v_mfma_f32_16x16x32_bf16 v[52:55], v[20:23], v[96:99], v[52:55]
    ds_read_b64_tr_b16 v[36:37], v9 offset:40960
    v_mfma_f32_16x16x32_bf16 v[68:71], v[20:23], v[100:103], v[68:71]
    ds_read_b64_tr_b16 v[38:39], v9 offset:43008
    v_mfma_f32_16x16x32_bf16 v[56:59], v[24:27], v[96:99], v[56:59]
    ds_read_b64_tr_b16 v[40:41], v10 offset:40960
    v_mfma_f32_16x16x32_bf16 v[72:75], v[24:27], v[100:103], v[72:75]
    ds_read_b64_tr_b16 v[42:43], v10 offset:43008
    v_mfma_f32_16x16x32_bf16 v[60:63], v[28:31], v[96:99], v[60:63]
    ds_read_b64_tr_b16 v[44:45], v11 offset:40960
    v_mfma_f32_16x16x32_bf16 v[76:79], v[28:31], v[100:103], v[76:79]
    ds_read_b64_tr_b16 v[46:47], v11 offset:43008
    s_waitcnt lgkmcnt(0)
    v_mfma_f32_16x16x32_bf16 v[48:51], v[32:35], v[104:107], v[48:51]
    s_waitcnt vmcnt(16)
    s_barrier
    v_mfma_f32_16x16x32_bf16 v[64:67], v[32:35], v[108:111], v[64:67]
    ds_read_b64_tr_b16 v[16:17], v8 offset:49152
    ds_read_b64_tr_b16 v[18:19], v8 offset:51200
    v_mfma_f32_16x16x32_bf16 v[52:55], v[36:39], v[104:107], v[52:55]
    ds_read_b64_tr_b16 v[20:21], v9 offset:49152
    v_mfma_f32_16x16x32_bf16 v[68:71], v[36:39], v[108:111], v[68:71]
    ds_read_b64_tr_b16 v[22:23], v9 offset:51200
    v_mfma_f32_16x16x32_bf16 v[56:59], v[40:43], v[104:107], v[56:59]
    ds_read_b64_tr_b16 v[24:25], v10 offset:49152
    ds_read_b64_tr_b16 v[26:27], v10 offset:51200
    v_mfma_f32_16x16x32_bf16 v[72:75], v[40:43], v[108:111], v[72:75]
    ds_read_b64_tr_b16 v[28:29], v11 offset:49152
    v_mfma_f32_16x16x32_bf16 v[60:63], v[44:47], v[104:107], v[60:63]
    ds_read_b64_tr_b16 v[30:31], v11 offset:51200
    v_mfma_f32_16x16x32_bf16 v[76:79], v[44:47], v[108:111], v[76:79]
    s_add_u32 m0, s64, 98304
    s_mov_b32 s63, 1572864
    buffer_load_dwordx4 v247, s[80:83], s63 offen lds
    buffer_load_dwordx4 v248, s[80:83], s63 offen offset:1024 lds
    s_add_u32 s62, s65, 6815744
    buffer_load_dwordx4 v[96:99], v1, s[8:11], s62 offen sc1
    buffer_load_dwordx4 v[100:103], v1, s[8:11], s62 offen offset:1024 sc1
    s_add_u32 s62, s65, 7077888
    buffer_load_dwordx4 v[104:107], v1, s[8:11], s62 offen sc1
    buffer_load_dwordx4 v[108:111], v1, s[8:11], s62 offen offset:1024 sc1
    s_waitcnt vmcnt(12) lgkmcnt(0)
    v_mfma_f32_16x16x32_bf16 v[48:51], v[16:19], v[112:115], v[48:51]
    ds_read_b64_tr_b16 v[32:33], v8 offset:57344
    v_mfma_f32_16x16x32_bf16 v[64:67], v[16:19], v[116:119], v[64:67]
    ds_read_b64_tr_b16 v[34:35], v8 offset:59392
    v_mfma_f32_16x16x32_bf16 v[52:55], v[20:23], v[112:115], v[52:55]
    ds_read_b64_tr_b16 v[36:37], v9 offset:57344
    v_mfma_f32_16x16x32_bf16 v[68:71], v[20:23], v[116:119], v[68:71]
    ds_read_b64_tr_b16 v[38:39], v9 offset:59392
    v_mfma_f32_16x16x32_bf16 v[56:59], v[24:27], v[112:115], v[56:59]
    ds_read_b64_tr_b16 v[40:41], v10 offset:57344
    v_mfma_f32_16x16x32_bf16 v[72:75], v[24:27], v[116:119], v[72:75]
    ds_read_b64_tr_b16 v[42:43], v10 offset:59392
    v_mfma_f32_16x16x32_bf16 v[60:63], v[28:31], v[112:115], v[60:63]
    ds_read_b64_tr_b16 v[44:45], v11 offset:57344
    v_mfma_f32_16x16x32_bf16 v[76:79], v[28:31], v[116:119], v[76:79]
    ds_read_b64_tr_b16 v[46:47], v11 offset:59392
    s_waitcnt lgkmcnt(0)
    v_mfma_f32_16x16x32_bf16 v[48:51], v[32:35], v[120:123], v[48:51]
    v_add_u32 v12, 65536, v8
    v_add_u32 v13, 65536, v9
    v_add_u32 v14, 65536, v10
    v_add_u32 v15, 65536, v11
    s_waitcnt vmcnt(16)
    s_barrier
    v_mfma_f32_16x16x32_bf16 v[64:67], v[32:35], v[124:127], v[64:67]
    ds_read_b64_tr_b16 v[16:17], v12 offset:0
    ds_read_b64_tr_b16 v[18:19], v12 offset:2048
    v_mfma_f32_16x16x32_bf16 v[52:55], v[36:39], v[120:123], v[52:55]
    ds_read_b64_tr_b16 v[20:21], v13 offset:0
    v_mfma_f32_16x16x32_bf16 v[68:71], v[36:39], v[124:127], v[68:71]
    ds_read_b64_tr_b16 v[22:23], v13 offset:2048
    v_mfma_f32_16x16x32_bf16 v[56:59], v[40:43], v[120:123], v[56:59]
    ds_read_b64_tr_b16 v[24:25], v14 offset:0
    ds_read_b64_tr_b16 v[26:27], v14 offset:2048
    v_mfma_f32_16x16x32_bf16 v[72:75], v[40:43], v[124:127], v[72:75]
    ds_read_b64_tr_b16 v[28:29], v15 offset:0
    v_mfma_f32_16x16x32_bf16 v[60:63], v[44:47], v[120:123], v[60:63]
    ds_read_b64_tr_b16 v[30:31], v15 offset:2048
    v_mfma_f32_16x16x32_bf16 v[76:79], v[44:47], v[124:127], v[76:79]
    s_add_u32 m0, s64, 114688
    s_mov_b32 s63, 1835008
    buffer_load_dwordx4 v247, s[80:83], s63 offen lds
    buffer_load_dwordx4 v248, s[80:83], s63 offen offset:1024 lds
    s_add_u32 s62, s65, 7340032
    buffer_load_dwordx4 v[112:115], v1, s[8:11], s62 offen sc1
    buffer_load_dwordx4 v[116:119], v1, s[8:11], s62 offen offset:1024 sc1
    s_add_u32 s62, s65, 7602176
    buffer_load_dwordx4 v[120:123], v1, s[8:11], s62 offen sc1
    buffer_load_dwordx4 v[124:127], v1, s[8:11], s62 offen offset:1024 sc1
    s_waitcnt vmcnt(12) lgkmcnt(0)
    v_mfma_f32_16x16x32_bf16 v[48:51], v[16:19], v[80:83], v[48:51]
    ds_read_b64_tr_b16 v[32:33], v12 offset:8192
    v_mfma_f32_16x16x32_bf16 v[64:67], v[16:19], v[84:87], v[64:67]
    ds_read_b64_tr_b16 v[34:35], v12 offset:10240
    v_mfma_f32_16x16x32_bf16 v[52:55], v[20:23], v[80:83], v[52:55]
    ds_read_b64_tr_b16 v[36:37], v13 offset:8192
    v_mfma_f32_16x16x32_bf16 v[68:71], v[20:23], v[84:87], v[68:71]
    ds_read_b64_tr_b16 v[38:39], v13 offset:10240
    v_mfma_f32_16x16x32_bf16 v[56:59], v[24:27], v[80:83], v[56:59]
    ds_read_b64_tr_b16 v[40:41], v14 offset:8192
    v_mfma_f32_16x16x32_bf16 v[72:75], v[24:27], v[84:87], v[72:75]
    ds_read_b64_tr_b16 v[42:43], v14 offset:10240
    v_mfma_f32_16x16x32_bf16 v[60:63], v[28:31], v[80:83], v[60:63]
    ds_read_b64_tr_b16 v[44:45], v15 offset:8192
    v_mfma_f32_16x16x32_bf16 v[76:79], v[28:31], v[84:87], v[76:79]
    ds_read_b64_tr_b16 v[46:47], v15 offset:10240
    s_waitcnt lgkmcnt(0)
    v_mfma_f32_16x16x32_bf16 v[48:51], v[32:35], v[88:91], v[48:51]
    s_waitcnt vmcnt(16)
    s_barrier
    v_mfma_f32_16x16x32_bf16 v[64:67], v[32:35], v[92:95], v[64:67]
    ds_read_b64_tr_b16 v[16:17], v12 offset:16384
    ds_read_b64_tr_b16 v[18:19], v12 offset:18432
    v_mfma_f32_16x16x32_bf16 v[52:55], v[36:39], v[88:91], v[52:55]
    ds_read_b64_tr_b16 v[20:21], v13 offset:16384
    v_mfma_f32_16x16x32_bf16 v[68:71], v[36:39], v[92:95], v[68:71]
    ds_read_b64_tr_b16 v[22:23], v13 offset:18432
    v_mfma_f32_16x16x32_bf16 v[56:59], v[40:43], v[88:91], v[56:59]
    ds_read_b64_tr_b16 v[24:25], v14 offset:16384
    ds_read_b64_tr_b16 v[26:27], v14 offset:18432
    v_mfma_f32_16x16x32_bf16 v[72:75], v[40:43], v[92:95], v[72:75]
    ds_read_b64_tr_b16 v[28:29], v15 offset:16384
    v_mfma_f32_16x16x32_bf16 v[60:63], v[44:47], v[88:91], v[60:63]
    ds_read_b64_tr_b16 v[30:31], v15 offset:18432
    v_mfma_f32_16x16x32_bf16 v[76:79], v[44:47], v[92:95], v[76:79]
    s_add_u32 s62, s65, 7864320
    buffer_load_dwordx4 v[80:83], v1, s[8:11], s62 offen sc1
    buffer_load_dwordx4 v[84:87], v1, s[8:11], s62 offen offset:1024 sc1
    s_add_u32 s62, s65, 8126464
    buffer_load_dwordx4 v[88:91], v1, s[8:11], s62 offen sc1
    buffer_load_dwordx4 v[92:95], v1, s[8:11], s62 offen offset:1024 sc1
    s_waitcnt vmcnt(10) lgkmcnt(0)
    v_mfma_f32_16x16x32_bf16 v[48:51], v[16:19], v[96:99], v[48:51]
    ds_read_b64_tr_b16 v[32:33], v12 offset:24576
    v_mfma_f32_16x16x32_bf16 v[64:67], v[16:19], v[100:103], v[64:67]
    ds_read_b64_tr_b16 v[34:35], v12 offset:26624
    v_mfma_f32_16x16x32_bf16 v[52:55], v[20:23], v[96:99], v[52:55]
    ds_read_b64_tr_b16 v[36:37], v13 offset:24576
    v_mfma_f32_16x16x32_bf16 v[68:71], v[20:23], v[100:103], v[68:71]
    ds_read_b64_tr_b16 v[38:39], v13 offset:26624
    v_mfma_f32_16x16x32_bf16 v[56:59], v[24:27], v[96:99], v[56:59]
    ds_read_b64_tr_b16 v[40:41], v14 offset:24576
    v_mfma_f32_16x16x32_bf16 v[72:75], v[24:27], v[100:103], v[72:75]
    ds_read_b64_tr_b16 v[42:43], v14 offset:26624
    v_mfma_f32_16x16x32_bf16 v[60:63], v[28:31], v[96:99], v[60:63]
    ds_read_b64_tr_b16 v[44:45], v15 offset:24576
    v_mfma_f32_16x16x32_bf16 v[76:79], v[28:31], v[100:103], v[76:79]
    ds_read_b64_tr_b16 v[46:47], v15 offset:26624
    s_waitcnt lgkmcnt(0)
    v_mfma_f32_16x16x32_bf16 v[48:51], v[32:35], v[104:107], v[48:51]
    s_waitcnt vmcnt(14)
    s_barrier
    v_mfma_f32_16x16x32_bf16 v[64:67], v[32:35], v[108:111], v[64:67]
    ds_read_b64_tr_b16 v[16:17], v12 offset:32768
    ds_read_b64_tr_b16 v[18:19], v12 offset:34816
    v_mfma_f32_16x16x32_bf16 v[52:55], v[36:39], v[104:107], v[52:55]
    ds_read_b64_tr_b16 v[20:21], v13 offset:32768
    v_mfma_f32_16x16x32_bf16 v[68:71], v[36:39], v[108:111], v[68:71]
    ds_read_b64_tr_b16 v[22:23], v13 offset:34816
    v_mfma_f32_16x16x32_bf16 v[56:59], v[40:43], v[104:107], v[56:59]
    ds_read_b64_tr_b16 v[24:25], v14 offset:32768
    ds_read_b64_tr_b16 v[26:27], v14 offset:34816
    v_mfma_f32_16x16x32_bf16 v[72:75], v[40:43], v[108:111], v[72:75]
    ds_read_b64_tr_b16 v[28:29], v15 offset:32768
    v_mfma_f32_16x16x32_bf16 v[60:63], v[44:47], v[104:107], v[60:63]
    ds_read_b64_tr_b16 v[30:31], v15 offset:34816
    v_mfma_f32_16x16x32_bf16 v[76:79], v[44:47], v[108:111], v[76:79]
    s_waitcnt vmcnt(4) lgkmcnt(0)
    v_mfma_f32_16x16x32_bf16 v[48:51], v[16:19], v[112:115], v[48:51]
    ds_read_b64_tr_b16 v[32:33], v12 offset:40960
    v_mfma_f32_16x16x32_bf16 v[64:67], v[16:19], v[116:119], v[64:67]
    ds_read_b64_tr_b16 v[34:35], v12 offset:43008
    v_mfma_f32_16x16x32_bf16 v[52:55], v[20:23], v[112:115], v[52:55]
    ds_read_b64_tr_b16 v[36:37], v13 offset:40960
    v_mfma_f32_16x16x32_bf16 v[68:71], v[20:23], v[116:119], v[68:71]
    ds_read_b64_tr_b16 v[38:39], v13 offset:43008
    v_mfma_f32_16x16x32_bf16 v[56:59], v[24:27], v[112:115], v[56:59]
    ds_read_b64_tr_b16 v[40:41], v14 offset:40960
    v_mfma_f32_16x16x32_bf16 v[72:75], v[24:27], v[116:119], v[72:75]
    ds_read_b64_tr_b16 v[42:43], v14 offset:43008
    v_mfma_f32_16x16x32_bf16 v[60:63], v[28:31], v[112:115], v[60:63]
    ds_read_b64_tr_b16 v[44:45], v15 offset:40960
    v_mfma_f32_16x16x32_bf16 v[76:79], v[28:31], v[116:119], v[76:79]
    ds_read_b64_tr_b16 v[46:47], v15 offset:43008
    s_waitcnt lgkmcnt(0)
    v_mfma_f32_16x16x32_bf16 v[48:51], v[32:35], v[120:123], v[48:51]
    s_waitcnt vmcnt(8)
    s_barrier
    v_mfma_f32_16x16x32_bf16 v[64:67], v[32:35], v[124:127], v[64:67]
    ds_read_b64_tr_b16 v[16:17], v12 offset:49152
    ds_read_b64_tr_b16 v[18:19], v12 offset:51200
    v_mfma_f32_16x16x32_bf16 v[52:55], v[36:39], v[120:123], v[52:55]
    ds_read_b64_tr_b16 v[20:21], v13 offset:49152
    v_mfma_f32_16x16x32_bf16 v[68:71], v[36:39], v[124:127], v[68:71]
    ds_read_b64_tr_b16 v[22:23], v13 offset:51200
    v_mfma_f32_16x16x32_bf16 v[56:59], v[40:43], v[120:123], v[56:59]
    ds_read_b64_tr_b16 v[24:25], v14 offset:49152
    ds_read_b64_tr_b16 v[26:27], v14 offset:51200
    v_mfma_f32_16x16x32_bf16 v[72:75], v[40:43], v[124:127], v[72:75]
    ds_read_b64_tr_b16 v[28:29], v15 offset:49152
    v_mfma_f32_16x16x32_bf16 v[60:63], v[44:47], v[120:123], v[60:63]
    ds_read_b64_tr_b16 v[30:31], v15 offset:51200
    v_mfma_f32_16x16x32_bf16 v[76:79], v[44:47], v[124:127], v[76:79]
    s_waitcnt vmcnt(0) lgkmcnt(0)
    v_mfma_f32_16x16x32_bf16 v[48:51], v[16:19], v[80:83], v[48:51]
    ds_read_b64_tr_b16 v[32:33], v12 offset:57344
    v_mfma_f32_16x16x32_bf16 v[64:67], v[16:19], v[84:87], v[64:67]
    ds_read_b64_tr_b16 v[34:35], v12 offset:59392
    v_mfma_f32_16x16x32_bf16 v[52:55], v[20:23], v[80:83], v[52:55]
    ds_read_b64_tr_b16 v[36:37], v13 offset:57344
    v_mfma_f32_16x16x32_bf16 v[68:71], v[20:23], v[84:87], v[68:71]
    ds_read_b64_tr_b16 v[38:39], v13 offset:59392
    v_mfma_f32_16x16x32_bf16 v[56:59], v[24:27], v[80:83], v[56:59]
    ds_read_b64_tr_b16 v[40:41], v14 offset:57344
    v_mfma_f32_16x16x32_bf16 v[72:75], v[24:27], v[84:87], v[72:75]
    ds_read_b64_tr_b16 v[42:43], v14 offset:59392
    v_mfma_f32_16x16x32_bf16 v[60:63], v[28:31], v[80:83], v[60:63]
    ds_read_b64_tr_b16 v[44:45], v15 offset:57344
    v_mfma_f32_16x16x32_bf16 v[76:79], v[28:31], v[84:87], v[76:79]
    ds_read_b64_tr_b16 v[46:47], v15 offset:59392
    s_waitcnt lgkmcnt(0)
    v_mfma_f32_16x16x32_bf16 v[48:51], v[32:35], v[88:91], v[48:51]
    v_mfma_f32_16x16x32_bf16 v[64:67], v[32:35], v[92:95], v[64:67]
    v_mfma_f32_16x16x32_bf16 v[52:55], v[36:39], v[88:91], v[52:55]
    v_mfma_f32_16x16x32_bf16 v[68:71], v[36:39], v[92:95], v[68:71]
    v_mfma_f32_16x16x32_bf16 v[56:59], v[40:43], v[88:91], v[56:59]
    v_mfma_f32_16x16x32_bf16 v[72:75], v[40:43], v[92:95], v[72:75]
    v_mfma_f32_16x16x32_bf16 v[60:63], v[44:47], v[88:91], v[60:63]
    v_mfma_f32_16x16x32_bf16 v[76:79], v[44:47], v[92:95], v[76:79]
    s_lshl_b32 s3, s22, 12
    v_add_u32 v2, s3, v1
    s_xor_b32 s3, s22, 4
    s_lshl_b32 s3, s3, 12
    v_add_u32 v3, s3, v1
    s_cmp_eq_u32 s32, 0
    s_nop 7
    s_cbranch_scc1 gated_mix__softmax_full_mha__linear_kernel_hedgehog__prompt_kernel_k0
    ds_write_b128 v2, v[48:51] offset:0
    ds_write_b128 v2, v[52:55] offset:1024
    ds_write_b128 v2, v[56:59] offset:2048
    ds_write_b128 v2, v[60:63] offset:3072
    s_waitcnt lgkmcnt(0)
    v_mov_b32 v48, v64
    v_mov_b32 v49, v65
    v_mov_b32 v50, v66
    v_mov_b32 v51, v67
    v_mov_b32 v52, v68
    v_mov_b32 v53, v69
    v_mov_b32 v54, v70
    v_mov_b32 v55, v71
    v_mov_b32 v56, v72
    v_mov_b32 v57, v73
    v_mov_b32 v58, v74
    v_mov_b32 v59, v75
    v_mov_b32 v60, v76
    v_mov_b32 v61, v77
    v_mov_b32 v62, v78
    v_mov_b32 v63, v79
    s_branch gated_mix__softmax_full_mha__linear_kernel_hedgehog__prompt_kernel_k1
gated_mix__softmax_full_mha__linear_kernel_hedgehog__prompt_kernel_k0:
    ds_write_b128 v2, v[64:67] offset:0
    ds_write_b128 v2, v[68:71] offset:1024
    ds_write_b128 v2, v[72:75] offset:2048
    ds_write_b128 v2, v[76:79] offset:3072
gated_mix__softmax_full_mha__linear_kernel_hedgehog__prompt_kernel_k1:
    s_waitcnt lgkmcnt(0)
    s_barrier
    ds_read_b128 v[16:19], v3 offset:0
    ds_read_b128 v[20:23], v3 offset:1024
    ds_read_b128 v[24:27], v3 offset:2048
    ds_read_b128 v[28:31], v3 offset:3072
    v_and_b32 v203, 15, v202
    s_lshl_b32 s3, s60, 7
    s_lshl_b32 s6, s27, 5
    s_add_u32 s3, s3, s6
    s_lshl_b32 s6, s32, 4
    s_add_u32 s3, s3, s6
    v_add_u32 v203, s3, v203
    v_lshlrev_b32 v203, 11, v203
    v_bfe_u32 v204, v202, 4, 1
    v_lshl_add_u32 v203, v204, 5, v203
    v_lshrrev_b32 v204, 5, v202
    v_lshl_add_u32 v203, v204, 4, v203
    s_lshl_b32 s3, s61, 7
    s_waitcnt lgkmcnt(0)
    v_pk_add_f32 v[48:49], v[48:49], v[16:17]
    v_pk_add_f32 v[50:51], v[50:51], v[18:19]
    v_pk_add_f32 v[52:53], v[52:53], v[20:21]
    v_pk_add_f32 v[54:55], v[54:55], v[22:23]
    v_pk_add_f32 v[56:57], v[56:57], v[24:25]
    v_pk_add_f32 v[58:59], v[58:59], v[26:27]
    v_pk_add_f32 v[60:61], v[60:61], v[28:29]
    v_pk_add_f32 v[62:63], v[62:63], v[30:31]
    v_cvt_pk_bf16_f32 v32, v48, v49
    v_cvt_pk_bf16_f32 v33, v50, v51
    v_cvt_pk_bf16_f32 v34, v52, v53
    v_cvt_pk_bf16_f32 v35, v54, v55
    s_nop 1
    v_permlane16_swap_b32 v32, v34
    v_permlane16_swap_b32 v33, v35
    buffer_store_dwordx4 v[32:35], v203, s[52:55], s3 offen offset:0 nt
    v_cvt_pk_bf16_f32 v36, v56, v57
    v_cvt_pk_bf16_f32 v37, v58, v59
    v_cvt_pk_bf16_f32 v38, v60, v61
    v_cvt_pk_bf16_f32 v39, v62, v63
    s_nop 1
    v_permlane16_swap_b32 v36, v38
    v_permlane16_swap_b32 v37, v39
    buffer_store_dwordx4 v[36:39], v203, s[52:55], s3 offen offset:64 nt
gated_mix__softmax_full_mha__linear_kernel_hedgehog__prompt_kernel_end:
    s_endpgm
gated_mix__softmax_full_mha__linear_kernel_hedgehog__prompt_kernel_last:
.section .rodata,"a"
.p2align 6
.amdhsa_kernel gated_mix__softmax_full_mha__linear_kernel_hedgehog__prompt_kernel
  .amdhsa_next_free_vgpr 256
  .amdhsa_next_free_sgpr 102
  .amdhsa_accum_offset 256
  .amdhsa_group_segment_fixed_size 0
  .amdhsa_kernarg_size 88
  .amdhsa_user_sgpr_count 2
  .amdhsa_user_sgpr_kernarg_segment_ptr 1
  .amdhsa_system_sgpr_workgroup_id_x 1
.end_amdhsa_kernel
.text
```
